```python
import torch

def _softmax(x, axis=-1):
    return torch.softmax(x, dim=axis)

def _gelu(x):
    return torch.nn.functional.gelu(x, approximate='tanh')

def _silu(x):
    return torch.nn.functional.silu(x)

def _sigmoid(x):
    return torch.sigmoid(x)

def _layernorm(x, axis=-1, eps=1e-05):
    m = x.mean(dim=axis, keepdim=True)
    v = x.var(dim=axis, keepdim=True, unbiased=False)
    return (x - m) / torch.sqrt(v + eps)

def _scatter_add(tgt, idx, src, axis=0):
    return tgt.clone().index_add_(axis, idx, src)

def _segment_sum(src, seg, n):
    out = torch.zeros((n,) + src.shape[1:], dtype=src.dtype)
    return out.index_add_(0, seg, src)

def _pad(x, pw):
    flat = tuple((v for pair in reversed(pw) for v in pair))
    return torch.nn.functional.pad(x, flat)
kernel_name = 'concat_heads__memory_aug_recurrent_mem_tr__linear_attn_block__prompt'

def setup_inputs():

    _w = lambda a: (lambda t: t.to(torch.bfloat16) if t.is_floating_point() else t)(torch.as_tensor(a))

    def _A_setup():
        B, S, Dm = (1, 2048, 1024)
        H, Dh = (32, 128)
        M, seg = (8, 32)
        seg = min(seg, S)
        S = S // seg * seg
        return {'x': _w((lambda *s: torch.randn(*s, dtype=torch.bfloat16) * 0.05)(B, S, Dm)), 'mem0': _w((lambda *s: torch.randn(*s, dtype=torch.bfloat16) * 0.8)(B, M, Dm)), 'Wq': _w((lambda *s: torch.randn(*s, dtype=torch.bfloat16) * 3.2)(Dm, H, Dh) * Dm ** (-0.5)), 'Wk': _w((lambda *s: torch.randn(*s, dtype=torch.bfloat16) * 3.2)(Dm, H, Dh) * Dm ** (-0.5)), 'Wv': _w((lambda *s: torch.randn(*s, dtype=torch.bfloat16) * 0.8)(Dm, H, Dh) * Dm ** (-0.5)), 'Wo': _w((lambda *s: torch.randn(*s, dtype=torch.bfloat16) * 0.8)(H, Dh, Dm) * (H * Dh) ** (-0.5)), 'seg_len': seg}
    _A_in = _A_setup()

    def _B_setup():
        B, S, D = (1, 2048, 1024)
        return {'x': _w((lambda *s: torch.randn(*s, dtype=torch.bfloat16) * 0.05)(B, S, D)), 'wqkv': _w((lambda *s: torch.randn(*s, dtype=torch.bfloat16) * 0.8)(D, 3 * D)), 'wo': _w((lambda *s: torch.randn(*s, dtype=torch.bfloat16) * 0.1)(D, D))}
    _B_in = _B_setup()
    return {'A_x': _A_in['x'], 'A_mem0': _A_in['mem0'], 'A_Wq': _A_in['Wq'], 'A_Wk': _A_in['Wk'], 'A_Wv': _A_in['Wv'], 'A_Wo': _A_in['Wo'], 'A_seg_len': _A_in['seg_len'], 'B_x': _B_in['x'], 'B_wqkv': _B_in['wqkv'], 'B_wo': _B_in['wo']}

def reference(A_x, A_mem0, A_Wq, A_Wk, A_Wv, A_Wo, A_seg_len, B_x, B_wqkv, B_wo):

    def _A_ref(x, mem0, Wq, Wk, Wv, Wo, seg_len):
        B, S, Dm = x.shape
        H, Dh = (Wq.shape[1], Wq.shape[2])
        M = mem0.shape[1]
        scale = Dh ** (-0.5)
        n_seg = S // seg_len
        L = M + seg_len
        idx = torch.arange(L)
        mask = (idx[:, None] < M) | (idx[:, None] >= idx[None, :])
        mem = mem0
        outs = []
        for s in range(n_seg):
            xs = x[:, s * seg_len:(s + 1) * seg_len, :].clone()
            h = torch.concatenate([mem, xs], axis=1)
            q = torch.einsum('btd,dhe->bhte', h, Wq)
            k = torch.einsum('btd,dhe->bhte', h, Wk)
            v = torch.einsum('btd,dhe->bhte', h, Wv)
            scores = torch.einsum('bhqe,bhke->bhqk', q, k) * scale
            scores = torch.where(mask[None, None], scores, -1000000000.0)
            p = _softmax(scores, axis=-1)
            o = torch.einsum('bhqk,bhke->bhqe', p, v)
            o = torch.einsum('bhte,hed->btd', o, Wo)
            mem = o[:, :M, :].clone()
            outs.append(o[:, M:, :])
        return torch.concatenate(outs, axis=1)

    def _B_ref(x, wqkv, wo):
        B, S, D = x.shape
        H = 32
        Dh = D // H
        qkv = (lambda x, *d: x.permute(*d))((x @ wqkv).reshape(B, S, 3, H, Dh), 2, 0, 3, 1, 4)
        q, k, v = (qkv[0], qkv[1], qkv[2])
        phi = lambda t: torch.where(t > 0, t + 1, torch.exp(t)) + 1e-06
        pq, pk = (phi(q), phi(k))
        kv = torch.einsum('bhsd,bhse->bhde', pk, v)
        z = torch.einsum('bhsd->bhd', pk)
        num = torch.einsum('bhqd,bhde->bhqe', pq, kv)
        den = torch.einsum('bhqd,bhd->bhq', pq, z)[..., None] + 1e-06
        o = num / den
        return (lambda x, *d: x.permute(*d))(o, 0, 2, 1, 3).reshape(B, S, D) @ wo
    a = _A_ref(A_x, A_mem0, A_Wq, A_Wk, A_Wv, A_Wo, A_seg_len)
    b = _B_ref(B_x, B_wqkv, B_wo)
    return torch.concatenate([a, b], axis=-1)
```

```asm
; @launch grid=(256,1,1) block=(256,1,1) lds=163840
.amdgcn_target "amdgcn-amd-amdhsa--gfx950"
.text
.globl concat_heads__memory_aug_recurrent_mem_tr__linear_attn_block__prompt_kernel
.p2align 8
.type concat_heads__memory_aug_recurrent_mem_tr__linear_attn_block__prompt_kernel,@function
concat_heads__memory_aug_recurrent_mem_tr__linear_attn_block__prompt_kernel:
  s_cmp_ge_u32 s2, 256
  s_cbranch_scc1 L_end
  s_mov_b32 s101, s2
  v_lshrrev_b32 v1, 6, v0
  v_and_b32 v0, 63, v0
  s_getreg_b32 s51, hwreg(HW_REG_XCC_ID, 0, 4)
  v_readfirstlane_b32 s50, v1
  s_sub_u32 s100, s51, s2
  s_and_b32 s100, s100, 7
  s_cmp_gt_u32 s51, 7
  s_cselect_b32 s100, 8, s100
  s_lshl_b32 s100, s100, 2
  s_add_u32 s100, s100, 32
  s_and_b32 s51, s51, 7
  s_lshl_b32 s51, s51, 2
  s_lshr_b32 s51, 0x76541032, s51
  s_and_b32 s51, s51, 7
  s_mov_b32 s55, 0
L_start:
  s_load_dwordx16 s[24:39], s[0:1], 0
  s_load_dwordx8 s[40:47], s[0:1], 64
  s_load_dwordx2 s[48:49], s[0:1], 96
  s_lshr_b32 s52, s101, 3
  s_lshl_b32 s2, s52, 3
  s_add_u32 s2, s2, s51
  s_mov_b32 s54, 0
  s_waitcnt lgkmcnt(0)
  s_mov_b32 s4, s48
  s_mov_b32 s5, s49
  s_mov_b32 s6, 0x10000000
  s_mov_b32 s7, 0x20000
  s_mov_b32 s20, s46
  s_mov_b32 s21, s47
  s_mov_b32 s22, 0x100
  s_mov_b32 s23, 0x20000
  s_mov_b32 s16, s44
  s_mov_b32 s17, s45
  s_mov_b32 s18, 0x800000
  s_mov_b32 s19, 0x20000
  s_mov_b32 s12, s24
  s_mov_b32 s13, s25
  s_mov_b32 s14, 0x400000
  s_mov_b32 s15, 0x20000
  s_mov_b32 s8, s28
  s_mov_b32 s9, s29
  s_mov_b32 s10, 0x800000
  s_mov_b32 s11, 0x20000
  s_cmp_eq_u32 s100, 0
  s_cbranch_scc1 Lpl_1
  s_cmp_lg_u32 s50, 0
  s_cbranch_scc1 Lpl_1
  s_and_b32 s56, s52, 1
  s_lshl_b32 s56, s56, 7
  s_add_u32 s56, s56, s100
  v_mov_b32 v2, 1
  s_mov_b64 exec, 1
  buffer_atomic_add v2, off, s[20:23], s56 sc1
  s_mov_b64 exec, -1
Lpl_1:
  s_cmp_lt_u32 s51, 2
  s_cbranch_scc0 L_not_rec
  s_cmp_lt_u32 s52, 16
  s_cbranch_scc1 L_qk
  s_branch L_vo
L_not_rec:
  s_cmp_eq_u32 s51, 6
  s_cbranch_scc1 L_pk
  s_cmp_eq_u32 s51, 7
  s_cbranch_scc1 L_pv
  s_cmp_eq_u32 s51, 4
  s_cbranch_scc1 L_qa
  s_cmp_eq_u32 s51, 5
  s_cbranch_scc1 L_b
  s_branch L_g3
L_restart:
  s_and_b32 s51, s101, 7
  s_mov_b32 s100, 0
  s_waitcnt vmcnt(0)
  s_barrier
  s_branch L_start
L_qk:
  v_lshlrev_b32 v1, 4, v0
  s_mov_b32 s60, -1
  s_mov_b32 s61, 0
  s_mov_b32 s64, 0x3e0293ee
  s_and_b32 s65, s52, 15
  v_and_b32 v126, 1, v0
  v_cmp_ne_u32 vcc, 0, v126
  v_mov_b32 v3, 0x4444
  v_mov_b32 v127, 0xeeee
  v_cndmask_b32 v3, v3, v127, vcc
  s_xor_b32 s56, s50, 0
  s_lshl_b32 s56, s56, 12
  s_add_u32 s56, s56, 131072
  v_add_u32 v4, s56, v1
  s_xor_b32 s56, s50, 1
  s_lshl_b32 s56, s56, 12
  s_add_u32 s56, s56, 131072
  v_add_u32 v5, s56, v1
  s_xor_b32 s56, s50, 2
  s_lshl_b32 s56, s56, 12
  s_add_u32 s56, s56, 131072
  v_add_u32 v6, s56, v1
  s_xor_b32 s56, s50, 3
  s_lshl_b32 s56, s56, 12
  s_add_u32 s56, s56, 131072
  v_add_u32 v7, s56, v1
  v_bfe_u32 v126, v0, 2, 1
  v_lshlrev_b32 v126, 4, v126
  v_lshrrev_b32 v127, 5, v0
  v_lshl_add_u32 v126, v127, 3, v126
  v_bfe_u32 v127, v0, 3, 1
  v_lshl_add_u32 v126, v127, 1, v126
  v_bfe_u32 v8, v0, 4, 1
  v_add_u32 v126, v126, v8
  v_bfe_u32 v8, v0, 2, 1
  v_lshl_add_u32 v127, v8, 1, v127
  v_xor_b32 v127, s50, v127
  v_lshlrev_b32 v127, 5, v127
  v_lshl_add_u32 v126, v126, 7, v127
  v_and_b32 v127, 3, v0
  v_lshl_add_u32 v126, v127, 3, v126
  s_xor_b32 s56, s50, 0
  s_lshl_b32 s56, s56, 15
  v_add_u32 v8, s56, v126
  v_add_u32 v120, s56, v1
  v_lshl_add_u32 v120, s50, 11, v120
  s_xor_b32 s56, s50, 1
  s_lshl_b32 s56, s56, 15
  v_add_u32 v9, s56, v126
  v_add_u32 v121, s56, v1
  v_lshl_add_u32 v121, s50, 11, v121
  s_xor_b32 s56, s50, 2
  s_lshl_b32 s56, s56, 15
  v_add_u32 v10, s56, v126
  v_add_u32 v122, s56, v1
  v_lshl_add_u32 v122, s50, 11, v122
  s_xor_b32 s56, s50, 3
  s_lshl_b32 s56, s56, 15
  v_add_u32 v11, s56, v126
  v_add_u32 v123, s56, v1
  v_lshl_add_u32 v123, s50, 11, v123
  s_lshl_b32 s56, s50, 11
  s_lshl_b32 s66, s51, 15
  s_add_u32 s66, s66, s56
  s_add_u32 s66, s66, 0x90000
  s_xor_b32 s67, s51, 1
  s_lshl_b32 s67, s67, 16
  s_add_u32 s67, s67, s56
  s_add_u32 s67, s67, 0x280000
  s_lshl_b32 s69, s51, 17
  s_lshl_b32 s56, s65, 11
  s_add_u32 s69, s69, s56
  s_add_u32 s69, s69, 0xe0000
  s_lshl_b32 s3, s51, 10
  s_add_u32 s3, s3, 0x8000
  s_lshr_b32 s62, s52, 2
  s_lshl_b32 s62, s62, 7
  s_and_b32 s56, s52, 3
  s_lshl_b32 s56, s56, 2
  s_add_u32 s56, s56, s50
  s_lshl_b32 s56, s56, 2
  s_add_u32 s62, s62, s56
  s_add_u32 s62, s62, s3
  s_add_u32 s63, s3, 512
  s_lshl_b32 s37, s2, 7
  s_lshl_b32 s56, s51, 4
  s_add_u32 s65, s65, s56
  v_and_b32 v126, 8, v0
  v_cmp_ne_u32 vcc, 0, v126
  v_lshrrev_b32 v126, 5, v0
  v_lshlrev_b32 v126, 8, v126
  v_and_b32 v127, 7, v0
  v_lshl_add_u32 v126, v127, 5, v126
  v_and_b32 v127, 16, v0
  v_add_u32 v126, v126, v127
  s_lshl_b32 s56, s50, 9
  v_add_u32 v126, s56, v126
  v_mov_b32 v127, 0x80000000
  v_cndmask_b32 v14, v126, v127, vcc
  v_lshl_add_u32 v15, v0, 3, s56
  v_add_u32 v2, 151552, v1
  v_lshrrev_b32 v126, 4, v0
  v_bfe_u32 v127, v0, 3, 1
  v_lshlrev_b32 v127, 1, v127
  v_xor_b32 v126, v126, v127
  v_lshlrev_b32 v126, 4, v126
  v_lshl_add_u32 v126, v127, 7, v126
  v_bfe_u32 v127, v0, 2, 1
  v_lshl_add_u32 v126, v127, 6, v126
  v_and_b32 v127, 3, v0
  v_lshl_add_u32 v126, v127, 2, v126
  s_lshl_b32 s56, s50, 10
  s_add_u32 s56, s56, 147456
  v_add_u32 v12, s56, v126
  v_bfe_u32 v126, v0, 1, 2
  v_lshrrev_b32 v127, 5, v0
  v_lshlrev_b32 v127, 1, v127
  v_xor_b32 v126, v126, v127
  v_lshlrev_b32 v126, 4, v126
  v_lshl_add_u32 v126, v127, 7, v126
  v_bfe_u32 v127, v0, 4, 1
  v_lshl_add_u32 v126, v127, 6, v126
  v_and_b32 v127, 1, v0
  v_lshl_add_u32 v126, v127, 7, v126
  v_add_u32 v13, 147456, v126
  s_and_b32 s56, s50, 1
  s_lshl_b32 s56, s56, 11
  s_cmp_lt_u32 s50, 2
  s_cselect_b32 s41, 0x3000, 0
  s_cselect_b32 s40, 0, 8192
  s_add_u32 s40, s40, s56
  s_add_u32 s40, s40, 151552
  s_lshl_b32 s68, s51, 17
  s_and_b32 s57, s65, 15
  s_lshl_b32 s56, s57, 11
  s_add_u32 s68, s68, s56
  s_add_u32 s68, s68, 0xa0000
  s_lshl_b32 s38, s51, 18
  s_lshr_b32 s56, s57, 2
  s_lshl_b32 s56, s56, 14
  s_add_u32 s38, s38, s56
  s_and_b32 s56, s57, 3
  s_lshl_b32 s56, s56, 11
  s_add_u32 s38, s38, s56
  s_add_u32 s38, s38, 0x200000
  s_cmp_lg_u32 s50, 0
  s_cbranch_scc1 Lar_2
  s_cmp_eq_u32 s100, 0
  s_cbranch_scc0 Lar_2
  s_mov_b32 s56, 0
  v_mov_b32 v126, 1
  s_mov_b64 exec, 1
  buffer_atomic_add v126, off, s[20:23], s56 sc1
  s_mov_b64 exec, -1
Lar_2:
  v_lshrrev_b32 v126, 3, v0
  v_lshlrev_b32 v16, 13, v126
  v_and_b32 v126, 2, v126
  v_xor_b32 v126, v126, v0
  v_and_b32 v126, 7, v126
  v_lshlrev_b32 v126, 4, v126
  v_xor_b32 v17, 64, v126
  v_add_u32 v17, v17, v16
  v_add_u32 v16, v126, v16
  s_lshl_b32 s74, s65, 10
  s_add_u32 s74, s74, 768
  s_mov_b32 s72, 0
  s_mul_i32 s75, s65, 0x202000
  s_add_u32 s75, s75, 0x1000000
  s_mov_b32 s12, s34
  s_mov_b32 s13, s35
  s_mov_b32 s14, 0x800000
  s_mov_b32 s15, 0x20000
  s_bitcmp1_b32 s65, 0
  s_cbranch_scc1 Lhv_3
  s_and_b32 s56, s65, 14
  s_lshl_b32 s56, s56, 1
  s_add_u32 s56, s56, s50
  s_lshl_b32 s56, s56, 17
  s_xor_b32 s57, s51, 0
  s_lshl_b32 s57, s57, 22
  s_add_u32 s56, s56, s57
  s_lshl_b32 s57, s51, 10
  s_add_u32 s56, s56, s57
  v_lshlrev_b32 v22, 11, v0
  buffer_load_dword v23, v22, s[12:15], s56 offen offset:384
Lhv_3:
  s_mov_b32 s8, s28
  s_mov_b32 s9, s29
  s_mov_b32 s10, 0x800000
  s_mov_b32 s11, 0x20000
  s_xor_b32 s73, s51, 0
  s_lshl_b32 s73, s73, 2
  s_add_u32 s73, s73, s50
  s_lshl_b32 s73, s73, 20
  s_lshl_b32 s56, s65, 8
  s_add_u32 s73, s73, s56
  s_lshl_b32 s56, s50, 15
  s_add_u32 s56, s56, 0
  s_sub_u32 s57, s73, 65536
  s_mov_b32 s58, 4
Ldma_4:
  s_mov_b32 m0, s56
  s_add_u32 s57, s57, 65536
  buffer_load_dwordx4 v16, s[8:11], s57 offen nt lds
  s_add_u32 s56, s56, 1024
  s_mov_b32 m0, s56
  s_add_u32 s57, s57, 65536
  buffer_load_dwordx4 v16, s[8:11], s57 offen nt lds
  s_add_u32 s56, s56, 1024
  s_mov_b32 m0, s56
  s_add_u32 s57, s57, 65536
  buffer_load_dwordx4 v17, s[8:11], s57 offen nt lds
  s_add_u32 s56, s56, 1024
  s_mov_b32 m0, s56
  s_add_u32 s57, s57, 65536
  buffer_load_dwordx4 v17, s[8:11], s57 offen nt lds
  s_add_u32 s56, s56, 1024
  s_sub_u32 s58, s58, 1
  s_cmp_lg_u32 s58, 0
  s_cbranch_scc1 Ldma_4
  s_mov_b32 s8, s28
  s_mov_b32 s9, s29
  s_mov_b32 s10, 0x800000
  s_mov_b32 s11, 0x20000
  s_xor_b32 s73, s51, 1
  s_lshl_b32 s73, s73, 2
  s_add_u32 s73, s73, s50
  s_lshl_b32 s73, s73, 20
  s_lshl_b32 s56, s65, 8
  s_add_u32 s73, s73, s56
  s_lshl_b32 s56, s50, 15
  s_add_u32 s56, s56, 16384
  s_sub_u32 s57, s73, 65536
  s_mov_b32 s58, 4
Ldma_5:
  s_mov_b32 m0, s56
  s_add_u32 s57, s57, 65536
  buffer_load_dwordx4 v16, s[8:11], s57 offen nt lds
  s_add_u32 s56, s56, 1024
  s_mov_b32 m0, s56
  s_add_u32 s57, s57, 65536
  buffer_load_dwordx4 v16, s[8:11], s57 offen nt lds
  s_add_u32 s56, s56, 1024
  s_mov_b32 m0, s56
  s_add_u32 s57, s57, 65536
  buffer_load_dwordx4 v17, s[8:11], s57 offen nt lds
  s_add_u32 s56, s56, 1024
  s_mov_b32 m0, s56
  s_add_u32 s57, s57, 65536
  buffer_load_dwordx4 v17, s[8:11], s57 offen nt lds
  s_add_u32 s56, s56, 1024
  s_sub_u32 s58, s58, 1
  s_cmp_lg_u32 s58, 0
  s_cbranch_scc1 Ldma_5
  s_waitcnt vmcnt(16)
  s_barrier
  ds_read_b64_tr_b16 a[0:1], v8 offset:0
  ds_read_b64_tr_b16 a[2:3], v8 offset:512
  ds_read_b64_tr_b16 a[4:5], v8 offset:4096
  ds_read_b64_tr_b16 a[6:7], v8 offset:4608
  ds_read_b64_tr_b16 a[8:9], v8 offset:8192
  ds_read_b64_tr_b16 a[10:11], v8 offset:8704
  ds_read_b64_tr_b16 a[12:13], v8 offset:12288
  ds_read_b64_tr_b16 a[14:15], v8 offset:12800
  ds_read_b64_tr_b16 a[32:33], v9 offset:0
  ds_read_b64_tr_b16 a[34:35], v9 offset:512
  ds_read_b64_tr_b16 a[36:37], v9 offset:4096
  ds_read_b64_tr_b16 a[38:39], v9 offset:4608
  ds_read_b64_tr_b16 a[40:41], v9 offset:8192
  ds_read_b64_tr_b16 a[42:43], v9 offset:8704
  ds_read_b64_tr_b16 a[44:45], v9 offset:12288
  ds_read_b64_tr_b16 a[46:47], v9 offset:12800
  ds_read_b64_tr_b16 a[64:65], v10 offset:0
  ds_read_b64_tr_b16 a[66:67], v10 offset:512
  ds_read_b64_tr_b16 a[68:69], v10 offset:4096
  ds_read_b64_tr_b16 a[70:71], v10 offset:4608
  ds_read_b64_tr_b16 a[72:73], v10 offset:8192
  ds_read_b64_tr_b16 a[74:75], v10 offset:8704
  ds_read_b64_tr_b16 a[76:77], v10 offset:12288
  ds_read_b64_tr_b16 a[78:79], v10 offset:12800
  ds_read_b64_tr_b16 a[96:97], v11 offset:0
  ds_read_b64_tr_b16 a[98:99], v11 offset:512
  ds_read_b64_tr_b16 a[100:101], v11 offset:4096
  ds_read_b64_tr_b16 a[102:103], v11 offset:4608
  ds_read_b64_tr_b16 a[104:105], v11 offset:8192
  ds_read_b64_tr_b16 a[106:107], v11 offset:8704
  ds_read_b64_tr_b16 a[108:109], v11 offset:12288
  ds_read_b64_tr_b16 a[110:111], v11 offset:12800
  s_waitcnt lgkmcnt(0)
  s_barrier
  s_mov_b32 s12, s34
  s_mov_b32 s13, s35
  s_mov_b32 s14, 0x800000
  s_mov_b32 s15, 0x20000
  s_bitcmp1_b32 s65, 0
  s_cbranch_scc1 Lhv_6
  s_and_b32 s56, s65, 14
  s_lshl_b32 s56, s56, 1
  s_add_u32 s56, s56, s50
  s_lshl_b32 s56, s56, 17
  s_xor_b32 s57, s51, 1
  s_lshl_b32 s57, s57, 22
  s_add_u32 s56, s56, s57
  s_lshl_b32 s57, s51, 10
  s_add_u32 s56, s56, s57
  v_lshlrev_b32 v22, 11, v0
  buffer_load_dword v23, v22, s[12:15], s56 offen offset:384
Lhv_6:
  s_mov_b32 s8, s28
  s_mov_b32 s9, s29
  s_mov_b32 s10, 0x800000
  s_mov_b32 s11, 0x20000
  s_xor_b32 s73, s51, 0
  s_lshl_b32 s73, s73, 2
  s_add_u32 s73, s73, s50
  s_lshl_b32 s73, s73, 20
  s_lshl_b32 s56, s65, 8
  s_add_u32 s73, s73, s56
  s_add_u32 s73, s73, 128
  s_lshl_b32 s56, s50, 15
  s_add_u32 s56, s56, 0
  s_sub_u32 s57, s73, 65536
  s_mov_b32 s58, 4
Ldma_7:
  s_mov_b32 m0, s56
  s_add_u32 s57, s57, 65536
  buffer_load_dwordx4 v16, s[8:11], s57 offen nt lds
  s_add_u32 s56, s56, 1024
  s_mov_b32 m0, s56
  s_add_u32 s57, s57, 65536
  buffer_load_dwordx4 v16, s[8:11], s57 offen nt lds
  s_add_u32 s56, s56, 1024
  s_mov_b32 m0, s56
  s_add_u32 s57, s57, 65536
  buffer_load_dwordx4 v17, s[8:11], s57 offen nt lds
  s_add_u32 s56, s56, 1024
  s_mov_b32 m0, s56
  s_add_u32 s57, s57, 65536
  buffer_load_dwordx4 v17, s[8:11], s57 offen nt lds
  s_add_u32 s56, s56, 1024
  s_sub_u32 s58, s58, 1
  s_cmp_lg_u32 s58, 0
  s_cbranch_scc1 Ldma_7
  s_waitcnt vmcnt(16)
  s_barrier
  ds_read_b64_tr_b16 a[16:17], v8 offset:16384
  ds_read_b64_tr_b16 a[18:19], v8 offset:16896
  ds_read_b64_tr_b16 a[20:21], v8 offset:20480
  ds_read_b64_tr_b16 a[22:23], v8 offset:20992
  ds_read_b64_tr_b16 a[24:25], v8 offset:24576
  ds_read_b64_tr_b16 a[26:27], v8 offset:25088
  ds_read_b64_tr_b16 a[28:29], v8 offset:28672
  ds_read_b64_tr_b16 a[30:31], v8 offset:29184
  ds_read_b64_tr_b16 a[48:49], v9 offset:16384
  ds_read_b64_tr_b16 a[50:51], v9 offset:16896
  ds_read_b64_tr_b16 a[52:53], v9 offset:20480
  ds_read_b64_tr_b16 a[54:55], v9 offset:20992
  ds_read_b64_tr_b16 a[56:57], v9 offset:24576
  ds_read_b64_tr_b16 a[58:59], v9 offset:25088
  ds_read_b64_tr_b16 a[60:61], v9 offset:28672
  ds_read_b64_tr_b16 a[62:63], v9 offset:29184
  ds_read_b64_tr_b16 a[80:81], v10 offset:16384
  ds_read_b64_tr_b16 a[82:83], v10 offset:16896
  ds_read_b64_tr_b16 a[84:85], v10 offset:20480
  ds_read_b64_tr_b16 a[86:87], v10 offset:20992
  ds_read_b64_tr_b16 a[88:89], v10 offset:24576
  ds_read_b64_tr_b16 a[90:91], v10 offset:25088
  ds_read_b64_tr_b16 a[92:93], v10 offset:28672
  ds_read_b64_tr_b16 a[94:95], v10 offset:29184
  ds_read_b64_tr_b16 a[112:113], v11 offset:16384
  ds_read_b64_tr_b16 a[114:115], v11 offset:16896
  ds_read_b64_tr_b16 a[116:117], v11 offset:20480
  ds_read_b64_tr_b16 a[118:119], v11 offset:20992
  ds_read_b64_tr_b16 a[120:121], v11 offset:24576
  ds_read_b64_tr_b16 a[122:123], v11 offset:25088
  ds_read_b64_tr_b16 a[124:125], v11 offset:28672
  ds_read_b64_tr_b16 a[126:127], v11 offset:29184
  s_waitcnt lgkmcnt(0)
  s_barrier
  s_mov_b32 s12, s26
  s_mov_b32 s13, s27
  s_mov_b32 s14, 0x4000
  s_mov_b32 s15, 0x20000
  s_lshl_b32 s56, s50, 12
  s_add_u32 m0, s56, 131072
  s_nop 0
  buffer_load_dwordx4 v1, s[12:15], s56 offen offset:0 lds
  buffer_load_dwordx4 v1, s[12:15], s56 offen offset:1024 lds
  buffer_load_dwordx4 v1, s[12:15], s56 offen offset:2048 lds
  buffer_load_dwordx4 v1, s[12:15], s56 offen offset:3072 lds
  s_mov_b32 s8, s28
  s_mov_b32 s9, s29
  s_mov_b32 s10, 0x800000
  s_mov_b32 s11, 0x20000
  s_xor_b32 s73, s51, 1
  s_lshl_b32 s73, s73, 2
  s_add_u32 s73, s73, s50
  s_lshl_b32 s73, s73, 20
  s_lshl_b32 s56, s65, 8
  s_add_u32 s73, s73, s56
  s_add_u32 s73, s73, 128
  s_lshl_b32 s56, s50, 15
  s_add_u32 s56, s56, 16384
  s_sub_u32 s57, s73, 65536
  s_mov_b32 s58, 4
Ldma_8:
  s_mov_b32 m0, s56
  s_add_u32 s57, s57, 65536
  buffer_load_dwordx4 v16, s[8:11], s57 offen nt lds
  s_add_u32 s56, s56, 1024
  s_mov_b32 m0, s56
  s_add_u32 s57, s57, 65536
  buffer_load_dwordx4 v16, s[8:11], s57 offen nt lds
  s_add_u32 s56, s56, 1024
  s_mov_b32 m0, s56
  s_add_u32 s57, s57, 65536
  buffer_load_dwordx4 v17, s[8:11], s57 offen nt lds
  s_add_u32 s56, s56, 1024
  s_mov_b32 m0, s56
  s_add_u32 s57, s57, 65536
  buffer_load_dwordx4 v17, s[8:11], s57 offen nt lds
  s_add_u32 s56, s56, 1024
  s_sub_u32 s58, s58, 1
  s_cmp_lg_u32 s58, 0
  s_cbranch_scc1 Ldma_8
  s_waitcnt vmcnt(16)
  s_barrier
  ds_read_b64_tr_b16 a[128:129], v8 offset:0
  ds_read_b64_tr_b16 a[130:131], v8 offset:512
  ds_read_b64_tr_b16 a[132:133], v8 offset:4096
  ds_read_b64_tr_b16 a[134:135], v8 offset:4608
  ds_read_b64_tr_b16 a[136:137], v8 offset:8192
  ds_read_b64_tr_b16 a[138:139], v8 offset:8704
  ds_read_b64_tr_b16 a[140:141], v8 offset:12288
  ds_read_b64_tr_b16 a[142:143], v8 offset:12800
  ds_read_b64_tr_b16 a[160:161], v9 offset:0
  ds_read_b64_tr_b16 a[162:163], v9 offset:512
  ds_read_b64_tr_b16 a[164:165], v9 offset:4096
  ds_read_b64_tr_b16 a[166:167], v9 offset:4608
  ds_read_b64_tr_b16 a[168:169], v9 offset:8192
  ds_read_b64_tr_b16 a[170:171], v9 offset:8704
  ds_read_b64_tr_b16 a[172:173], v9 offset:12288
  ds_read_b64_tr_b16 a[174:175], v9 offset:12800
  ds_read_b64_tr_b16 a[192:193], v10 offset:0
  ds_read_b64_tr_b16 a[194:195], v10 offset:512
  ds_read_b64_tr_b16 a[196:197], v10 offset:4096
  ds_read_b64_tr_b16 a[198:199], v10 offset:4608
  ds_read_b64_tr_b16 a[200:201], v10 offset:8192
  ds_read_b64_tr_b16 a[202:203], v10 offset:8704
  ds_read_b64_tr_b16 a[204:205], v10 offset:12288
  ds_read_b64_tr_b16 a[206:207], v10 offset:12800
  ds_read_b64_tr_b16 a[224:225], v11 offset:0
  ds_read_b64_tr_b16 a[226:227], v11 offset:512
  ds_read_b64_tr_b16 a[228:229], v11 offset:4096
  ds_read_b64_tr_b16 a[230:231], v11 offset:4608
  ds_read_b64_tr_b16 a[232:233], v11 offset:8192
  ds_read_b64_tr_b16 a[234:235], v11 offset:8704
  ds_read_b64_tr_b16 a[236:237], v11 offset:12288
  ds_read_b64_tr_b16 a[238:239], v11 offset:12800
  s_waitcnt lgkmcnt(0)
  s_barrier
  s_mov_b32 s8, s30
  s_mov_b32 s9, s31
  s_mov_b32 s10, 0x800000
  s_mov_b32 s11, 0x20000
  s_xor_b32 s73, s51, 0
  s_lshl_b32 s73, s73, 2
  s_add_u32 s73, s73, s50
  s_lshl_b32 s73, s73, 20
  s_lshl_b32 s56, s65, 8
  s_add_u32 s73, s73, s56
  s_lshl_b32 s56, s50, 15
  s_add_u32 s56, s56, 0
  s_sub_u32 s57, s73, 65536
  s_mov_b32 s58, 4
Ldma_9:
  s_mov_b32 m0, s56
  s_add_u32 s57, s57, 65536
  buffer_load_dwordx4 v16, s[8:11], s57 offen nt lds
  s_add_u32 s56, s56, 1024
  s_mov_b32 m0, s56
  s_add_u32 s57, s57, 65536
  buffer_load_dwordx4 v16, s[8:11], s57 offen nt lds
  s_add_u32 s56, s56, 1024
  s_mov_b32 m0, s56
  s_add_u32 s57, s57, 65536
  buffer_load_dwordx4 v17, s[8:11], s57 offen nt lds
  s_add_u32 s56, s56, 1024
  s_mov_b32 m0, s56
  s_add_u32 s57, s57, 65536
  buffer_load_dwordx4 v17, s[8:11], s57 offen nt lds
  s_add_u32 s56, s56, 1024
  s_sub_u32 s58, s58, 1
  s_cmp_lg_u32 s58, 0
  s_cbranch_scc1 Ldma_9
  s_waitcnt vmcnt(16)
  s_barrier
  ds_read_b64_tr_b16 a[144:145], v8 offset:16384
  ds_read_b64_tr_b16 a[146:147], v8 offset:16896
  ds_read_b64_tr_b16 a[148:149], v8 offset:20480
  ds_read_b64_tr_b16 a[150:151], v8 offset:20992
  ds_read_b64_tr_b16 a[152:153], v8 offset:24576
  ds_read_b64_tr_b16 a[154:155], v8 offset:25088
  ds_read_b64_tr_b16 a[156:157], v8 offset:28672
  ds_read_b64_tr_b16 a[158:159], v8 offset:29184
  ds_read_b64_tr_b16 a[176:177], v9 offset:16384
  ds_read_b64_tr_b16 a[178:179], v9 offset:16896
  ds_read_b64_tr_b16 a[180:181], v9 offset:20480
  ds_read_b64_tr_b16 a[182:183], v9 offset:20992
  ds_read_b64_tr_b16 a[184:185], v9 offset:24576
  ds_read_b64_tr_b16 a[186:187], v9 offset:25088
  ds_read_b64_tr_b16 a[188:189], v9 offset:28672
  ds_read_b64_tr_b16 a[190:191], v9 offset:29184
  ds_read_b64_tr_b16 a[208:209], v10 offset:16384
  ds_read_b64_tr_b16 a[210:211], v10 offset:16896
  ds_read_b64_tr_b16 a[212:213], v10 offset:20480
  ds_read_b64_tr_b16 a[214:215], v10 offset:20992
  ds_read_b64_tr_b16 a[216:217], v10 offset:24576
  ds_read_b64_tr_b16 a[218:219], v10 offset:25088
  ds_read_b64_tr_b16 a[220:221], v10 offset:28672
  ds_read_b64_tr_b16 a[222:223], v10 offset:29184
  ds_read_b64_tr_b16 a[240:241], v11 offset:16384
  ds_read_b64_tr_b16 a[242:243], v11 offset:16896
  ds_read_b64_tr_b16 a[244:245], v11 offset:20480
  ds_read_b64_tr_b16 a[246:247], v11 offset:20992
  ds_read_b64_tr_b16 a[248:249], v11 offset:24576
  ds_read_b64_tr_b16 a[250:251], v11 offset:25088
  ds_read_b64_tr_b16 a[252:253], v11 offset:28672
  ds_read_b64_tr_b16 a[254:255], v11 offset:29184
  s_waitcnt lgkmcnt(0)
  s_barrier
  v_bfe_u32 v126, v0, 1, 3
  v_lshlrev_b32 v126, 11, v126
  v_lshrrev_b32 v127, 5, v0
  v_lshl_add_u32 v126, v127, 6, v126
  v_and_b32 v127, 16, v0
  v_add_u32 v126, v126, v127
  v_and_b32 v127, 1, v0
  v_lshl_add_u32 v126, v127, 2, v126
  s_lshl_b32 s56, s51, 2
  s_add_u32 s56, s56, s50
  s_lshl_b32 s56, s56, 8
  s_add_u32 s56, s56, 131072
  v_add_u32 v126, s56, v126
  v_xor_b32 v127, 1024, v126
  ds_read_b32 v96, v126 offset:0
  ds_read_b32 v97, v126 offset:8
  ds_read_b32 v98, v126 offset:32
  ds_read_b32 v99, v126 offset:40
  ds_read_b32 v100, v126 offset:128
  ds_read_b32 v101, v126 offset:136
  ds_read_b32 v102, v126 offset:160
  ds_read_b32 v103, v126 offset:168
  ds_read_b32 v104, v127 offset:0
  ds_read_b32 v105, v127 offset:8
  ds_read_b32 v106, v127 offset:32
  ds_read_b32 v107, v127 offset:40
  ds_read_b32 v108, v127 offset:128
  ds_read_b32 v109, v127 offset:136
  ds_read_b32 v110, v127 offset:160
  ds_read_b32 v111, v127 offset:168
  s_mov_b32 s8, s30
  s_mov_b32 s9, s31
  s_mov_b32 s10, 0x800000
  s_mov_b32 s11, 0x20000
  s_xor_b32 s73, s51, 1
  s_lshl_b32 s73, s73, 2
  s_add_u32 s73, s73, s50
  s_lshl_b32 s73, s73, 20
  s_lshl_b32 s56, s65, 8
  s_add_u32 s73, s73, s56
  s_lshl_b32 s56, s50, 15
  s_add_u32 s56, s56, 16384
  s_sub_u32 s57, s73, 65536
  s_mov_b32 s58, 4
Ldma_10:
  s_mov_b32 m0, s56
  s_add_u32 s57, s57, 65536
  buffer_load_dwordx4 v16, s[8:11], s57 offen nt lds
  s_add_u32 s56, s56, 1024
  s_mov_b32 m0, s56
  s_add_u32 s57, s57, 65536
  buffer_load_dwordx4 v16, s[8:11], s57 offen nt lds
  s_add_u32 s56, s56, 1024
  s_mov_b32 m0, s56
  s_add_u32 s57, s57, 65536
  buffer_load_dwordx4 v17, s[8:11], s57 offen nt lds
  s_add_u32 s56, s56, 1024
  s_mov_b32 m0, s56
  s_add_u32 s57, s57, 65536
  buffer_load_dwordx4 v17, s[8:11], s57 offen nt lds
  s_add_u32 s56, s56, 1024
  s_sub_u32 s58, s58, 1
  s_cmp_lg_u32 s58, 0
  s_cbranch_scc1 Ldma_10
  s_waitcnt vmcnt(16)
  s_barrier
  ds_read_b64_tr_b16 v[128:129], v8 offset:0
  ds_read_b64_tr_b16 v[130:131], v8 offset:512
  ds_read_b64_tr_b16 v[132:133], v8 offset:4096
  ds_read_b64_tr_b16 v[134:135], v8 offset:4608
  ds_read_b64_tr_b16 v[136:137], v8 offset:8192
  ds_read_b64_tr_b16 v[138:139], v8 offset:8704
  ds_read_b64_tr_b16 v[140:141], v8 offset:12288
  ds_read_b64_tr_b16 v[142:143], v8 offset:12800
  ds_read_b64_tr_b16 v[160:161], v9 offset:0
  ds_read_b64_tr_b16 v[162:163], v9 offset:512
  ds_read_b64_tr_b16 v[164:165], v9 offset:4096
  ds_read_b64_tr_b16 v[166:167], v9 offset:4608
  ds_read_b64_tr_b16 v[168:169], v9 offset:8192
  ds_read_b64_tr_b16 v[170:171], v9 offset:8704
  ds_read_b64_tr_b16 v[172:173], v9 offset:12288
  ds_read_b64_tr_b16 v[174:175], v9 offset:12800
  ds_read_b64_tr_b16 v[192:193], v10 offset:0
  ds_read_b64_tr_b16 v[194:195], v10 offset:512
  ds_read_b64_tr_b16 v[196:197], v10 offset:4096
  ds_read_b64_tr_b16 v[198:199], v10 offset:4608
  ds_read_b64_tr_b16 v[200:201], v10 offset:8192
  ds_read_b64_tr_b16 v[202:203], v10 offset:8704
  ds_read_b64_tr_b16 v[204:205], v10 offset:12288
  ds_read_b64_tr_b16 v[206:207], v10 offset:12800
  ds_read_b64_tr_b16 v[224:225], v11 offset:0
  ds_read_b64_tr_b16 v[226:227], v11 offset:512
  ds_read_b64_tr_b16 v[228:229], v11 offset:4096
  ds_read_b64_tr_b16 v[230:231], v11 offset:4608
  ds_read_b64_tr_b16 v[232:233], v11 offset:8192
  ds_read_b64_tr_b16 v[234:235], v11 offset:8704
  ds_read_b64_tr_b16 v[236:237], v11 offset:12288
  ds_read_b64_tr_b16 v[238:239], v11 offset:12800
  s_waitcnt lgkmcnt(0)
  s_barrier
  v_lshlrev_b32 v21, 2, v0
  buffer_load_dword v20, v21, s[20:23], 0 offen sc1
  s_mov_b32 s8, s30
  s_mov_b32 s9, s31
  s_mov_b32 s10, 0x800000
  s_mov_b32 s11, 0x20000
  s_xor_b32 s73, s51, 0
  s_lshl_b32 s73, s73, 2
  s_add_u32 s73, s73, s50
  s_lshl_b32 s73, s73, 20
  s_lshl_b32 s56, s65, 8
  s_add_u32 s73, s73, s56
  s_add_u32 s73, s73, 128
  s_lshl_b32 s56, s50, 15
  s_add_u32 s56, s56, 0
  s_sub_u32 s57, s73, 65536
  s_mov_b32 s58, 4
Ldma_11:
  s_mov_b32 m0, s56
  s_add_u32 s57, s57, 65536
  buffer_load_dwordx4 v16, s[8:11], s57 offen nt lds
  s_add_u32 s56, s56, 1024
  s_mov_b32 m0, s56
  s_add_u32 s57, s57, 65536
  buffer_load_dwordx4 v16, s[8:11], s57 offen nt lds
  s_add_u32 s56, s56, 1024
  s_mov_b32 m0, s56
  s_add_u32 s57, s57, 65536
  buffer_load_dwordx4 v17, s[8:11], s57 offen nt lds
  s_add_u32 s56, s56, 1024
  s_mov_b32 m0, s56
  s_add_u32 s57, s57, 65536
  buffer_load_dwordx4 v17, s[8:11], s57 offen nt lds
  s_add_u32 s56, s56, 1024
  s_sub_u32 s58, s58, 1
  s_cmp_lg_u32 s58, 0
  s_cbranch_scc1 Ldma_11
  s_waitcnt vmcnt(16)
  s_barrier
  ds_read_b64_tr_b16 v[144:145], v8 offset:16384
  ds_read_b64_tr_b16 v[146:147], v8 offset:16896
  ds_read_b64_tr_b16 v[148:149], v8 offset:20480
  ds_read_b64_tr_b16 v[150:151], v8 offset:20992
  ds_read_b64_tr_b16 v[152:153], v8 offset:24576
  ds_read_b64_tr_b16 v[154:155], v8 offset:25088
  ds_read_b64_tr_b16 v[156:157], v8 offset:28672
  ds_read_b64_tr_b16 v[158:159], v8 offset:29184
  ds_read_b64_tr_b16 v[176:177], v9 offset:16384
  ds_read_b64_tr_b16 v[178:179], v9 offset:16896
  ds_read_b64_tr_b16 v[180:181], v9 offset:20480
  ds_read_b64_tr_b16 v[182:183], v9 offset:20992
  ds_read_b64_tr_b16 v[184:185], v9 offset:24576
  ds_read_b64_tr_b16 v[186:187], v9 offset:25088
  ds_read_b64_tr_b16 v[188:189], v9 offset:28672
  ds_read_b64_tr_b16 v[190:191], v9 offset:29184
  ds_read_b64_tr_b16 v[208:209], v10 offset:16384
  ds_read_b64_tr_b16 v[210:211], v10 offset:16896
  ds_read_b64_tr_b16 v[212:213], v10 offset:20480
  ds_read_b64_tr_b16 v[214:215], v10 offset:20992
  ds_read_b64_tr_b16 v[216:217], v10 offset:24576
  ds_read_b64_tr_b16 v[218:219], v10 offset:25088
  ds_read_b64_tr_b16 v[220:221], v10 offset:28672
  ds_read_b64_tr_b16 v[222:223], v10 offset:29184
  ds_read_b64_tr_b16 v[240:241], v11 offset:16384
  ds_read_b64_tr_b16 v[242:243], v11 offset:16896
  ds_read_b64_tr_b16 v[244:245], v11 offset:20480
  ds_read_b64_tr_b16 v[246:247], v11 offset:20992
  ds_read_b64_tr_b16 v[248:249], v11 offset:24576
  ds_read_b64_tr_b16 v[250:251], v11 offset:25088
  ds_read_b64_tr_b16 v[252:253], v11 offset:28672
  ds_read_b64_tr_b16 v[254:255], v11 offset:29184
  s_waitcnt lgkmcnt(0)
  s_barrier
  s_branch Lwa_16
Lwa_12:
  v_lshlrev_b32 v21, 2, v0
  buffer_load_dword v20, v21, s[20:23], 0 offen sc1
  s_waitcnt vmcnt(0)
Lwa_16:
  s_cmp_eq_u32 s100, 0
  s_cbranch_scc1 Lwa_14
  s_mov_b32 s56, 0
  v_readlane_b32 s57, v20, 8
  s_add_u32 s56, s56, s57
  v_readlane_b32 s57, v20, 9
  s_add_u32 s56, s56, s57
  v_readlane_b32 s57, v20, 10
  s_add_u32 s56, s56, s57
  v_readlane_b32 s57, v20, 11
  s_add_u32 s56, s56, s57
  v_readlane_b32 s57, v20, 12
  s_add_u32 s56, s56, s57
  v_readlane_b32 s57, v20, 13
  s_add_u32 s56, s56, s57
  v_readlane_b32 s57, v20, 14
  s_add_u32 s56, s56, s57
  v_readlane_b32 s57, v20, 15
  s_add_u32 s56, s56, s57
  v_readlane_b32 s57, v20, 16
  s_add_u32 s56, s56, s57
  v_readlane_b32 s57, v20, 40
  s_add_u32 s56, s56, s57
  v_readlane_b32 s57, v20, 41
  s_add_u32 s56, s56, s57
  v_readlane_b32 s57, v20, 42
  s_add_u32 s56, s56, s57
  v_readlane_b32 s57, v20, 43
  s_add_u32 s56, s56, s57
  v_readlane_b32 s57, v20, 44
  s_add_u32 s56, s56, s57
  v_readlane_b32 s57, v20, 45
  s_add_u32 s56, s56, s57
  v_readlane_b32 s57, v20, 46
  s_add_u32 s56, s56, s57
  v_readlane_b32 s57, v20, 47
  s_add_u32 s56, s56, s57
  v_readlane_b32 s57, v20, 48
  s_add_u32 s56, s56, s57
  s_cmp_lt_u32 s56, 256
  s_cbranch_scc1 Lwa_15
  s_lshr_b32 s58, s100, 2
  v_readlane_b32 s56, v20, s58
  s_add_u32 s58, s58, 32
  v_readlane_b32 s57, v20, s58
  s_add_u32 s56, s56, s57
  s_cmp_eq_u32 s58, 48
  s_cselect_b32 s56, 0, s56
  s_cmp_lt_u32 s56, 256
  s_cbranch_scc1 L_restart
  v_readlane_b32 s56, v20, 32
  s_cmp_ge_u32 s56, 128
  s_cbranch_scc1 Lwa_13
  s_branch Lwa_15
Lwa_14:
  v_readlane_b32 s56, v20, 0
  s_cmp_ge_u32 s56, 256
  s_cbranch_scc1 Lwa_13
Lwa_15:
  s_sleep 8
  s_add_u32 s55, s55, 1
  s_bitcmp1_b32 s55, 21
  s_cbranch_scc1 L_abort
  s_branch Lwa_12
Lwa_13:
  s_mov_b32 s56, 0
  s_cmp_eq_u32 s100, 0
  s_cbranch_scc1 Lwa_17
  v_readlane_b32 s56, v20, 1
  s_and_b32 s57, s56, 0xff
  s_cmp_lt_u32 s57, 32
  s_cbranch_scc1 Lwa_15
Lwa_17:
  s_cmp_gt_u32 s56, 0x10ff
  s_cselect_b32 s39, 8192, 0
  s_add_u32 s38, s38, s39
  s_add_u32 s67, s67, s39
  buffer_load_dword v20, off, s[4:7], s74 sc1
  buffer_load_dword v21, off, s[4:7], s74 offset:128 sc1
  s_mov_b32 s8, s30
  s_mov_b32 s9, s31
  s_mov_b32 s10, 0x800000
  s_mov_b32 s11, 0x20000
  s_xor_b32 s73, s51, 1
  s_lshl_b32 s73, s73, 2
  s_add_u32 s73, s73, s50
  s_lshl_b32 s73, s73, 20
  s_lshl_b32 s56, s65, 8
  s_add_u32 s73, s73, s56
  s_add_u32 s73, s73, 128
  s_lshl_b32 s56, s50, 15
  s_add_u32 s56, s56, 16384
  s_sub_u32 s57, s73, 65536
  s_mov_b32 s58, 4
Ldma_18:
  s_mov_b32 m0, s56
  s_add_u32 s57, s57, 65536
  buffer_load_dwordx4 v16, s[8:11], s57 offen nt lds
  s_add_u32 s56, s56, 1024
  s_mov_b32 m0, s56
  s_add_u32 s57, s57, 65536
  buffer_load_dwordx4 v16, s[8:11], s57 offen nt lds
  s_add_u32 s56, s56, 1024
  s_mov_b32 m0, s56
  s_add_u32 s57, s57, 65536
  buffer_load_dwordx4 v17, s[8:11], s57 offen nt lds
  s_add_u32 s56, s56, 1024
  s_mov_b32 m0, s56
  s_add_u32 s57, s57, 65536
  buffer_load_dwordx4 v17, s[8:11], s57 offen nt lds
  s_add_u32 s56, s56, 1024
  s_sub_u32 s58, s58, 1
  s_cmp_lg_u32 s58, 0
  s_cbranch_scc1 Ldma_18
  s_waitcnt vmcnt(16)
  s_barrier
  ds_read_b64_tr_b16 v[32:33], v8 offset:0
  ds_read_b64_tr_b16 v[34:35], v8 offset:512
  ds_read_b64_tr_b16 v[36:37], v8 offset:4096
  ds_read_b64_tr_b16 v[38:39], v8 offset:4608
  ds_read_b64_tr_b16 v[40:41], v8 offset:8192
  ds_read_b64_tr_b16 v[42:43], v8 offset:8704
  ds_read_b64_tr_b16 v[44:45], v8 offset:12288
  ds_read_b64_tr_b16 v[46:47], v8 offset:12800
  ds_read_b64_tr_b16 v[48:49], v9 offset:0
  ds_read_b64_tr_b16 v[50:51], v9 offset:512
  ds_read_b64_tr_b16 v[52:53], v9 offset:4096
  ds_read_b64_tr_b16 v[54:55], v9 offset:4608
  ds_read_b64_tr_b16 v[56:57], v9 offset:8192
  ds_read_b64_tr_b16 v[58:59], v9 offset:8704
  ds_read_b64_tr_b16 v[60:61], v9 offset:12288
  ds_read_b64_tr_b16 v[62:63], v9 offset:12800
  ds_read_b64_tr_b16 v[64:65], v10 offset:0
  ds_read_b64_tr_b16 v[66:67], v10 offset:512
  ds_read_b64_tr_b16 v[68:69], v10 offset:4096
  ds_read_b64_tr_b16 v[70:71], v10 offset:4608
  ds_read_b64_tr_b16 v[72:73], v10 offset:8192
  ds_read_b64_tr_b16 v[74:75], v10 offset:8704
  ds_read_b64_tr_b16 v[76:77], v10 offset:12288
  ds_read_b64_tr_b16 v[78:79], v10 offset:12800
  ds_read_b64_tr_b16 v[80:81], v11 offset:0
  ds_read_b64_tr_b16 v[82:83], v11 offset:512
  ds_read_b64_tr_b16 v[84:85], v11 offset:4096
  ds_read_b64_tr_b16 v[86:87], v11 offset:4608
  ds_read_b64_tr_b16 v[88:89], v11 offset:8192
  ds_read_b64_tr_b16 v[90:91], v11 offset:8704
  ds_read_b64_tr_b16 v[92:93], v11 offset:12288
  ds_read_b64_tr_b16 v[94:95], v11 offset:12800
  s_waitcnt lgkmcnt(0)
  s_barrier
  ds_write_b128 v120, v[32:35] offset:0
  ds_write_b128 v120, v[36:39] offset:1024
  ds_write_b128 v120, v[40:43] offset:8192
  ds_write_b128 v120, v[44:47] offset:9216
  ds_write_b128 v121, v[48:51] offset:0
  ds_write_b128 v121, v[52:55] offset:1024
  ds_write_b128 v121, v[56:59] offset:8192
  ds_write_b128 v121, v[60:63] offset:9216
  ds_write_b128 v122, v[64:67] offset:0
  ds_write_b128 v122, v[68:71] offset:1024
  ds_write_b128 v122, v[72:75] offset:8192
  ds_write_b128 v122, v[76:79] offset:9216
  ds_write_b128 v123, v[80:83] offset:0
  ds_write_b128 v123, v[84:87] offset:1024
  ds_write_b128 v123, v[88:91] offset:8192
  ds_write_b128 v123, v[92:95] offset:9216
  s_waitcnt lgkmcnt(0)
  s_barrier
  v_min_u32 v20, v20, v21
  s_nop 0
  v_readfirstlane_b32 s72, v20
  s_add_u32 s42, s54, 0
  s_min_u32 s42, s42, 63
Lq0_19:
  s_cmp_gt_u32 s72, s42
  s_cbranch_scc1 Lq0_20
  buffer_load_dword v56, off, s[4:7], s74 sc1
  buffer_load_dword v57, off, s[4:7], s74 offset:128 sc1
  s_waitcnt vmcnt(0)
  v_min_u32 v56, v56, v57
  s_nop 0
  v_readfirstlane_b32 s72, v56
  s_add_u32 s55, s55, 1
  s_bitcmp1_b32 s55, 21
  s_cbranch_scc1 L_abort
  s_branch Lq0_19
Lq0_20:
  s_lshl_b32 s42, s42, 2
  s_add_u32 s42, s42, s50
  s_lshl_b32 s42, s42, 11
  s_add_u32 s42, s42, s75
  s_mov_b32 m0, s40
  s_nop 0
  buffer_load_dwordx4 v1, s[4:7], s42 offen offset:0 sc1 lds
  buffer_load_dwordx4 v1, s[4:7], s42 offen offset:1024 sc1 lds
  s_add_u32 s46, s42, 0x80000
  buffer_load_dwordx4 v[112:115], v1, s[4:7], s46 offen offset:0 sc1
  buffer_load_dwordx4 v[116:119], v1, s[4:7], s46 offen offset:1024 sc1
  s_and_b32 s56, s65, 15
  s_lshl_b32 s56, s56, 2
  s_add_u32 s56, s56, s50
  v_and_b32 v20, 15, v0
  v_lshlrev_b32 v20, 7, v20
  v_lshl_add_u32 v21, s56, 11, v20
  v_bfe_u32 v22, v0, 4, 1
  v_lshl_add_u32 v21, v22, 18, v21
  s_lshl_b32 s57, s51, 17
  s_add_u32 s57, s57, 0xa0000
  buffer_load_dword v23, v21, s[4:7], s57 offen sc1
  v_and_b32 v20, 0x180, v20
  v_lshl_add_u32 v22, s56, 9, v20
  s_lshl_b32 s57, s51, 15
  s_add_u32 s57, s57, 0x90000
  buffer_load_dword v24, v22, s[4:7], s57 offen sc1
  s_waitcnt vmcnt(0)
  s_barrier
  ds_read_b64_tr_b16 v[32:33], v8 offset:16384
  ds_read_b64_tr_b16 v[34:35], v8 offset:16896
  ds_read_b64_tr_b16 v[36:37], v8 offset:20480
  ds_read_b64_tr_b16 v[38:39], v8 offset:20992
  ds_read_b64_tr_b16 v[40:41], v8 offset:24576
  ds_read_b64_tr_b16 v[42:43], v8 offset:25088
  ds_read_b64_tr_b16 v[44:45], v8 offset:28672
  ds_read_b64_tr_b16 v[46:47], v8 offset:29184
  ds_read_b64_tr_b16 v[48:49], v9 offset:16384
  ds_read_b64_tr_b16 v[50:51], v9 offset:16896
  ds_read_b64_tr_b16 v[52:53], v9 offset:20480
  ds_read_b64_tr_b16 v[54:55], v9 offset:20992
  ds_read_b64_tr_b16 v[56:57], v9 offset:24576
  ds_read_b64_tr_b16 v[58:59], v9 offset:25088
  ds_read_b64_tr_b16 v[60:61], v9 offset:28672
  ds_read_b64_tr_b16 v[62:63], v9 offset:29184
  ds_read_b64_tr_b16 v[64:65], v10 offset:16384
  ds_read_b64_tr_b16 v[66:67], v10 offset:16896
  ds_read_b64_tr_b16 v[68:69], v10 offset:20480
  ds_read_b64_tr_b16 v[70:71], v10 offset:20992
  ds_read_b64_tr_b16 v[72:73], v10 offset:24576
  ds_read_b64_tr_b16 v[74:75], v10 offset:25088
  ds_read_b64_tr_b16 v[76:77], v10 offset:28672
  ds_read_b64_tr_b16 v[78:79], v10 offset:29184
  ds_read_b64_tr_b16 v[80:81], v11 offset:16384
  ds_read_b64_tr_b16 v[82:83], v11 offset:16896
  ds_read_b64_tr_b16 v[84:85], v11 offset:20480
  ds_read_b64_tr_b16 v[86:87], v11 offset:20992
  ds_read_b64_tr_b16 v[88:89], v11 offset:24576
  ds_read_b64_tr_b16 v[90:91], v11 offset:25088
  ds_read_b64_tr_b16 v[92:93], v11 offset:28672
  ds_read_b64_tr_b16 v[94:95], v11 offset:29184
  s_waitcnt lgkmcnt(0)
  s_barrier
  ds_write_b128 v120, v[32:35] offset:16384
  ds_write_b128 v120, v[36:39] offset:17408
  ds_write_b128 v120, v[40:43] offset:24576
  ds_write_b128 v120, v[44:47] offset:25600
  ds_write_b128 v121, v[48:51] offset:16384
  ds_write_b128 v121, v[52:55] offset:17408
  ds_write_b128 v121, v[56:59] offset:24576
  ds_write_b128 v121, v[60:63] offset:25600
  ds_write_b128 v122, v[64:67] offset:16384
  ds_write_b128 v122, v[68:71] offset:17408
  ds_write_b128 v122, v[72:75] offset:24576
  ds_write_b128 v122, v[76:79] offset:25600
  ds_write_b128 v123, v[80:83] offset:16384
  ds_write_b128 v123, v[84:87] offset:17408
  ds_write_b128 v123, v[88:91] offset:24576
  ds_write_b128 v123, v[92:95] offset:25600
  v_mov_b32 v8, v120
  v_mov_b32 v9, v121
  v_mov_b32 v10, v122
  v_mov_b32 v11, v123
  s_waitcnt lgkmcnt(0)
  s_barrier
  s_mov_b32 s57, 0x05040100
  s_mov_b32 s58, 0x07060302
  v_perm_b32 v32, v98, v96, s57
  v_perm_b32 v33, v99, v97, s57
  v_perm_b32 v34, v98, v96, s58
  v_perm_b32 v35, v99, v97, s58
  v_min_u32 v32, -2, v32
  v_min_u32 v33, -2, v33
  v_min_u32 v34, -2, v34
  v_min_u32 v35, -2, v35
  ds_write_b128 v4, v[32:35] offset:0
  v_perm_b32 v36, v102, v100, s57
  v_perm_b32 v37, v103, v101, s57
  v_perm_b32 v38, v102, v100, s58
  v_perm_b32 v39, v103, v101, s58
  v_min_u32 v36, -2, v36
  v_min_u32 v37, -2, v37
  v_min_u32 v38, -2, v38
  v_min_u32 v39, -2, v39
  ds_write_b128 v4, v[36:39] offset:1024
  v_perm_b32 v40, v106, v104, s57
  v_perm_b32 v41, v107, v105, s57
  v_perm_b32 v42, v106, v104, s58
  v_perm_b32 v43, v107, v105, s58
  v_min_u32 v40, -2, v40
  v_min_u32 v41, -2, v41
  v_min_u32 v42, -2, v42
  v_min_u32 v43, -2, v43
  ds_write_b128 v4, v[40:43] offset:2048
  v_perm_b32 v44, v110, v108, s57
  v_perm_b32 v45, v111, v109, s57
  v_perm_b32 v46, v110, v108, s58
  v_perm_b32 v47, v111, v109, s58
  v_min_u32 v44, -2, v44
  v_min_u32 v45, -2, v45
  v_min_u32 v46, -2, v46
  v_min_u32 v47, -2, v47
  ds_write_b128 v4, v[44:47] offset:3072
  v_mov_b32 v16, 0
  v_mov_b32 v17, 0
  v_mov_b32 v18, 0
  v_mov_b32 v19, 0
  v_mov_b32 v20, 0
  v_mov_b32 v21, 0
  v_mov_b32 v22, 0
  v_mov_b32 v23, 0
  v_mov_b32 v24, 0
  v_mov_b32 v25, 0
  v_mov_b32 v26, 0
  v_mov_b32 v27, 0
  v_mov_b32 v28, 0
  v_mov_b32 v29, 0
  v_mov_b32 v30, 0
  v_mov_b32 v31, 0
  ds_read_b128 v[80:83], v8 offset:0
  ds_read_b128 v[84:87], v8 offset:1024
  ds_read_b128 v[88:91], v8 offset:8192
  ds_read_b128 v[92:95], v8 offset:9216
  ds_read_b128 v[96:99], v9 offset:0
  ds_read_b128 v[100:103], v9 offset:1024
  ds_read_b128 v[104:107], v9 offset:8192
  ds_read_b128 v[108:111], v9 offset:9216
  s_cmp_eq_u32 s50, 3
  s_cselect_b32 s39, 0, 0x80000000
  v_mov_b32 v127, 0x80000000
  v_writelane_b32 v127, 0, 0
  v_mov_b32 v120, -1
  v_mov_b32 v121, -1
  v_mov_b32 v122, -1
  v_mov_b32 v123, -1
  v_mov_b32 v124, -1
  v_mov_b32 v125, -1
  s_waitcnt vmcnt(0) lgkmcnt(0)
  s_barrier
  v_add_u32 v126, 159744, v1
  ds_read_b128 v[64:67], v126 offset:0
  ds_read_b128 v[68:71], v126 offset:1024
  ds_read_b128 v[72:75], v126 offset:2048
  ds_read_b128 v[76:79], v126 offset:3072
  s_add_u32 s42, s54, 1
  s_min_u32 s42, s42, 63
Lq0_21:
  s_cmp_gt_u32 s72, s42
  s_cbranch_scc1 Lq0_22
  buffer_load_dword v56, off, s[4:7], s74 sc1
  buffer_load_dword v57, off, s[4:7], s74 offset:128 sc1
  s_waitcnt vmcnt(0)
  v_min_u32 v56, v56, v57
  s_nop 0
  v_readfirstlane_b32 s72, v56
  s_add_u32 s55, s55, 1
  s_bitcmp1_b32 s55, 21
  s_cbranch_scc1 L_abort
  s_branch Lq0_21
Lq0_22:
  s_lshl_b32 s42, s42, 2
  s_add_u32 s42, s42, s50
  s_lshl_b32 s42, s42, 11
  s_add_u32 s42, s42, s75
  s_xor_b32 s40, s40, s41
  s_sub_u32 s43, s54, 1
  s_and_b32 s43, s43, 63
  s_lshl_b32 s43, s43, 11
  s_add_u32 s43, s43, s75
  s_add_u32 s44, s43, 0x120000
  s_add_u32 s43, s43, 0x100000
  s_and_b32 s45, s54, 3
  s_lshl_b32 s45, s45, 15
  s_add_u32 s45, s45, s69
  v_smfmac_f32_16x16x64_bf16 v[16:19], v[32:35], a[0:7], v3
  v_smfmac_f32_16x16x64_bf16 v[20:23], v[32:35], a[128:135], v3
  v_smfmac_f32_16x16x64_bf16 v[24:27], v[32:35], v[128:135], v3
  v_smfmac_f32_16x16x64_bf16 v[28:31], v[32:35], v[80:87], v3
  s_cmp_eq_u32 s100, 0
  s_cbranch_scc1 L_qk_e1
  s_branch L_qk_e0
L_qk_top0:
  s_waitcnt lgkmcnt(0)
  s_and_b32 s70, s54, 3
  s_lshl_b32 s70, s70, 13
  s_add_u32 s70, s70, s66
  s_and_b32 s73, s54, 3
  s_lshl_b32 s73, s73, 14
  s_add_u32 s73, s73, s67
  v_and_b32 v48, 15, v0
  v_lshlrev_b32 v48, 2, v48
  v_lshl_add_u32 v48, s50, 7, v48
  s_add_u32 s56, s54, 0
  buffer_load_dword v49, v48, s[4:7], s63 offen sc1
  buffer_load_dword v50, v48, s[4:7], s63 offen sc1
  buffer_load_dword v51, v48, s[4:7], s63 offen sc1
  buffer_load_dword v52, v48, s[4:7], s63 offen sc1
Lh_25:
  s_waitcnt vmcnt(3)
  v_cmp_gt_u32 vcc, s56, v49
  s_cbranch_vccz Lh_26
  buffer_load_dword v49, v48, s[4:7], s63 offen sc1
  s_nop 1
  s_waitcnt vmcnt(3)
  v_cmp_gt_u32 vcc, s56, v50
  s_cbranch_vccz Lh_26
  buffer_load_dword v50, v48, s[4:7], s63 offen sc1
  s_nop 1
  s_waitcnt vmcnt(3)
  v_cmp_gt_u32 vcc, s56, v51
  s_cbranch_vccz Lh_26
  buffer_load_dword v51, v48, s[4:7], s63 offen sc1
  s_nop 1
  s_waitcnt vmcnt(3)
  v_cmp_gt_u32 vcc, s56, v52
  s_cbranch_vccz Lh_26
  buffer_load_dword v52, v48, s[4:7], s63 offen sc1
  s_nop 1
  s_waitcnt vmcnt(3)
  v_cmp_gt_u32 vcc, s56, v49
  s_cbranch_vccz Lh_26
  buffer_load_dword v49, v48, s[4:7], s63 offen sc1
  s_nop 1
  s_waitcnt vmcnt(3)
  v_cmp_gt_u32 vcc, s56, v50
  s_cbranch_vccz Lh_26
  buffer_load_dword v50, v48, s[4:7], s63 offen sc1
  s_nop 1
  s_waitcnt vmcnt(3)
  v_cmp_gt_u32 vcc, s56, v51
  s_cbranch_vccz Lh_26
  buffer_load_dword v51, v48, s[4:7], s63 offen sc1
  s_nop 1
  s_waitcnt vmcnt(3)
  v_cmp_gt_u32 vcc, s56, v52
  s_cbranch_vccz Lh_26
  buffer_load_dword v52, v48, s[4:7], s63 offen sc1
  s_nop 1
  s_waitcnt vmcnt(3)
  v_cmp_gt_u32 vcc, s56, v49
  s_cbranch_vccz Lh_26
  buffer_load_dword v49, v48, s[4:7], s63 offen sc1
  s_nop 1
  s_waitcnt vmcnt(3)
  v_cmp_gt_u32 vcc, s56, v50
  s_cbranch_vccz Lh_26
  buffer_load_dword v50, v48, s[4:7], s63 offen sc1
  s_nop 1
  s_waitcnt vmcnt(3)
  v_cmp_gt_u32 vcc, s56, v51
  s_cbranch_vccz Lh_26
  buffer_load_dword v51, v48, s[4:7], s63 offen sc1
  s_nop 1
  s_waitcnt vmcnt(3)
  v_cmp_gt_u32 vcc, s56, v52
  s_cbranch_vccz Lh_26
  buffer_load_dword v52, v48, s[4:7], s63 offen sc1
  s_add_u32 s55, s55, 1
  s_bitcmp1_b32 s55, 21
  s_cbranch_scc1 L_abort
  s_branch Lh_25
.p2align 6
  s_nop 0
  s_nop 0
  s_nop 0
  s_nop 0
  s_nop 0
Lh_26:
  s_barrier
  buffer_load_dwordx4 v[32:35], v1, s[4:7], s70 offen offset:0 sc1
  v_add_u32 v126, 159744, v1
  ds_read_b128 v[64:67], v126 offset:0
  ds_read_b128 v[68:71], v126 offset:1024
  ds_read_b128 v[72:75], v126 offset:2048
  ds_read_b128 v[76:79], v126 offset:3072
  buffer_load_dwordx4 v[36:39], v1, s[4:7], s70 offen offset:1024 sc1
  v_min_u32 v58, v58, v59
  s_nop 0
  v_readfirstlane_b32 s72, v58
  s_waitcnt vmcnt(1)
Lm_27:
  v_max3_u32 v126, v32, v33, v34
  v_max_u32 v126, v126, v35
  v_cmp_eq_u32 vcc, -1, v126
  ds_write_b128 v4, v[32:35] offset:0
  s_cbranch_vccnz Lm_29
  v_smfmac_f32_16x16x64_bf16 v[16:19], v[32:35], a[0:7], v3
  s_waitcnt vmcnt(0)
  ds_write_b128 v4, v[36:39] offset:1024
  v_max3_u32 v126, v36, v37, v38
  v_smfmac_f32_16x16x64_bf16 v[20:23], v[32:35], a[128:135], v3
  v_max_u32 v126, v126, v39
  v_cmp_eq_u32 vcc, -1, v126
  v_smfmac_f32_16x16x64_bf16 v[24:27], v[32:35], v[128:135], v3
  buffer_load_dwordx4 v1, s[4:7], s73 offen offset:0 sc1 lds
  v_smfmac_f32_16x16x64_bf16 v[28:31], v[32:35], v[80:87], v3
  buffer_load_dwordx4 v1, s[4:7], s73 offen offset:1024 sc1 lds
  s_cbranch_vccnz Lm_30
Lm_28:
L_qk_e0:
  v_smfmac_f32_16x16x64_bf16 v[16:19], v[36:39], a[8:15], v3
  s_waitcnt lgkmcnt(0)
  s_barrier
  ds_read_b128 v[56:59], v5 offset:0
  v_smfmac_f32_16x16x64_bf16 v[20:23], v[36:39], a[136:143], v3
  ds_read_b128 v[60:63], v5 offset:1024
  s_mov_b32 m0, s40
  v_smfmac_f32_16x16x64_bf16 v[24:27], v[36:39], v[136:143], v3
  ds_read_b128 v[80:83], v10 offset:0
  v_smfmac_f32_16x16x64_bf16 v[28:31], v[36:39], v[88:95], v3
  ds_read_b128 v[84:87], v10 offset:1024
  ds_read_b128 v[48:51], v6 offset:0
  s_waitcnt lgkmcnt(4)
  v_smfmac_f32_16x16x64_bf16 v[16:19], v[56:59], a[32:39], v3
  ds_read_b128 v[52:55], v6 offset:1024
  v_smfmac_f32_16x16x64_bf16 v[20:23], v[56:59], a[160:167], v3
  ds_read_b128 v[88:91], v10 offset:8192
  v_smfmac_f32_16x16x64_bf16 v[24:27], v[56:59], v[160:167], v3
  ds_read_b128 v[92:95], v10 offset:9216
  s_waitcnt lgkmcnt(6)
  v_smfmac_f32_16x16x64_bf16 v[28:31], v[56:59], v[96:103], v3
  buffer_load_dwordx4 v1, s[4:7], s42 offen offset:0 sc1 lds
  v_smfmac_f32_16x16x64_bf16 v[16:19], v[60:63], a[40:47], v3
  ds_read_b128 v[56:59], v7 offset:0
  v_smfmac_f32_16x16x64_bf16 v[20:23], v[60:63], a[168:175], v3
  ds_read_b128 v[96:99], v11 offset:0
  v_smfmac_f32_16x16x64_bf16 v[24:27], v[60:63], v[168:175], v3
  ds_read_b128 v[100:103], v11 offset:1024
  s_waitcnt lgkmcnt(6)
  v_smfmac_f32_16x16x64_bf16 v[28:31], v[60:63], v[104:111], v3
  buffer_load_dwordx4 v1, s[4:7], s42 offen offset:1024 sc1 lds
  v_smfmac_f32_16x16x64_bf16 v[16:19], v[48:51], a[64:71], v3
  ds_read_b128 v[60:63], v7 offset:1024
  v_smfmac_f32_16x16x64_bf16 v[20:23], v[48:51], a[192:199], v3
  ds_read_b128 v[104:107], v11 offset:8192
  v_smfmac_f32_16x16x64_bf16 v[24:27], v[48:51], v[192:199], v3
  ds_read_b128 v[108:111], v11 offset:9216
  s_waitcnt lgkmcnt(6)
  v_smfmac_f32_16x16x64_bf16 v[28:31], v[48:51], v[80:87], v3
  buffer_store_dwordx4 v[122:125], v14, s[4:7], s43 offen sc1
  v_smfmac_f32_16x16x64_bf16 v[16:19], v[52:55], a[72:79], v3
  buffer_store_dwordx2 v[120:121], v15, s[4:7], s44 offen sc1
  v_smfmac_f32_16x16x64_bf16 v[20:23], v[52:55], a[200:207], v3
  ds_read_b128 v[80:83], v8 offset:16384
  v_smfmac_f32_16x16x64_bf16 v[24:27], v[52:55], v[200:207], v3
  ds_read_b128 v[84:87], v8 offset:17408
  s_waitcnt lgkmcnt(5)
  v_smfmac_f32_16x16x64_bf16 v[28:31], v[52:55], v[88:95], v3
  s_waitcnt vmcnt(5)
  ds_read_b128 v[40:43], v4 offset:2048
  v_smfmac_f32_16x16x64_bf16 v[16:19], v[56:59], a[96:103], v3
  s_waitcnt vmcnt(4)
  ds_read_b128 v[44:47], v4 offset:3072
  v_smfmac_f32_16x16x64_bf16 v[20:23], v[56:59], a[224:231], v3
  ds_read_b128 v[88:91], v8 offset:24576
  v_smfmac_f32_16x16x64_bf16 v[24:27], v[56:59], v[224:231], v3
  ds_read_b128 v[92:95], v8 offset:25600
  v_smfmac_f32_16x16x64_bf16 v[28:31], v[56:59], v[96:103], v3
  s_waitcnt lgkmcnt(3)
  v_max_u32 v126, v40, v41
  v_max3_u32 v126, v126, v42, v43
  v_smfmac_f32_16x16x64_bf16 v[16:19], v[60:63], a[104:111], v3
  s_waitcnt lgkmcnt(2)
  v_max3_u32 v126, v126, v44, v45
  v_max3_u32 v126, v126, v46, v47
  v_smfmac_f32_16x16x64_bf16 v[20:23], v[60:63], a[232:239], v3
  ds_read_b128 v[96:99], v9 offset:16384
  v_cmp_eq_u32 vcc, -1, v126
  v_smfmac_f32_16x16x64_bf16 v[24:27], v[60:63], v[232:239], v3
  ds_read_b128 v[100:103], v9 offset:17408
  v_smfmac_f32_16x16x64_bf16 v[28:31], v[60:63], v[104:111], v3
  s_cbranch_vccnz Lr_24
Lr_23:
  v_smfmac_f32_16x16x64_bf16 v[16:19], v[40:43], a[16:23], v3
  s_barrier
  ds_read_b128 v[56:59], v5 offset:2048
  v_smfmac_f32_16x16x64_bf16 v[20:23], v[40:43], a[144:151], v3
  ds_read_b128 v[104:107], v9 offset:24576
  v_smfmac_f32_16x16x64_bf16 v[28:31], v[40:43], v[80:87], v3
  ds_read_b128 v[108:111], v9 offset:25600
  s_waitcnt lgkmcnt(5)
  v_smfmac_f32_16x16x64_bf16 v[16:19], v[44:47], a[24:31], v3
  ds_read_b128 v[60:63], v5 offset:3072
  v_smfmac_f32_16x16x64_bf16 v[20:23], v[44:47], a[152:159], v3
  ds_read_b128 v[80:83], v10 offset:16384
  v_smfmac_f32_16x16x64_bf16 v[28:31], v[44:47], v[88:95], v3
  ds_read_b128 v[84:87], v10 offset:17408
  s_waitcnt lgkmcnt(5)
  v_smfmac_f32_16x16x64_bf16 v[16:19], v[56:59], a[48:55], v3
  ds_read_b128 v[48:51], v6 offset:2048
  v_smfmac_f32_16x16x64_bf16 v[20:23], v[56:59], a[176:183], v3
  ds_read_b128 v[88:91], v10 offset:24576
  v_smfmac_f32_16x16x64_bf16 v[24:27], v[56:59], v[176:183], v3
  ds_read_b128 v[92:95], v10 offset:25600
  v_smfmac_f32_16x16x64_bf16 v[28:31], v[56:59], v[96:103], v3
  ds_read_b128 v[52:55], v6 offset:3072
  s_waitcnt lgkmcnt(6)
  v_smfmac_f32_16x16x64_bf16 v[16:19], v[60:63], a[56:63], v3
  ds_read_b128 v[56:59], v7 offset:2048
  v_smfmac_f32_16x16x64_bf16 v[20:23], v[60:63], a[184:191], v3
  ds_read_b128 v[96:99], v11 offset:16384
  v_smfmac_f32_16x16x64_bf16 v[24:27], v[60:63], v[184:191], v3
  ds_read_b128 v[100:103], v11 offset:17408
  v_smfmac_f32_16x16x64_bf16 v[28:31], v[60:63], v[104:111], v3
  s_waitcnt lgkmcnt(3)
  v_smfmac_f32_16x16x64_bf16 v[16:19], v[48:51], a[80:87], v3
  ds_read_b128 v[60:63], v7 offset:3072
  v_smfmac_f32_16x16x64_bf16 v[16:19], v[52:55], a[88:95], v3
  ds_read_b128 v[104:107], v11 offset:24576
  v_smfmac_f32_16x16x64_bf16 v[20:23], v[48:51], a[208:215], v3
  ds_read_b128 v[108:111], v11 offset:25600
  s_waitcnt lgkmcnt(5)
  v_smfmac_f32_16x16x64_bf16 v[16:19], v[56:59], a[112:119], v3
  ds_read_b128 v[32:35], v2 offset:0
  v_smfmac_f32_16x16x64_bf16 v[20:23], v[52:55], a[216:223], v3
  ds_read_b128 v[36:39], v2 offset:1024
  s_waitcnt lgkmcnt(4)
  v_smfmac_f32_16x16x64_bf16 v[16:19], v[60:63], a[120:127], v3
  s_and_b32 s71, s54, 3
  s_lshl_b32 s71, s71, 15
  s_add_u32 s71, s71, s68
  v_smfmac_f32_16x16x64_bf16 v[20:23], v[56:59], a[240:247], v3
  s_and_b32 s77, s54, 3
  s_lshl_b32 s77, s77, 16
  s_add_u32 s77, s77, s38
  v_smfmac_f32_16x16x64_bf16 v[20:23], v[60:63], a[248:255], v3
  s_nop 1
  v_add_f32 v16, v16, v17
  v_smfmac_f32_16x16x64_bf16 v[24:27], v[40:43], v[144:151], v3
  s_add_u32 s56, s54, 1
  s_cmp_eq_u32 s54, 63
  v_add_f32 v18, v18, v19
  v_smfmac_f32_16x16x64_bf16 v[24:27], v[44:47], v[152:159], v3
  v_add_f32 v20, v20, v21
  v_add_f32 v22, v22, v23
  v_smfmac_f32_16x16x64_bf16 v[28:31], v[48:51], v[80:87], v3
  v_cvt_pk_bf16_f32 v16, v16, v20
  v_cvt_pk_bf16_f32 v18, v18, v22
  v_smfmac_f32_16x16x64_bf16 v[28:31], v[52:55], v[88:95], v3
  ds_write2_b32 v12, v16, v18 offset0:0 offset1:32
  v_smfmac_f32_16x16x64_bf16 v[28:31], v[56:59], v[96:103], v3
  ds_read_b128 v[40:43], v2 offset:2048
  s_waitcnt lgkmcnt(4)
  v_smfmac_f32_16x16x64_bf16 v[28:31], v[60:63], v[104:111], v3
  ds_read_b128 v[44:47], v2 offset:3072
  v_mov_b32 v125, s56
  v_smfmac_f32_16x16x64_bf16 v[24:27], v[48:51], v[208:215], v3
  s_nop 0
  v_smfmac_f32_16x16x64_bf16 v[24:27], v[52:55], v[216:223], v3
  s_waitcnt lgkmcnt(2)
  s_barrier
  ds_read_b128 v[80:83], v13 offset:0
  v_add_f32 v28, v28, v29
  v_smfmac_f32_16x16x64_bf16 v[24:27], v[56:59], v[240:247], v3
  ds_read_b128 v[84:87], v13 offset:1024
  v_add_f32 v30, v30, v31
  v_smfmac_f32_16x16x64_bf16 v[24:27], v[60:63], v[248:255], v3
  ds_read_b128 v[88:91], v13 offset:2048
  s_waitcnt lgkmcnt(2)
  v_mfma_f32_16x16x32_bf16 v[48:51], v[32:35], v[80:83], 0
  ds_read_b128 v[92:95], v13 offset:3072
  s_waitcnt lgkmcnt(2)
  v_mfma_f32_16x16x32_bf16 v[52:55], v[64:67], v[80:83], 0
  s_nop 1
  v_add_f32 v24, v24, v25
  v_add_f32 v26, v26, v27
  v_cvt_pk_bf16_f32 v24, v24, v28
  v_cvt_pk_bf16_f32 v26, v26, v30
  v_mfma_f32_16x16x32_bf16 v[48:51], v[36:39], v[84:87], v[48:51]
  ds_write2_b32 v12, v24, v26 offset0:128 offset1:160
  v_mfma_f32_16x16x32_bf16 v[52:55], v[68:71], v[84:87], v[52:55]
  s_waitcnt lgkmcnt(2)
  v_mov_b32 v32, 0x3f803f80
  v_mov_b32 v33, 0x3f803f80
  v_mfma_f32_16x16x32_bf16 v[48:51], v[40:43], v[88:91], v[48:51]
  v_mov_b32 v34, 0x3f803f80
  v_mov_b32 v35, 0x3f803f80
  v_mfma_f32_16x16x32_bf16 v[52:55], v[72:75], v[88:91], v[52:55]
  s_waitcnt lgkmcnt(1)
  v_cndmask_b32 v36, 0, v32, s[60:61]
  v_mfma_f32_16x16x32_bf16 v[48:51], v[44:47], v[92:95], v[48:51]
  s_waitcnt lgkmcnt(0)
  s_barrier
  ds_read_b128 v[96:99], v13 offset:512
  v_mfma_f32_16x16x32_bf16 v[52:55], v[76:79], v[92:95], v[52:55]
  ds_read_b128 v[100:103], v13 offset:1536
  ds_read_b128 v[104:107], v13 offset:2560
  ds_read_b128 v[108:111], v13 offset:3584
  v_cndmask_b32 v37, 0, v32, s[60:61]
  v_max3_f32 v60, v48, v49, v50
  s_waitcnt lgkmcnt(3)
  v_mfma_f32_16x16x32_bf16 v[56:59], v[96:99], v[80:83], 0
  s_waitcnt lgkmcnt(2)
  v_max3_f32 v60, v60, v51, v52
  v_max3_f32 v60, v60, v53, v54
  v_mfma_f32_16x16x32_bf16 v[56:59], v[100:103], v[84:87], v[56:59]
  s_waitcnt lgkmcnt(1)
  v_max_f32 v62, v60, v55
  v_max_f32 v60, v60, v55
  v_mfma_f32_16x16x32_bf16 v[56:59], v[104:107], v[88:91], v[56:59]
  s_waitcnt lgkmcnt(0)
  s_cbranch_scc1 Lql_31
  v_mfma_f32_16x16x32_bf16 v[56:59], v[108:111], v[92:95], v[56:59]
  buffer_load_dwordx2 v[120:121], v15, s[4:7], s45 offen sc1
  v_permlane32_swap_b32 v60, v62
  v_max_f32 v60, v60, v62
  v_pk_mul_f32 v[48:49], v[48:49], s[64:65] op_sel_hi:[1,0]
  v_pk_mul_f32 v[50:51], v[50:51], s[64:65] op_sel_hi:[1,0]
  v_pk_mul_f32 v[52:53], v[52:53], s[64:65] op_sel_hi:[1,0]
  v_pk_mul_f32 v[54:55], v[54:55], s[64:65] op_sel_hi:[1,0]
  s_nop 0
  v_max3_f32 v60, v60, v56, v57
  v_max3_f32 v62, v60, v58, v59
  v_max3_f32 v60, v60, v58, v59
  v_pk_mul_f32 v[56:57], v[56:57], s[64:65] op_sel_hi:[1,0]
  v_pk_mul_f32 v[58:59], v[58:59], s[64:65] op_sel_hi:[1,0]
  v_permlane16_swap_b32 v60, v62
  v_max_f32 v60, v60, v62
  v_mul_f32 v60, s64, v60
  v_pk_add_f32 v[48:49], v[48:49], v[60:61] op_sel_hi:[1,0] neg_lo:[0,1] neg_hi:[0,1]
  v_pk_add_f32 v[50:51], v[50:51], v[60:61] op_sel_hi:[1,0] neg_lo:[0,1] neg_hi:[0,1]
  v_pk_add_f32 v[52:53], v[52:53], v[60:61] op_sel_hi:[1,0] neg_lo:[0,1] neg_hi:[0,1]
  v_pk_add_f32 v[54:55], v[54:55], v[60:61] op_sel_hi:[1,0] neg_lo:[0,1] neg_hi:[0,1]
  v_pk_add_f32 v[56:57], v[56:57], v[60:61] op_sel_hi:[1,0] neg_lo:[0,1] neg_hi:[0,1]
  v_pk_add_f32 v[58:59], v[58:59], v[60:61] op_sel_hi:[1,0] neg_lo:[0,1] neg_hi:[0,1]
  v_exp_f32 v48, v48
  v_exp_f32 v49, v49
  v_exp_f32 v50, v50
  v_exp_f32 v51, v51
  v_exp_f32 v52, v52
  v_exp_f32 v53, v53
  v_exp_f32 v54, v54
  v_exp_f32 v55, v55
  v_cvt_pk_bf16_f32 v24, v48, v49
  v_cvt_pk_bf16_f32 v25, v50, v51
  v_cvt_pk_bf16_f32 v26, v52, v53
  v_cvt_pk_bf16_f32 v27, v54, v55
  v_exp_f32 v56, v56
  v_exp_f32 v57, v57
  v_mfma_f32_16x16x32_bf16 v[40:43], v[32:35], v[24:27], 0
  buffer_store_dword v125, v127, s[4:7], s62 offen
  v_exp_f32 v58, v58
  v_mfma_f32_16x16x32_bf16 v[16:19], v[112:115], v[24:27], 0
  v_exp_f32 v59, v59
  s_waitcnt vmcnt(1)
  v_max_u32 v126, v120, v121
  v_cmp_eq_u32 vcc, -1, v126
  v_cvt_pk_bf16_f32 v28, v56, v57
  v_cvt_pk_bf16_f32 v29, v58, v59
  v_mfma_f32_16x16x32_bf16 v[20:23], v[116:119], v[24:27], 0
  s_cbranch_vccnz Lv_33
Lv_32:
  v_cndmask_b32 v122, 0, v120, s[60:61]
  v_cndmask_b32 v123, 0, v121, s[60:61]
  v_mfma_f32_16x16x16_bf16 v[40:43], v[36:37], v[28:29], v[40:43]
  v_cndmask_b32 v124, v120, 0, s[60:61]
  v_cndmask_b32 v125, v121, 0, s[60:61]
  v_mfma_f32_16x16x16_bf16 v[16:19], v[122:123], v[28:29], v[16:19]
  s_nop 2
  v_mfma_f32_16x16x16_bf16 v[20:23], v[124:125], v[28:29], v[20:23]
  s_nop 0
  v_rcp_f32 v40, v40
  s_nop 1
  v_pk_mul_f32 v[16:17], v[16:17], v[40:41] op_sel_hi:[1,0]
  v_pk_mul_f32 v[18:19], v[18:19], v[40:41] op_sel_hi:[1,0]
  v_cvt_pk_bf16_f32 v24, v16, v17
  v_cvt_pk_bf16_f32 v25, v18, v19
  v_pk_mul_f32 v[20:21], v[20:21], v[40:41] op_sel_hi:[1,0]
  v_pk_mul_f32 v[22:23], v[22:23], v[40:41] op_sel_hi:[1,0]
  v_cvt_pk_bf16_f32 v26, v20, v21
  v_cvt_pk_bf16_f32 v27, v22, v23
  buffer_store_dwordx4 v[24:27], v14, s[4:7], s71 offen
  s_barrier
  buffer_store_dwordx4 v[24:27], v14, s[4:7], s77 offen sc1
  s_xor_b32 s77, s77, 0x40000
  s_add_u32 s46, s42, 0x80000
  s_cmp_lt_u32 s54, 56
  s_cbranch_scc1 Lp_34
  v_lshl_add_u32 v126, s50, 10, v13
  ds_read_b128 v[48:51], v126 offset:512
  s_lshl_b32 s70, s54, 11
  s_add_u32 s70, s70, s75
  s_add_u32 s71, s70, 0x120000
  s_add_u32 s70, s70, 0x100000
  buffer_store_dwordx2 v[120:121], v15, s[4:7], s71 offen sc1
  s_waitcnt lgkmcnt(0)
  buffer_store_dwordx4 v[48:51], v14, s[4:7], s70 offen sc1
Lp_34:
  v_mov_b32 v16, 0
  v_mov_b32 v17, 0
  v_mov_b32 v18, 0
  v_mov_b32 v19, 0
  v_mov_b32 v20, 0
  v_mov_b32 v21, 0
  v_mov_b32 v22, 0
  v_mov_b32 v23, 0
  v_mov_b32 v24, 0
  v_mov_b32 v25, 0
  v_mov_b32 v26, 0
  v_mov_b32 v27, 0
  v_mov_b32 v28, 0
  v_mov_b32 v29, 0
  v_mov_b32 v30, 0
  v_mov_b32 v31, 0
  v_lshl_add_u32 v126, s50, 10, v13
  ds_read_b128 v[122:125], v126 offset:512
  ds_read_b128 v[80:83], v8 offset:0
  ds_read_b128 v[84:87], v8 offset:1024
  ds_read_b128 v[88:91], v8 offset:8192
  ds_read_b128 v[92:95], v8 offset:9216
  ds_read_b128 v[96:99], v9 offset:0
  ds_read_b128 v[100:103], v9 offset:1024
  ds_read_b128 v[104:107], v9 offset:8192
  ds_read_b128 v[108:111], v9 offset:9216
  buffer_load_dwordx2 v[60:61], v15, s[4:7], s77 offen sc1
  s_cmp_ge_u32 s54, 56
  s_cbranch_scc1 Lp_35
  s_waitcnt vmcnt(1)
Lp_35:
  buffer_load_dwordx4 v[112:115], v1, s[4:7], s46 offen offset:0 sc1
  buffer_load_dwordx4 v[116:119], v1, s[4:7], s46 offen offset:1024 sc1
  v_xor_b32 v2, 0x3000, v2
  s_mov_b32 s56, s54
  s_cmp_lt_u32 s54, 56
  s_cbranch_scc1 Lp_36
  s_add_u32 s56, s56, 1
  s_waitcnt vmcnt(3)
  s_barrier
Lp_36:
  v_or_b32 v57, s39, v127
  v_mov_b32 v56, s56
  buffer_store_dword v56, v57, s[4:7], s37 offen sc1
  v_mov_b32 v58, s72
  v_mov_b32 v59, s72
  s_add_u32 s56, s54, 5
  s_min_u32 s56, s56, 64
  s_cmp_ge_u32 s72, s56
  s_cbranch_scc1 Lf_37
  buffer_load_dword v58, off, s[4:7], s74 sc1
  buffer_load_dword v59, off, s[4:7], s74 offset:128 sc1
Lf_37:
  s_add_u32 s42, s54, 2
  s_min_u32 s42, s42, 63
Lq0_38:
  s_cmp_gt_u32 s72, s42
  s_cbranch_scc1 Lq0_39
  buffer_load_dword v56, off, s[4:7], s74 sc1
  buffer_load_dword v57, off, s[4:7], s74 offset:128 sc1
  s_waitcnt vmcnt(0)
  v_min_u32 v56, v56, v57
  s_nop 0
  v_readfirstlane_b32 s72, v56
  s_add_u32 s55, s55, 1
  s_bitcmp1_b32 s55, 21
  s_cbranch_scc1 L_abort
  s_branch Lq0_38
Lq0_39:
  s_lshl_b32 s42, s42, 2
  s_add_u32 s42, s42, s50
  s_lshl_b32 s42, s42, 11
  s_add_u32 s42, s42, s75
  s_xor_b32 s40, s40, s41
  s_sub_u32 s43, s54, 0
  s_and_b32 s43, s43, 63
  s_lshl_b32 s43, s43, 11
  s_add_u32 s43, s43, s75
  s_add_u32 s44, s43, 0x120000
  s_add_u32 s43, s43, 0x100000
  s_add_u32 s45, s54, 1
  s_and_b32 s45, s45, 3
  s_lshl_b32 s45, s45, 15
  s_add_u32 s45, s45, s69
  s_lshl_b32 s56, s50, 12
  s_add_u32 m0, s56, 133120
  v_mov_b32 v52, -1
  v_mov_b32 v53, -1
  v_mov_b32 v54, -1
  v_mov_b32 v55, -1
  s_add_u32 s71, s54, 2
  s_and_b32 s71, s71, 3
  s_lshl_b32 s71, s71, 15
  s_add_u32 s71, s71, s68
  buffer_store_dwordx4 v[52:55], v14, s[4:7], s71 offen
  s_xor_b32 s71, s77, 0x20000
  buffer_store_dwordx4 v[52:55], v14, s[4:7], s71 offen sc1
  s_add_u32 s54, s54, 1
  s_branch L_qk_top0
Lm_29:
  buffer_load_dwordx4 v[32:35], v1, s[4:7], s70 offen offset:0 sc1
  buffer_load_dwordx4 v[36:39], v1, s[4:7], s70 offen offset:1024 sc1
  s_add_u32 s55, s55, 1
  s_bitcmp1_b32 s55, 21
  s_cbranch_scc1 L_abort
  s_waitcnt vmcnt(0)
  s_branch Lm_27
Lm_30:
  buffer_load_dwordx4 v[36:39], v1, s[4:7], s70 offen offset:1024 sc1
  s_add_u32 s55, s55, 1
  s_bitcmp1_b32 s55, 21
  s_cbranch_scc1 L_abort
  s_waitcnt vmcnt(0)
  v_max3_u32 v126, v36, v37, v38
  v_max_u32 v126, v126, v39
  v_cmp_eq_u32 vcc, -1, v126
  s_cbranch_vccnz Lm_30
  ds_write_b128 v4, v[36:39] offset:1024
  s_branch Lm_28
Lr_24:
  s_lshl_b32 s56, s50, 12
  s_add_u32 m0, s56, 133120
  s_nop 0
  buffer_load_dwordx4 v1, s[4:7], s73 offen offset:0 sc1 lds
  buffer_load_dwordx4 v1, s[4:7], s73 offen offset:1024 sc1 lds
  s_add_u32 s55, s55, 1
  s_bitcmp1_b32 s55, 21
  s_cbranch_scc1 L_abort
  s_waitcnt vmcnt(0)
  ds_read_b128 v[40:43], v4 offset:2048
  ds_read_b128 v[44:47], v4 offset:3072
  s_waitcnt lgkmcnt(0)
  v_max3_u32 v126, v40, v41, v42
  v_max3_u32 v126, v126, v43, v44
  v_max3_u32 v126, v126, v45, v46
  v_max_u32 v126, v126, v47
  v_cmp_eq_u32 vcc, -1, v126
  s_cbranch_vccnz Lr_24
  s_branch Lr_23
Lv_33:
  s_add_u32 s55, s55, 1
  s_bitcmp1_b32 s55, 21
  s_cbranch_scc1 L_abort
  buffer_load_dwordx2 v[120:121], v15, s[4:7], s45 offen sc1
  s_waitcnt vmcnt(0)
  v_max_u32 v126, v120, v121
  v_cmp_eq_u32 vcc, -1, v126
  s_cbranch_vccnz Lv_33
  s_branch Lv_32
Lql_31:
  buffer_load_dwordx2 v[120:121], v15, s[4:7], s45 offen sc1
  s_waitcnt lgkmcnt(0)
  s_nop 7
Lv_40:
  s_waitcnt vmcnt(0)
  v_max_u32 v126, v120, v121
  v_cmp_eq_u32 vcc, -1, v126
  s_cbranch_vccz Lv_41
  s_add_u32 s55, s55, 1
  s_bitcmp1_b32 s55, 21
  s_cbranch_scc1 L_abort
  buffer_load_dwordx2 v[120:121], v15, s[4:7], s45 offen sc1
  s_branch Lv_40
Lv_41:
  v_lshl_add_u32 v126, s50, 10, v13
  ds_read_b128 v[48:51], v126 offset:512
  s_lshl_b32 s70, s54, 11
  s_add_u32 s70, s70, s75
  s_add_u32 s71, s70, 0x120000
  s_add_u32 s70, s70, 0x100000
  buffer_store_dwordx2 v[120:121], v15, s[4:7], s71 offen sc1
  s_waitcnt lgkmcnt(0)
  buffer_store_dwordx4 v[48:51], v14, s[4:7], s70 offen sc1
  s_branch L_end
L_qk_top1:
  s_waitcnt lgkmcnt(0)
  s_and_b32 s70, s54, 3
  s_lshl_b32 s70, s70, 13
  s_add_u32 s70, s70, s66
  s_and_b32 s73, s54, 3
  s_lshl_b32 s73, s73, 14
  s_add_u32 s73, s73, s67
  v_and_b32 v48, 15, v0
  v_lshlrev_b32 v48, 2, v48
  v_lshl_add_u32 v48, s50, 7, v48
  s_add_u32 s56, s54, 0
  buffer_load_dword v49, v48, s[4:7], s63 offen sc1
  buffer_load_dword v50, v48, s[4:7], s63 offen sc1
  buffer_load_dword v51, v48, s[4:7], s63 offen sc1
  buffer_load_dword v52, v48, s[4:7], s63 offen sc1
Lh_44:
  s_waitcnt vmcnt(3)
  v_cmp_gt_u32 vcc, s56, v49
  s_cbranch_vccz Lh_45
  buffer_load_dword v49, v48, s[4:7], s63 offen sc1
  s_nop 1
  s_waitcnt vmcnt(3)
  v_cmp_gt_u32 vcc, s56, v50
  s_cbranch_vccz Lh_45
  buffer_load_dword v50, v48, s[4:7], s63 offen sc1
  s_nop 1
  s_waitcnt vmcnt(3)
  v_cmp_gt_u32 vcc, s56, v51
  s_cbranch_vccz Lh_45
  buffer_load_dword v51, v48, s[4:7], s63 offen sc1
  s_nop 1
  s_waitcnt vmcnt(3)
  v_cmp_gt_u32 vcc, s56, v52
  s_cbranch_vccz Lh_45
  buffer_load_dword v52, v48, s[4:7], s63 offen sc1
  s_nop 1
  s_waitcnt vmcnt(3)
  v_cmp_gt_u32 vcc, s56, v49
  s_cbranch_vccz Lh_45
  buffer_load_dword v49, v48, s[4:7], s63 offen sc1
  s_nop 1
  s_waitcnt vmcnt(3)
  v_cmp_gt_u32 vcc, s56, v50
  s_cbranch_vccz Lh_45
  buffer_load_dword v50, v48, s[4:7], s63 offen sc1
  s_nop 1
  s_waitcnt vmcnt(3)
  v_cmp_gt_u32 vcc, s56, v51
  s_cbranch_vccz Lh_45
  buffer_load_dword v51, v48, s[4:7], s63 offen sc1
  s_nop 1
  s_waitcnt vmcnt(3)
  v_cmp_gt_u32 vcc, s56, v52
  s_cbranch_vccz Lh_45
  buffer_load_dword v52, v48, s[4:7], s63 offen sc1
  s_nop 1
  s_waitcnt vmcnt(3)
  v_cmp_gt_u32 vcc, s56, v49
  s_cbranch_vccz Lh_45
  buffer_load_dword v49, v48, s[4:7], s63 offen sc1
  s_nop 1
  s_waitcnt vmcnt(3)
  v_cmp_gt_u32 vcc, s56, v50
  s_cbranch_vccz Lh_45
  buffer_load_dword v50, v48, s[4:7], s63 offen sc1
  s_nop 1
  s_waitcnt vmcnt(3)
  v_cmp_gt_u32 vcc, s56, v51
  s_cbranch_vccz Lh_45
  buffer_load_dword v51, v48, s[4:7], s63 offen sc1
  s_nop 1
  s_waitcnt vmcnt(3)
  v_cmp_gt_u32 vcc, s56, v52
  s_cbranch_vccz Lh_45
  buffer_load_dword v52, v48, s[4:7], s63 offen sc1
  s_add_u32 s55, s55, 1
  s_bitcmp1_b32 s55, 21
  s_cbranch_scc1 L_abort
  s_branch Lh_44
.p2align 6
  s_nop 0
  s_nop 0
  s_nop 0
  s_nop 0
  s_nop 0
Lh_45:
  s_barrier
  buffer_load_dwordx4 v[32:35], v1, s[4:7], s70 offen offset:0 sc1
  v_add_u32 v126, 159744, v1
  ds_read_b128 v[64:67], v126 offset:0
  ds_read_b128 v[68:71], v126 offset:1024
  ds_read_b128 v[72:75], v126 offset:2048
  ds_read_b128 v[76:79], v126 offset:3072
  buffer_load_dwordx4 v[36:39], v1, s[4:7], s70 offen offset:1024 sc1
  v_min_u32 v58, v58, v59
  s_nop 0
  v_readfirstlane_b32 s72, v58
  s_waitcnt vmcnt(1)
Lm_46:
  v_max3_u32 v126, v32, v33, v34
  v_max_u32 v126, v126, v35
  v_cmp_eq_u32 vcc, -1, v126
  ds_write_b128 v4, v[32:35] offset:0
  s_cbranch_vccnz Lm_48
  v_smfmac_f32_16x16x64_bf16 v[16:19], v[32:35], a[0:7], v3
  s_waitcnt vmcnt(0)
  ds_write_b128 v4, v[36:39] offset:1024
  v_max3_u32 v126, v36, v37, v38
  v_smfmac_f32_16x16x64_bf16 v[20:23], v[32:35], a[128:135], v3
  v_max_u32 v126, v126, v39
  v_cmp_eq_u32 vcc, -1, v126
  v_smfmac_f32_16x16x64_bf16 v[24:27], v[32:35], v[128:135], v3
  buffer_load_dwordx4 v1, s[4:7], s73 offen offset:0 sc1 lds
  v_smfmac_f32_16x16x64_bf16 v[28:31], v[32:35], v[80:87], v3
  buffer_load_dwordx4 v1, s[4:7], s73 offen offset:1024 sc1 lds
  s_cbranch_vccnz Lm_49
Lm_47:
L_qk_e1:
  v_smfmac_f32_16x16x64_bf16 v[16:19], v[36:39], a[8:15], v3
  s_waitcnt lgkmcnt(0)
  s_barrier
  ds_read_b128 v[56:59], v5 offset:0
  v_smfmac_f32_16x16x64_bf16 v[20:23], v[36:39], a[136:143], v3
  ds_read_b128 v[60:63], v5 offset:1024
  s_mov_b32 m0, s40
  v_smfmac_f32_16x16x64_bf16 v[24:27], v[36:39], v[136:143], v3
  ds_read_b128 v[80:83], v10 offset:0
  v_smfmac_f32_16x16x64_bf16 v[28:31], v[36:39], v[88:95], v3
  ds_read_b128 v[84:87], v10 offset:1024
  ds_read_b128 v[48:51], v6 offset:0
  s_waitcnt lgkmcnt(4)
  v_smfmac_f32_16x16x64_bf16 v[16:19], v[56:59], a[32:39], v3
  ds_read_b128 v[52:55], v6 offset:1024
  v_smfmac_f32_16x16x64_bf16 v[20:23], v[56:59], a[160:167], v3
  ds_read_b128 v[88:91], v10 offset:8192
  v_smfmac_f32_16x16x64_bf16 v[24:27], v[56:59], v[160:167], v3
  ds_read_b128 v[92:95], v10 offset:9216
  s_waitcnt lgkmcnt(6)
  v_smfmac_f32_16x16x64_bf16 v[28:31], v[56:59], v[96:103], v3
  buffer_load_dwordx4 v1, s[4:7], s42 offen offset:0 sc1 lds
  v_smfmac_f32_16x16x64_bf16 v[16:19], v[60:63], a[40:47], v3
  ds_read_b128 v[56:59], v7 offset:0
  v_smfmac_f32_16x16x64_bf16 v[20:23], v[60:63], a[168:175], v3
  ds_read_b128 v[96:99], v11 offset:0
  v_smfmac_f32_16x16x64_bf16 v[24:27], v[60:63], v[168:175], v3
  ds_read_b128 v[100:103], v11 offset:1024
  s_waitcnt lgkmcnt(6)
  v_smfmac_f32_16x16x64_bf16 v[28:31], v[60:63], v[104:111], v3
  buffer_load_dwordx4 v1, s[4:7], s42 offen offset:1024 sc1 lds
  v_smfmac_f32_16x16x64_bf16 v[16:19], v[48:51], a[64:71], v3
  ds_read_b128 v[60:63], v7 offset:1024
  v_smfmac_f32_16x16x64_bf16 v[20:23], v[48:51], a[192:199], v3
  ds_read_b128 v[104:107], v11 offset:8192
  v_smfmac_f32_16x16x64_bf16 v[24:27], v[48:51], v[192:199], v3
  ds_read_b128 v[108:111], v11 offset:9216
  s_waitcnt lgkmcnt(6)
  v_smfmac_f32_16x16x64_bf16 v[28:31], v[48:51], v[80:87], v3
  buffer_store_dwordx4 v[122:125], v14, s[4:7], s43 offen sc1
  v_smfmac_f32_16x16x64_bf16 v[16:19], v[52:55], a[72:79], v3
  buffer_store_dwordx2 v[120:121], v15, s[4:7], s44 offen sc1
  v_smfmac_f32_16x16x64_bf16 v[20:23], v[52:55], a[200:207], v3
  ds_read_b128 v[80:83], v8 offset:16384
  v_smfmac_f32_16x16x64_bf16 v[24:27], v[52:55], v[200:207], v3
  ds_read_b128 v[84:87], v8 offset:17408
  s_waitcnt lgkmcnt(5)
  v_smfmac_f32_16x16x64_bf16 v[28:31], v[52:55], v[88:95], v3
  s_waitcnt vmcnt(5)
  ds_read_b128 v[40:43], v4 offset:2048
  v_smfmac_f32_16x16x64_bf16 v[16:19], v[56:59], a[96:103], v3
  s_waitcnt vmcnt(4)
  ds_read_b128 v[44:47], v4 offset:3072
  v_smfmac_f32_16x16x64_bf16 v[20:23], v[56:59], a[224:231], v3
  ds_read_b128 v[88:91], v8 offset:24576
  v_smfmac_f32_16x16x64_bf16 v[24:27], v[56:59], v[224:231], v3
  ds_read_b128 v[92:95], v8 offset:25600
  v_smfmac_f32_16x16x64_bf16 v[28:31], v[56:59], v[96:103], v3
  s_waitcnt lgkmcnt(3)
  v_max_u32 v126, v40, v41
  v_max3_u32 v126, v126, v42, v43
  v_smfmac_f32_16x16x64_bf16 v[16:19], v[60:63], a[104:111], v3
  s_waitcnt lgkmcnt(2)
  v_max3_u32 v126, v126, v44, v45
  v_max3_u32 v126, v126, v46, v47
  v_smfmac_f32_16x16x64_bf16 v[20:23], v[60:63], a[232:239], v3
  ds_read_b128 v[96:99], v9 offset:16384
  v_cmp_eq_u32 vcc, -1, v126
  v_smfmac_f32_16x16x64_bf16 v[24:27], v[60:63], v[232:239], v3
  ds_read_b128 v[100:103], v9 offset:17408
  v_smfmac_f32_16x16x64_bf16 v[28:31], v[60:63], v[104:111], v3
  s_cbranch_vccnz Lr_43
Lr_42:
  v_smfmac_f32_16x16x64_bf16 v[16:19], v[40:43], a[16:23], v3
  s_barrier
  ds_read_b128 v[56:59], v5 offset:2048
  v_smfmac_f32_16x16x64_bf16 v[20:23], v[40:43], a[144:151], v3
  ds_read_b128 v[104:107], v9 offset:24576
  v_smfmac_f32_16x16x64_bf16 v[28:31], v[40:43], v[80:87], v3
  ds_read_b128 v[108:111], v9 offset:25600
  s_waitcnt lgkmcnt(5)
  v_smfmac_f32_16x16x64_bf16 v[16:19], v[44:47], a[24:31], v3
  ds_read_b128 v[60:63], v5 offset:3072
  v_smfmac_f32_16x16x64_bf16 v[20:23], v[44:47], a[152:159], v3
  ds_read_b128 v[80:83], v10 offset:16384
  v_smfmac_f32_16x16x64_bf16 v[28:31], v[44:47], v[88:95], v3
  ds_read_b128 v[84:87], v10 offset:17408
  s_waitcnt lgkmcnt(5)
  v_smfmac_f32_16x16x64_bf16 v[16:19], v[56:59], a[48:55], v3
  ds_read_b128 v[48:51], v6 offset:2048
  v_smfmac_f32_16x16x64_bf16 v[20:23], v[56:59], a[176:183], v3
  ds_read_b128 v[88:91], v10 offset:24576
  v_smfmac_f32_16x16x64_bf16 v[24:27], v[56:59], v[176:183], v3
  ds_read_b128 v[92:95], v10 offset:25600
  v_smfmac_f32_16x16x64_bf16 v[28:31], v[56:59], v[96:103], v3
  ds_read_b128 v[52:55], v6 offset:3072
  s_waitcnt lgkmcnt(6)
  v_smfmac_f32_16x16x64_bf16 v[16:19], v[60:63], a[56:63], v3
  ds_read_b128 v[56:59], v7 offset:2048
  v_smfmac_f32_16x16x64_bf16 v[20:23], v[60:63], a[184:191], v3
  ds_read_b128 v[96:99], v11 offset:16384
  v_smfmac_f32_16x16x64_bf16 v[24:27], v[60:63], v[184:191], v3
  ds_read_b128 v[100:103], v11 offset:17408
  v_smfmac_f32_16x16x64_bf16 v[28:31], v[60:63], v[104:111], v3
  s_waitcnt lgkmcnt(3)
  v_smfmac_f32_16x16x64_bf16 v[16:19], v[48:51], a[80:87], v3
  ds_read_b128 v[60:63], v7 offset:3072
  v_smfmac_f32_16x16x64_bf16 v[16:19], v[52:55], a[88:95], v3
  ds_read_b128 v[104:107], v11 offset:24576
  v_smfmac_f32_16x16x64_bf16 v[20:23], v[48:51], a[208:215], v3
  ds_read_b128 v[108:111], v11 offset:25600
  s_waitcnt lgkmcnt(5)
  v_smfmac_f32_16x16x64_bf16 v[16:19], v[56:59], a[112:119], v3
  ds_read_b128 v[32:35], v2 offset:0
  v_smfmac_f32_16x16x64_bf16 v[20:23], v[52:55], a[216:223], v3
  ds_read_b128 v[36:39], v2 offset:1024
  s_waitcnt lgkmcnt(4)
  v_smfmac_f32_16x16x64_bf16 v[16:19], v[60:63], a[120:127], v3
  s_and_b32 s71, s54, 3
  s_lshl_b32 s71, s71, 15
  s_add_u32 s71, s71, s68
  v_smfmac_f32_16x16x64_bf16 v[20:23], v[56:59], a[240:247], v3
  s_and_b32 s77, s54, 3
  s_lshl_b32 s77, s77, 16
  s_add_u32 s77, s77, s38
  v_smfmac_f32_16x16x64_bf16 v[20:23], v[60:63], a[248:255], v3
  s_nop 1
  v_add_f32 v16, v16, v17
  v_smfmac_f32_16x16x64_bf16 v[24:27], v[40:43], v[144:151], v3
  s_add_u32 s56, s54, 1
  s_cmp_eq_u32 s54, 63
  v_add_f32 v18, v18, v19
  v_smfmac_f32_16x16x64_bf16 v[24:27], v[44:47], v[152:159], v3
  v_add_f32 v20, v20, v21
  v_add_f32 v22, v22, v23
  v_smfmac_f32_16x16x64_bf16 v[28:31], v[48:51], v[80:87], v3
  v_cvt_pk_bf16_f32 v16, v16, v20
  v_cvt_pk_bf16_f32 v18, v18, v22
  v_smfmac_f32_16x16x64_bf16 v[28:31], v[52:55], v[88:95], v3
  ds_write2_b32 v12, v16, v18 offset0:0 offset1:32
  v_smfmac_f32_16x16x64_bf16 v[28:31], v[56:59], v[96:103], v3
  ds_read_b128 v[40:43], v2 offset:2048
  s_waitcnt lgkmcnt(4)
  v_smfmac_f32_16x16x64_bf16 v[28:31], v[60:63], v[104:111], v3
  ds_read_b128 v[44:47], v2 offset:3072
  v_mov_b32 v125, s56
  v_smfmac_f32_16x16x64_bf16 v[24:27], v[48:51], v[208:215], v3
  s_nop 0
  v_smfmac_f32_16x16x64_bf16 v[24:27], v[52:55], v[216:223], v3
  s_waitcnt lgkmcnt(2)
  s_barrier
  ds_read_b128 v[80:83], v13 offset:0
  v_add_f32 v28, v28, v29
  v_smfmac_f32_16x16x64_bf16 v[24:27], v[56:59], v[240:247], v3
  ds_read_b128 v[84:87], v13 offset:1024
  v_add_f32 v30, v30, v31
  v_smfmac_f32_16x16x64_bf16 v[24:27], v[60:63], v[248:255], v3
  ds_read_b128 v[88:91], v13 offset:2048
  s_waitcnt lgkmcnt(2)
  v_mfma_f32_16x16x32_bf16 v[48:51], v[32:35], v[80:83], 0
  ds_read_b128 v[92:95], v13 offset:3072
  s_waitcnt lgkmcnt(2)
  v_mfma_f32_16x16x32_bf16 v[52:55], v[64:67], v[80:83], 0
  s_nop 1
  v_add_f32 v24, v24, v25
  v_add_f32 v26, v26, v27
  v_cvt_pk_bf16_f32 v24, v24, v28
  v_cvt_pk_bf16_f32 v26, v26, v30
  v_mfma_f32_16x16x32_bf16 v[48:51], v[36:39], v[84:87], v[48:51]
  ds_write2_b32 v12, v24, v26 offset0:128 offset1:160
  v_mfma_f32_16x16x32_bf16 v[52:55], v[68:71], v[84:87], v[52:55]
  s_waitcnt lgkmcnt(2)
  v_mov_b32 v32, 0x3f803f80
  v_mov_b32 v33, 0x3f803f80
  v_mfma_f32_16x16x32_bf16 v[48:51], v[40:43], v[88:91], v[48:51]
  v_mov_b32 v34, 0x3f803f80
  v_mov_b32 v35, 0x3f803f80
  v_mfma_f32_16x16x32_bf16 v[52:55], v[72:75], v[88:91], v[52:55]
  s_waitcnt lgkmcnt(1)
  v_cndmask_b32 v36, 0, v32, s[60:61]
  v_mfma_f32_16x16x32_bf16 v[48:51], v[44:47], v[92:95], v[48:51]
  s_waitcnt lgkmcnt(0)
  s_barrier
  ds_read_b128 v[96:99], v13 offset:512
  v_mfma_f32_16x16x32_bf16 v[52:55], v[76:79], v[92:95], v[52:55]
  ds_read_b128 v[100:103], v13 offset:1536
  ds_read_b128 v[104:107], v13 offset:2560
  ds_read_b128 v[108:111], v13 offset:3584
  v_cndmask_b32 v37, 0, v32, s[60:61]
  v_max3_f32 v60, v48, v49, v50
  s_waitcnt lgkmcnt(3)
  v_mfma_f32_16x16x32_bf16 v[56:59], v[96:99], v[80:83], 0
  s_waitcnt lgkmcnt(2)
  v_max3_f32 v60, v60, v51, v52
  v_max3_f32 v60, v60, v53, v54
  v_mfma_f32_16x16x32_bf16 v[56:59], v[100:103], v[84:87], v[56:59]
  s_waitcnt lgkmcnt(1)
  v_max_f32 v62, v60, v55
  v_max_f32 v60, v60, v55
  v_mfma_f32_16x16x32_bf16 v[56:59], v[104:107], v[88:91], v[56:59]
  s_waitcnt lgkmcnt(0)
  s_cbranch_scc1 Lql_50
  v_mfma_f32_16x16x32_bf16 v[56:59], v[108:111], v[92:95], v[56:59]
  buffer_load_dwordx2 v[120:121], v15, s[4:7], s45 offen sc1
  v_permlane32_swap_b32 v60, v62
  v_max_f32 v60, v60, v62
  v_pk_mul_f32 v[48:49], v[48:49], s[64:65] op_sel_hi:[1,0]
  v_pk_mul_f32 v[50:51], v[50:51], s[64:65] op_sel_hi:[1,0]
  v_pk_mul_f32 v[52:53], v[52:53], s[64:65] op_sel_hi:[1,0]
  v_pk_mul_f32 v[54:55], v[54:55], s[64:65] op_sel_hi:[1,0]
  s_nop 0
  v_max3_f32 v60, v60, v56, v57
  v_max3_f32 v62, v60, v58, v59
  v_max3_f32 v60, v60, v58, v59
  v_pk_mul_f32 v[56:57], v[56:57], s[64:65] op_sel_hi:[1,0]
  v_pk_mul_f32 v[58:59], v[58:59], s[64:65] op_sel_hi:[1,0]
  v_permlane16_swap_b32 v60, v62
  v_max_f32 v60, v60, v62
  v_mul_f32 v60, s64, v60
  v_pk_add_f32 v[48:49], v[48:49], v[60:61] op_sel_hi:[1,0] neg_lo:[0,1] neg_hi:[0,1]
  v_pk_add_f32 v[50:51], v[50:51], v[60:61] op_sel_hi:[1,0] neg_lo:[0,1] neg_hi:[0,1]
  v_pk_add_f32 v[52:53], v[52:53], v[60:61] op_sel_hi:[1,0] neg_lo:[0,1] neg_hi:[0,1]
  v_pk_add_f32 v[54:55], v[54:55], v[60:61] op_sel_hi:[1,0] neg_lo:[0,1] neg_hi:[0,1]
  v_pk_add_f32 v[56:57], v[56:57], v[60:61] op_sel_hi:[1,0] neg_lo:[0,1] neg_hi:[0,1]
  v_pk_add_f32 v[58:59], v[58:59], v[60:61] op_sel_hi:[1,0] neg_lo:[0,1] neg_hi:[0,1]
  v_exp_f32 v48, v48
  v_exp_f32 v49, v49
  v_exp_f32 v50, v50
  v_exp_f32 v51, v51
  v_exp_f32 v52, v52
  v_exp_f32 v53, v53
  v_exp_f32 v54, v54
  v_exp_f32 v55, v55
  v_cvt_pk_bf16_f32 v24, v48, v49
  v_cvt_pk_bf16_f32 v25, v50, v51
  v_cvt_pk_bf16_f32 v26, v52, v53
  v_cvt_pk_bf16_f32 v27, v54, v55
  v_exp_f32 v56, v56
  v_exp_f32 v57, v57
  v_mfma_f32_16x16x32_bf16 v[40:43], v[32:35], v[24:27], 0
  buffer_store_dword v125, v127, s[4:7], s62 offen sc1
  v_exp_f32 v58, v58
  v_mfma_f32_16x16x32_bf16 v[16:19], v[112:115], v[24:27], 0
  v_exp_f32 v59, v59
  s_waitcnt vmcnt(1)
  v_max_u32 v126, v120, v121
  v_cmp_eq_u32 vcc, -1, v126
  v_cvt_pk_bf16_f32 v28, v56, v57
  v_cvt_pk_bf16_f32 v29, v58, v59
  v_mfma_f32_16x16x32_bf16 v[20:23], v[116:119], v[24:27], 0
  s_cbranch_vccnz Lv_52
Lv_51:
  v_cndmask_b32 v122, 0, v120, s[60:61]
  v_cndmask_b32 v123, 0, v121, s[60:61]
  v_mfma_f32_16x16x16_bf16 v[40:43], v[36:37], v[28:29], v[40:43]
  v_cndmask_b32 v124, v120, 0, s[60:61]
  v_cndmask_b32 v125, v121, 0, s[60:61]
  v_mfma_f32_16x16x16_bf16 v[16:19], v[122:123], v[28:29], v[16:19]
  s_nop 2
  v_mfma_f32_16x16x16_bf16 v[20:23], v[124:125], v[28:29], v[20:23]
  s_nop 0
  v_rcp_f32 v40, v40
  s_nop 1
  v_pk_mul_f32 v[16:17], v[16:17], v[40:41] op_sel_hi:[1,0]
  v_pk_mul_f32 v[18:19], v[18:19], v[40:41] op_sel_hi:[1,0]
  v_cvt_pk_bf16_f32 v24, v16, v17
  v_cvt_pk_bf16_f32 v25, v18, v19
  v_pk_mul_f32 v[20:21], v[20:21], v[40:41] op_sel_hi:[1,0]
  v_pk_mul_f32 v[22:23], v[22:23], v[40:41] op_sel_hi:[1,0]
  v_cvt_pk_bf16_f32 v26, v20, v21
  v_cvt_pk_bf16_f32 v27, v22, v23
  buffer_store_dwordx4 v[24:27], v14, s[4:7], s71 offen sc1
  s_barrier
  buffer_store_dwordx4 v[24:27], v14, s[4:7], s77 offen sc1
  s_xor_b32 s77, s77, 0x40000
  s_add_u32 s46, s42, 0x80000
  s_cmp_lt_u32 s54, 56
  s_cbranch_scc1 Lp_53
  v_lshl_add_u32 v126, s50, 10, v13
  ds_read_b128 v[48:51], v126 offset:512
  s_lshl_b32 s70, s54, 11
  s_add_u32 s70, s70, s75
  s_add_u32 s71, s70, 0x120000
  s_add_u32 s70, s70, 0x100000
  buffer_store_dwordx2 v[120:121], v15, s[4:7], s71 offen sc1
  s_waitcnt lgkmcnt(0)
  buffer_store_dwordx4 v[48:51], v14, s[4:7], s70 offen sc1
Lp_53:
  v_mov_b32 v16, 0
  v_mov_b32 v17, 0
  v_mov_b32 v18, 0
  v_mov_b32 v19, 0
  v_mov_b32 v20, 0
  v_mov_b32 v21, 0
  v_mov_b32 v22, 0
  v_mov_b32 v23, 0
  v_mov_b32 v24, 0
  v_mov_b32 v25, 0
  v_mov_b32 v26, 0
  v_mov_b32 v27, 0
  v_mov_b32 v28, 0
  v_mov_b32 v29, 0
  v_mov_b32 v30, 0
  v_mov_b32 v31, 0
  v_lshl_add_u32 v126, s50, 10, v13
  ds_read_b128 v[122:125], v126 offset:512
  ds_read_b128 v[80:83], v8 offset:0
  ds_read_b128 v[84:87], v8 offset:1024
  ds_read_b128 v[88:91], v8 offset:8192
  ds_read_b128 v[92:95], v8 offset:9216
  ds_read_b128 v[96:99], v9 offset:0
  ds_read_b128 v[100:103], v9 offset:1024
  ds_read_b128 v[104:107], v9 offset:8192
  ds_read_b128 v[108:111], v9 offset:9216
  buffer_load_dwordx2 v[60:61], v15, s[4:7], s77 offen sc1
  s_cmp_ge_u32 s54, 56
  s_cbranch_scc1 Lp_54
  s_waitcnt vmcnt(1)
Lp_54:
  buffer_load_dwordx4 v[112:115], v1, s[4:7], s46 offen offset:0 sc1
  buffer_load_dwordx4 v[116:119], v1, s[4:7], s46 offen offset:1024 sc1
  v_xor_b32 v2, 0x3000, v2
  s_mov_b32 s56, s54
  s_cmp_lt_u32 s54, 56
  s_cbranch_scc1 Lp_55
  s_add_u32 s56, s56, 1
  s_waitcnt vmcnt(3)
  s_barrier
Lp_55:
  v_or_b32 v57, s39, v127
  v_mov_b32 v56, s56
  buffer_store_dword v56, v57, s[4:7], s37 offen sc1
  v_mov_b32 v58, s72
  v_mov_b32 v59, s72
  s_add_u32 s56, s54, 5
  s_min_u32 s56, s56, 64
  s_cmp_ge_u32 s72, s56
  s_cbranch_scc1 Lf_56
  buffer_load_dword v58, off, s[4:7], s74 sc1
  buffer_load_dword v59, off, s[4:7], s74 offset:128 sc1
Lf_56:
  s_add_u32 s42, s54, 2
  s_min_u32 s42, s42, 63
Lq0_57:
  s_cmp_gt_u32 s72, s42
  s_cbranch_scc1 Lq0_58
  buffer_load_dword v56, off, s[4:7], s74 sc1
  buffer_load_dword v57, off, s[4:7], s74 offset:128 sc1
  s_waitcnt vmcnt(0)
  v_min_u32 v56, v56, v57
  s_nop 0
  v_readfirstlane_b32 s72, v56
  s_add_u32 s55, s55, 1
  s_bitcmp1_b32 s55, 21
  s_cbranch_scc1 L_abort
  s_branch Lq0_57
Lq0_58:
  s_lshl_b32 s42, s42, 2
  s_add_u32 s42, s42, s50
  s_lshl_b32 s42, s42, 11
  s_add_u32 s42, s42, s75
  s_xor_b32 s40, s40, s41
  s_sub_u32 s43, s54, 0
  s_and_b32 s43, s43, 63
  s_lshl_b32 s43, s43, 11
  s_add_u32 s43, s43, s75
  s_add_u32 s44, s43, 0x120000
  s_add_u32 s43, s43, 0x100000
  s_add_u32 s45, s54, 1
  s_and_b32 s45, s45, 3
  s_lshl_b32 s45, s45, 15
  s_add_u32 s45, s45, s69
  s_lshl_b32 s56, s50, 12
  s_add_u32 m0, s56, 133120
  v_mov_b32 v52, -1
  v_mov_b32 v53, -1
  v_mov_b32 v54, -1
  v_mov_b32 v55, -1
  s_add_u32 s71, s54, 2
  s_and_b32 s71, s71, 3
  s_lshl_b32 s71, s71, 15
  s_add_u32 s71, s71, s68
  buffer_store_dwordx4 v[52:55], v14, s[4:7], s71 offen sc1
  s_xor_b32 s71, s77, 0x20000
  buffer_store_dwordx4 v[52:55], v14, s[4:7], s71 offen sc1
  s_add_u32 s54, s54, 1
  s_branch L_qk_top1
Lm_48:
  buffer_load_dwordx4 v[32:35], v1, s[4:7], s70 offen offset:0 sc1
  buffer_load_dwordx4 v[36:39], v1, s[4:7], s70 offen offset:1024 sc1
  s_add_u32 s55, s55, 1
  s_bitcmp1_b32 s55, 21
  s_cbranch_scc1 L_abort
  s_waitcnt vmcnt(0)
  s_branch Lm_46
Lm_49:
  buffer_load_dwordx4 v[36:39], v1, s[4:7], s70 offen offset:1024 sc1
  s_add_u32 s55, s55, 1
  s_bitcmp1_b32 s55, 21
  s_cbranch_scc1 L_abort
  s_waitcnt vmcnt(0)
  v_max3_u32 v126, v36, v37, v38
  v_max_u32 v126, v126, v39
  v_cmp_eq_u32 vcc, -1, v126
  s_cbranch_vccnz Lm_49
  ds_write_b128 v4, v[36:39] offset:1024
  s_branch Lm_47
Lr_43:
  s_lshl_b32 s56, s50, 12
  s_add_u32 m0, s56, 133120
  s_nop 0
  buffer_load_dwordx4 v1, s[4:7], s73 offen offset:0 sc1 lds
  buffer_load_dwordx4 v1, s[4:7], s73 offen offset:1024 sc1 lds
  s_add_u32 s55, s55, 1
  s_bitcmp1_b32 s55, 21
  s_cbranch_scc1 L_abort
  s_waitcnt vmcnt(0)
  ds_read_b128 v[40:43], v4 offset:2048
  ds_read_b128 v[44:47], v4 offset:3072
  s_waitcnt lgkmcnt(0)
  v_max3_u32 v126, v40, v41, v42
  v_max3_u32 v126, v126, v43, v44
  v_max3_u32 v126, v126, v45, v46
  v_max_u32 v126, v126, v47
  v_cmp_eq_u32 vcc, -1, v126
  s_cbranch_vccnz Lr_43
  s_branch Lr_42
Lv_52:
  s_add_u32 s55, s55, 1
  s_bitcmp1_b32 s55, 21
  s_cbranch_scc1 L_abort
  buffer_load_dwordx2 v[120:121], v15, s[4:7], s45 offen sc1
  s_waitcnt vmcnt(0)
  v_max_u32 v126, v120, v121
  v_cmp_eq_u32 vcc, -1, v126
  s_cbranch_vccnz Lv_52
  s_branch Lv_51
Lql_50:
  buffer_load_dwordx2 v[120:121], v15, s[4:7], s45 offen sc1
  s_waitcnt lgkmcnt(0)
  s_nop 7
Lv_59:
  s_waitcnt vmcnt(0)
  v_max_u32 v126, v120, v121
  v_cmp_eq_u32 vcc, -1, v126
  s_cbranch_vccz Lv_60
  s_add_u32 s55, s55, 1
  s_bitcmp1_b32 s55, 21
  s_cbranch_scc1 L_abort
  buffer_load_dwordx2 v[120:121], v15, s[4:7], s45 offen sc1
  s_branch Lv_59
Lv_60:
  v_lshl_add_u32 v126, s50, 10, v13
  ds_read_b128 v[48:51], v126 offset:512
  s_lshl_b32 s70, s54, 11
  s_add_u32 s70, s70, s75
  s_add_u32 s71, s70, 0x120000
  s_add_u32 s70, s70, 0x100000
  buffer_store_dwordx2 v[120:121], v15, s[4:7], s71 offen sc1
  s_waitcnt lgkmcnt(0)
  buffer_store_dwordx4 v[48:51], v14, s[4:7], s70 offen sc1
  s_branch L_end
L_vo:
  v_lshlrev_b32 v1, 4, v0
  s_mov_b32 s60, -1
  s_mov_b32 s61, 0
  s_mov_b32 s64, 0x3e0293ee
  s_and_b32 s65, s52, 15
  v_and_b32 v126, 1, v0
  v_cmp_ne_u32 vcc, 0, v126
  v_mov_b32 v3, 0x4444
  v_mov_b32 v127, 0xeeee
  v_cndmask_b32 v3, v3, v127, vcc
  s_xor_b32 s56, s50, 0
  s_lshl_b32 s56, s56, 12
  s_add_u32 s56, s56, 131072
  v_add_u32 v4, s56, v1
  s_xor_b32 s56, s50, 1
  s_lshl_b32 s56, s56, 12
  s_add_u32 s56, s56, 131072
  v_add_u32 v5, s56, v1
  s_xor_b32 s56, s50, 2
  s_lshl_b32 s56, s56, 12
  s_add_u32 s56, s56, 131072
  v_add_u32 v6, s56, v1
  s_xor_b32 s56, s50, 3
  s_lshl_b32 s56, s56, 12
  s_add_u32 s56, s56, 131072
  v_add_u32 v7, s56, v1
  v_bfe_u32 v126, v0, 2, 1
  v_lshlrev_b32 v126, 4, v126
  v_lshrrev_b32 v127, 5, v0
  v_lshl_add_u32 v126, v127, 3, v126
  v_bfe_u32 v127, v0, 3, 1
  v_lshl_add_u32 v126, v127, 1, v126
  v_bfe_u32 v8, v0, 4, 1
  v_add_u32 v126, v126, v8
  v_bfe_u32 v8, v0, 2, 1
  v_lshl_add_u32 v127, v8, 1, v127
  v_xor_b32 v127, s50, v127
  v_lshlrev_b32 v127, 5, v127
  v_lshl_add_u32 v126, v126, 7, v127
  v_and_b32 v127, 3, v0
  v_lshl_add_u32 v126, v127, 3, v126
  s_xor_b32 s56, s50, 0
  s_lshl_b32 s56, s56, 15
  v_add_u32 v8, s56, v126
  v_add_u32 v120, s56, v1
  v_lshl_add_u32 v120, s50, 11, v120
  s_xor_b32 s56, s50, 1
  s_lshl_b32 s56, s56, 15
  v_add_u32 v9, s56, v126
  v_add_u32 v121, s56, v1
  v_lshl_add_u32 v121, s50, 11, v121
  s_xor_b32 s56, s50, 2
  s_lshl_b32 s56, s56, 15
  v_add_u32 v10, s56, v126
  v_add_u32 v122, s56, v1
  v_lshl_add_u32 v122, s50, 11, v122
  s_xor_b32 s56, s50, 3
  s_lshl_b32 s56, s56, 15
  v_add_u32 v11, s56, v126
  v_add_u32 v123, s56, v1
  v_lshl_add_u32 v123, s50, 11, v123
  s_lshl_b32 s56, s50, 11
  s_lshl_b32 s66, s51, 15
  s_add_u32 s66, s66, s56
  s_add_u32 s66, s66, 0x90000
  s_xor_b32 s67, s51, 1
  s_lshl_b32 s67, s67, 16
  s_add_u32 s67, s67, s56
  s_add_u32 s67, s67, 0x280000
  s_lshl_b32 s69, s51, 17
  s_lshl_b32 s56, s65, 11
  s_add_u32 s69, s69, s56
  s_add_u32 s69, s69, 0xe0000
  s_lshl_b32 s3, s51, 10
  s_add_u32 s3, s3, 0x8000
  s_lshr_b32 s62, s52, 2
  s_lshl_b32 s62, s62, 7
  s_and_b32 s56, s52, 3
  s_lshl_b32 s56, s56, 2
  s_add_u32 s56, s56, s50
  s_lshl_b32 s56, s56, 2
  s_add_u32 s62, s62, s56
  s_add_u32 s62, s62, s3
  s_add_u32 s63, s3, 512
  s_lshl_b32 s37, s2, 7
  s_lshl_b32 s56, s51, 4
  s_add_u32 s65, s65, s56
  v_lshrrev_b32 v126, 5, v0
  v_lshlrev_b32 v126, 7, v126
  v_and_b32 v127, 15, v0
  v_lshl_add_u32 v126, v127, 3, v126
  v_bfe_u32 v127, v0, 4, 1
  v_lshl_add_u32 v126, v127, 2, v126
  s_lshl_b32 s56, s50, 8
  v_add_u32 v14, s56, v126
  s_lshl_b32 s56, s50, 7
  v_lshl_add_u32 v126, v0, 2, s56
  v_lshrrev_b32 v127, 5, v0
  v_lshl_or_b32 v15, v127, 31, v126
  v_lshrrev_b32 v126, 4, v0
  v_mul_u32_u24 v126, 384, v126
  v_and_b32 v127, 15, v0
  v_lshl_add_u32 v126, v127, 4, v126
  s_mul_i32 s56, s50, 1536
  s_add_u32 s56, s56, 147456
  v_add_u32 v12, s56, v126
  v_bfe_u32 v126, v0, 4, 1
  v_mul_u32_u24 v126, 384, v126
  v_and_b32 v127, 8, v0
  v_add_u32 v126, v126, v127
  v_bfe_u32 v127, v0, 1, 2
  v_lshl_add_u32 v126, v127, 4, v126
  v_and_b32 v127, 1, v0
  v_lshl_add_u32 v126, v127, 6, v126
  s_and_b32 s56, s50, 1
  s_mul_i32 s56, s56, 768
  s_lshr_b32 s57, s50, 1
  s_lshl_b32 s57, s57, 7
  s_add_u32 s56, s56, s57
  s_add_u32 s56, s56, 147456
  v_add_u32 v13, s56, v126
  s_lshl_b32 s68, s51, 17
  s_lshl_b32 s56, s50, 13
  s_add_u32 s68, s68, s56
  s_add_u32 s68, s68, 0xa0000
  s_xor_b32 s38, s51, 1
  s_lshl_b32 s38, s38, 18
  s_lshl_b32 s56, s50, 14
  s_add_u32 s38, s38, s56
  s_add_u32 s38, s38, 0x200000
  s_and_b32 s56, s65, 15
  s_lshl_b32 s56, s56, 9
  s_lshl_b32 s74, s51, 15
  s_add_u32 s74, s74, s56
  s_add_u32 s74, s74, 0x90000
  s_lshl_b32 s75, s51, 16
  s_add_u32 s75, s75, s56
  s_add_u32 s75, s75, 0x280000
  s_cmp_lg_u32 s50, 0
  s_cbranch_scc1 Lar_61
  s_cmp_eq_u32 s100, 0
  s_cbranch_scc0 Lar_61
  s_mov_b32 s56, 0
  v_mov_b32 v126, 1
  s_mov_b64 exec, 1
  buffer_atomic_add v126, off, s[20:23], s56 sc1
  s_mov_b64 exec, -1
Lar_61:
  v_lshrrev_b32 v126, 3, v0
  v_lshlrev_b32 v18, 13, v126
  v_and_b32 v126, 2, v126
  v_xor_b32 v126, v126, v0
  v_and_b32 v126, 7, v126
  v_lshlrev_b32 v126, 4, v126
  v_xor_b32 v19, 64, v126
  v_add_u32 v19, v19, v18
  v_add_u32 v18, v126, v18
  v_lshrrev_b32 v126, 2, v0
  v_and_b32 v127, 3, v0
  v_lshlrev_b32 v16, 11, v126
  v_lshl_add_u32 v16, v127, 4, v16
  v_and_b32 v126, 16, v0
  v_lshrrev_b32 v17, 5, v0
  v_lshl_add_u32 v126, v17, 3, v126
  v_bfe_u32 v17, v0, 3, 1
  v_lshl_add_u32 v126, v17, 2, v126
  v_bfe_u32 v17, v0, 2, 1
  v_add_u32 v126, v126, v17
  v_lshlrev_b32 v126, 6, v126
  v_lshl_add_u32 v126, v127, 3, v126
  s_lshl_b32 s56, s50, 15
  v_add_u32 v17, s56, v126
  s_mov_b32 s8, s34
  s_mov_b32 s9, s35
  s_mov_b32 s10, 0x800000
  s_mov_b32 s11, 0x20000
  s_xor_b32 s73, s51, 0
  s_lshl_b32 s73, s73, 2
  s_add_u32 s73, s73, s50
  s_lshl_b32 s73, s73, 20
  s_lshl_b32 s56, s65, 6
  s_add_u32 s73, s73, s56
  s_lshl_b32 s56, s50, 15
  s_add_u32 s56, s56, 0
  s_mov_b32 s58, 0
Ldn_62:
  s_and_b32 s59, s52, 1
  s_lshl_b32 s59, s59, 3
  s_xor_b32 s59, s59, s58
  s_lshl_b32 s57, s59, 10
  s_add_u32 m0, s56, s57
  s_lshl_b32 s57, s59, 15
  s_add_u32 s57, s57, s73
  buffer_load_dwordx4 v16, s[8:11], s57 offen lds
  s_add_u32 s58, s58, 1
  s_cmp_lg_u32 s58, 16
  s_cbranch_scc1 Ldn_62
  s_mov_b32 s8, s34
  s_mov_b32 s9, s35
  s_mov_b32 s10, 0x800000
  s_mov_b32 s11, 0x20000
  s_xor_b32 s73, s51, 0
  s_lshl_b32 s73, s73, 2
  s_add_u32 s73, s73, s50
  s_lshl_b32 s73, s73, 20
  s_lshl_b32 s56, s65, 6
  s_add_u32 s73, s73, s56
  s_add_u32 s73, s73, 524288
  s_lshl_b32 s56, s50, 15
  s_add_u32 s56, s56, 16384
  s_mov_b32 s58, 0
Ldn_63:
  s_and_b32 s59, s52, 1
  s_lshl_b32 s59, s59, 3
  s_xor_b32 s59, s59, s58
  s_lshl_b32 s57, s59, 10
  s_add_u32 m0, s56, s57
  s_lshl_b32 s57, s59, 15
  s_add_u32 s57, s57, s73
  buffer_load_dwordx4 v16, s[8:11], s57 offen lds
  s_add_u32 s58, s58, 1
  s_cmp_lg_u32 s58, 16
  s_cbranch_scc1 Ldn_63
  s_waitcnt vmcnt(16)
  s_barrier
  ds_read_b64_tr_b16 a[0:1], v17 offset:0
  ds_read_b64_tr_b16 a[2:3], v17 offset:128
  ds_read_b64_tr_b16 a[4:5], v17 offset:2048
  ds_read_b64_tr_b16 a[6:7], v17 offset:2176
  ds_read_b64_tr_b16 a[8:9], v17 offset:32
  ds_read_b64_tr_b16 a[10:11], v17 offset:160
  ds_read_b64_tr_b16 a[12:13], v17 offset:2080
  ds_read_b64_tr_b16 a[14:15], v17 offset:2208
  ds_read_b64_tr_b16 a[16:17], v17 offset:4096
  ds_read_b64_tr_b16 a[18:19], v17 offset:4224
  ds_read_b64_tr_b16 a[20:21], v17 offset:6144
  ds_read_b64_tr_b16 a[22:23], v17 offset:6272
  ds_read_b64_tr_b16 a[24:25], v17 offset:4128
  ds_read_b64_tr_b16 a[26:27], v17 offset:4256
  ds_read_b64_tr_b16 a[28:29], v17 offset:6176
  ds_read_b64_tr_b16 a[30:31], v17 offset:6304
  ds_read_b64_tr_b16 a[32:33], v17 offset:8192
  ds_read_b64_tr_b16 a[34:35], v17 offset:8320
  ds_read_b64_tr_b16 a[36:37], v17 offset:10240
  ds_read_b64_tr_b16 a[38:39], v17 offset:10368
  ds_read_b64_tr_b16 a[40:41], v17 offset:8224
  ds_read_b64_tr_b16 a[42:43], v17 offset:8352
  ds_read_b64_tr_b16 a[44:45], v17 offset:10272
  ds_read_b64_tr_b16 a[46:47], v17 offset:10400
  ds_read_b64_tr_b16 a[48:49], v17 offset:12288
  ds_read_b64_tr_b16 a[50:51], v17 offset:12416
  ds_read_b64_tr_b16 a[52:53], v17 offset:14336
  ds_read_b64_tr_b16 a[54:55], v17 offset:14464
  ds_read_b64_tr_b16 a[56:57], v17 offset:12320
  ds_read_b64_tr_b16 a[58:59], v17 offset:12448
  ds_read_b64_tr_b16 a[60:61], v17 offset:14368
  ds_read_b64_tr_b16 a[62:63], v17 offset:14496
  s_waitcnt lgkmcnt(0)
  s_barrier
  s_mov_b32 s8, s34
  s_mov_b32 s9, s35
  s_mov_b32 s10, 0x800000
  s_mov_b32 s11, 0x20000
  s_xor_b32 s73, s51, 1
  s_lshl_b32 s73, s73, 2
  s_add_u32 s73, s73, s50
  s_lshl_b32 s73, s73, 20
  s_lshl_b32 s56, s65, 6
  s_add_u32 s73, s73, s56
  s_lshl_b32 s56, s50, 15
  s_add_u32 s56, s56, 0
  s_mov_b32 s58, 0
Ldn_64:
  s_and_b32 s59, s52, 1
  s_lshl_b32 s59, s59, 3
  s_xor_b32 s59, s59, s58
  s_lshl_b32 s57, s59, 10
  s_add_u32 m0, s56, s57
  s_lshl_b32 s57, s59, 15
  s_add_u32 s57, s57, s73
  buffer_load_dwordx4 v16, s[8:11], s57 offen lds
  s_add_u32 s58, s58, 1
  s_cmp_lg_u32 s58, 16
  s_cbranch_scc1 Ldn_64
  s_waitcnt vmcnt(16)
  s_barrier
  ds_read_b64_tr_b16 a[64:65], v17 offset:16384
  ds_read_b64_tr_b16 a[66:67], v17 offset:16512
  ds_read_b64_tr_b16 a[68:69], v17 offset:18432
  ds_read_b64_tr_b16 a[70:71], v17 offset:18560
  ds_read_b64_tr_b16 a[72:73], v17 offset:16416
  ds_read_b64_tr_b16 a[74:75], v17 offset:16544
  ds_read_b64_tr_b16 a[76:77], v17 offset:18464
  ds_read_b64_tr_b16 a[78:79], v17 offset:18592
  ds_read_b64_tr_b16 a[80:81], v17 offset:20480
  ds_read_b64_tr_b16 a[82:83], v17 offset:20608
  ds_read_b64_tr_b16 a[84:85], v17 offset:22528
  ds_read_b64_tr_b16 a[86:87], v17 offset:22656
  ds_read_b64_tr_b16 a[88:89], v17 offset:20512
  ds_read_b64_tr_b16 a[90:91], v17 offset:20640
  ds_read_b64_tr_b16 a[92:93], v17 offset:22560
  ds_read_b64_tr_b16 a[94:95], v17 offset:22688
  ds_read_b64_tr_b16 a[96:97], v17 offset:24576
  ds_read_b64_tr_b16 a[98:99], v17 offset:24704
  ds_read_b64_tr_b16 a[100:101], v17 offset:26624
  ds_read_b64_tr_b16 a[102:103], v17 offset:26752
  ds_read_b64_tr_b16 a[104:105], v17 offset:24608
  ds_read_b64_tr_b16 a[106:107], v17 offset:24736
  ds_read_b64_tr_b16 a[108:109], v17 offset:26656
  ds_read_b64_tr_b16 a[110:111], v17 offset:26784
  ds_read_b64_tr_b16 a[112:113], v17 offset:28672
  ds_read_b64_tr_b16 a[114:115], v17 offset:28800
  ds_read_b64_tr_b16 a[116:117], v17 offset:30720
  ds_read_b64_tr_b16 a[118:119], v17 offset:30848
  ds_read_b64_tr_b16 a[120:121], v17 offset:28704
  ds_read_b64_tr_b16 a[122:123], v17 offset:28832
  ds_read_b64_tr_b16 a[124:125], v17 offset:30752
  ds_read_b64_tr_b16 a[126:127], v17 offset:30880
  s_waitcnt lgkmcnt(0)
  s_barrier
  s_mov_b32 s12, s26
  s_mov_b32 s13, s27
  s_mov_b32 s14, 0x4000
  s_mov_b32 s15, 0x20000
  s_lshl_b32 s56, s50, 12
  s_add_u32 m0, s56, 131072
  s_nop 0
  buffer_load_dwordx4 v1, s[12:15], s56 offen offset:0 lds
  buffer_load_dwordx4 v1, s[12:15], s56 offen offset:1024 lds
  buffer_load_dwordx4 v1, s[12:15], s56 offen offset:2048 lds
  buffer_load_dwordx4 v1, s[12:15], s56 offen offset:3072 lds
  s_mov_b32 s8, s34
  s_mov_b32 s9, s35
  s_mov_b32 s10, 0x800000
  s_mov_b32 s11, 0x20000
  s_xor_b32 s73, s51, 1
  s_lshl_b32 s73, s73, 2
  s_add_u32 s73, s73, s50
  s_lshl_b32 s73, s73, 20
  s_lshl_b32 s56, s65, 6
  s_add_u32 s73, s73, s56
  s_add_u32 s73, s73, 524288
  s_lshl_b32 s56, s50, 15
  s_add_u32 s56, s56, 16384
  s_mov_b32 s58, 0
Ldn_65:
  s_and_b32 s59, s52, 1
  s_lshl_b32 s59, s59, 3
  s_xor_b32 s59, s59, s58
  s_lshl_b32 s57, s59, 10
  s_add_u32 m0, s56, s57
  s_lshl_b32 s57, s59, 15
  s_add_u32 s57, s57, s73
  buffer_load_dwordx4 v16, s[8:11], s57 offen lds
  s_add_u32 s58, s58, 1
  s_cmp_lg_u32 s58, 16
  s_cbranch_scc1 Ldn_65
  s_waitcnt vmcnt(16)
  s_barrier
  ds_read_b64_tr_b16 a[128:129], v17 offset:0
  ds_read_b64_tr_b16 a[130:131], v17 offset:128
  ds_read_b64_tr_b16 a[132:133], v17 offset:2048
  ds_read_b64_tr_b16 a[134:135], v17 offset:2176
  ds_read_b64_tr_b16 a[136:137], v17 offset:32
  ds_read_b64_tr_b16 a[138:139], v17 offset:160
  ds_read_b64_tr_b16 a[140:141], v17 offset:2080
  ds_read_b64_tr_b16 a[142:143], v17 offset:2208
  ds_read_b64_tr_b16 a[144:145], v17 offset:4096
  ds_read_b64_tr_b16 a[146:147], v17 offset:4224
  ds_read_b64_tr_b16 a[148:149], v17 offset:6144
  ds_read_b64_tr_b16 a[150:151], v17 offset:6272
  ds_read_b64_tr_b16 a[152:153], v17 offset:4128
  ds_read_b64_tr_b16 a[154:155], v17 offset:4256
  ds_read_b64_tr_b16 a[156:157], v17 offset:6176
  ds_read_b64_tr_b16 a[158:159], v17 offset:6304
  ds_read_b64_tr_b16 a[160:161], v17 offset:8192
  ds_read_b64_tr_b16 a[162:163], v17 offset:8320
  ds_read_b64_tr_b16 a[164:165], v17 offset:10240
  ds_read_b64_tr_b16 a[166:167], v17 offset:10368
  ds_read_b64_tr_b16 a[168:169], v17 offset:8224
  ds_read_b64_tr_b16 a[170:171], v17 offset:8352
  ds_read_b64_tr_b16 a[172:173], v17 offset:10272
  ds_read_b64_tr_b16 a[174:175], v17 offset:10400
  ds_read_b64_tr_b16 a[176:177], v17 offset:12288
  ds_read_b64_tr_b16 a[178:179], v17 offset:12416
  ds_read_b64_tr_b16 a[180:181], v17 offset:14336
  ds_read_b64_tr_b16 a[182:183], v17 offset:14464
  ds_read_b64_tr_b16 a[184:185], v17 offset:12320
  ds_read_b64_tr_b16 a[186:187], v17 offset:12448
  ds_read_b64_tr_b16 a[188:189], v17 offset:14368
  ds_read_b64_tr_b16 a[190:191], v17 offset:14496
  s_waitcnt lgkmcnt(0)
  s_barrier
  s_mov_b32 s8, s32
  s_mov_b32 s9, s33
  s_mov_b32 s10, 0x800000
  s_mov_b32 s11, 0x20000
  s_xor_b32 s73, s51, 0
  s_lshl_b32 s73, s73, 2
  s_add_u32 s73, s73, s50
  s_lshl_b32 s73, s73, 20
  s_lshl_b32 s56, s65, 8
  s_add_u32 s73, s73, s56
  s_lshl_b32 s56, s50, 15
  s_add_u32 s56, s56, 0
  s_sub_u32 s57, s73, 65536
  s_mov_b32 s58, 4
Ldma_66:
  s_mov_b32 m0, s56
  s_add_u32 s57, s57, 65536
  buffer_load_dwordx4 v18, s[8:11], s57 offen lds
  s_add_u32 s56, s56, 1024
  s_mov_b32 m0, s56
  s_add_u32 s57, s57, 65536
  buffer_load_dwordx4 v18, s[8:11], s57 offen lds
  s_add_u32 s56, s56, 1024
  s_mov_b32 m0, s56
  s_add_u32 s57, s57, 65536
  buffer_load_dwordx4 v19, s[8:11], s57 offen lds
  s_add_u32 s56, s56, 1024
  s_mov_b32 m0, s56
  s_add_u32 s57, s57, 65536
  buffer_load_dwordx4 v19, s[8:11], s57 offen lds
  s_add_u32 s56, s56, 1024
  s_sub_u32 s58, s58, 1
  s_cmp_lg_u32 s58, 0
  s_cbranch_scc1 Ldma_66
  s_waitcnt vmcnt(16)
  s_barrier
  ds_read_b64_tr_b16 a[192:193], v17 offset:16384
  ds_read_b64_tr_b16 a[194:195], v17 offset:16512
  ds_read_b64_tr_b16 a[196:197], v17 offset:18432
  ds_read_b64_tr_b16 a[198:199], v17 offset:18560
  ds_read_b64_tr_b16 a[200:201], v17 offset:16416
  ds_read_b64_tr_b16 a[202:203], v17 offset:16544
  ds_read_b64_tr_b16 a[204:205], v17 offset:18464
  ds_read_b64_tr_b16 a[206:207], v17 offset:18592
  ds_read_b64_tr_b16 a[208:209], v17 offset:20480
  ds_read_b64_tr_b16 a[210:211], v17 offset:20608
  ds_read_b64_tr_b16 a[212:213], v17 offset:22528
  ds_read_b64_tr_b16 a[214:215], v17 offset:22656
  ds_read_b64_tr_b16 a[216:217], v17 offset:20512
  ds_read_b64_tr_b16 a[218:219], v17 offset:20640
  ds_read_b64_tr_b16 a[220:221], v17 offset:22560
  ds_read_b64_tr_b16 a[222:223], v17 offset:22688
  ds_read_b64_tr_b16 a[224:225], v17 offset:24576
  ds_read_b64_tr_b16 a[226:227], v17 offset:24704
  ds_read_b64_tr_b16 a[228:229], v17 offset:26624
  ds_read_b64_tr_b16 a[230:231], v17 offset:26752
  ds_read_b64_tr_b16 a[232:233], v17 offset:24608
  ds_read_b64_tr_b16 a[234:235], v17 offset:24736
  ds_read_b64_tr_b16 a[236:237], v17 offset:26656
  ds_read_b64_tr_b16 a[238:239], v17 offset:26784
  ds_read_b64_tr_b16 a[240:241], v17 offset:28672
  ds_read_b64_tr_b16 a[242:243], v17 offset:28800
  ds_read_b64_tr_b16 a[244:245], v17 offset:30720
  ds_read_b64_tr_b16 a[246:247], v17 offset:30848
  ds_read_b64_tr_b16 a[248:249], v17 offset:28704
  ds_read_b64_tr_b16 a[250:251], v17 offset:28832
  ds_read_b64_tr_b16 a[252:253], v17 offset:30752
  ds_read_b64_tr_b16 a[254:255], v17 offset:30880
  s_waitcnt lgkmcnt(0)
  s_barrier
  v_bfe_u32 v126, v0, 1, 3
  v_lshlrev_b32 v126, 11, v126
  v_lshrrev_b32 v127, 5, v0
  v_lshl_add_u32 v126, v127, 6, v126
  v_and_b32 v127, 16, v0
  v_add_u32 v126, v126, v127
  v_and_b32 v127, 1, v0
  v_lshl_add_u32 v126, v127, 2, v126
  s_lshl_b32 s56, s51, 2
  s_add_u32 s56, s56, s50
  s_lshl_b32 s56, s56, 8
  s_add_u32 s56, s56, 131072
  v_add_u32 v126, s56, v126
  v_xor_b32 v127, 1024, v126
  ds_read_b32 v96, v126 offset:0
  ds_read_b32 v97, v126 offset:8
  ds_read_b32 v98, v126 offset:32
  ds_read_b32 v99, v126 offset:40
  ds_read_b32 v100, v126 offset:128
  ds_read_b32 v101, v126 offset:136
  ds_read_b32 v102, v126 offset:160
  ds_read_b32 v103, v126 offset:168
  ds_read_b32 v104, v127 offset:0
  ds_read_b32 v105, v127 offset:8
  ds_read_b32 v106, v127 offset:32
  ds_read_b32 v107, v127 offset:40
  ds_read_b32 v108, v127 offset:128
  ds_read_b32 v109, v127 offset:136
  ds_read_b32 v110, v127 offset:160
  ds_read_b32 v111, v127 offset:168
  s_mov_b32 s8, s32
  s_mov_b32 s9, s33
  s_mov_b32 s10, 0x800000
  s_mov_b32 s11, 0x20000
  s_xor_b32 s73, s51, 1
  s_lshl_b32 s73, s73, 2
  s_add_u32 s73, s73, s50
  s_lshl_b32 s73, s73, 20
  s_lshl_b32 s56, s65, 8
  s_add_u32 s73, s73, s56
  s_lshl_b32 s56, s50, 15
  s_add_u32 s56, s56, 16384
  s_sub_u32 s57, s73, 65536
  s_mov_b32 s58, 4
Ldma_67:
  s_mov_b32 m0, s56
  s_add_u32 s57, s57, 65536
  buffer_load_dwordx4 v18, s[8:11], s57 offen lds
  s_add_u32 s56, s56, 1024
  s_mov_b32 m0, s56
  s_add_u32 s57, s57, 65536
  buffer_load_dwordx4 v18, s[8:11], s57 offen lds
  s_add_u32 s56, s56, 1024
  s_mov_b32 m0, s56
  s_add_u32 s57, s57, 65536
  buffer_load_dwordx4 v19, s[8:11], s57 offen lds
  s_add_u32 s56, s56, 1024
  s_mov_b32 m0, s56
  s_add_u32 s57, s57, 65536
  buffer_load_dwordx4 v19, s[8:11], s57 offen lds
  s_add_u32 s56, s56, 1024
  s_sub_u32 s58, s58, 1
  s_cmp_lg_u32 s58, 0
  s_cbranch_scc1 Ldma_67
  s_waitcnt vmcnt(16)
  s_barrier
  ds_read_b64_tr_b16 v[128:129], v8 offset:0
  ds_read_b64_tr_b16 v[130:131], v8 offset:512
  ds_read_b64_tr_b16 v[132:133], v8 offset:4096
  ds_read_b64_tr_b16 v[134:135], v8 offset:4608
  ds_read_b64_tr_b16 v[136:137], v8 offset:8192
  ds_read_b64_tr_b16 v[138:139], v8 offset:8704
  ds_read_b64_tr_b16 v[140:141], v8 offset:12288
  ds_read_b64_tr_b16 v[142:143], v8 offset:12800
  ds_read_b64_tr_b16 v[160:161], v9 offset:0
  ds_read_b64_tr_b16 v[162:163], v9 offset:512
  ds_read_b64_tr_b16 v[164:165], v9 offset:4096
  ds_read_b64_tr_b16 v[166:167], v9 offset:4608
  ds_read_b64_tr_b16 v[168:169], v9 offset:8192
  ds_read_b64_tr_b16 v[170:171], v9 offset:8704
  ds_read_b64_tr_b16 v[172:173], v9 offset:12288
  ds_read_b64_tr_b16 v[174:175], v9 offset:12800
  ds_read_b64_tr_b16 v[192:193], v10 offset:0
  ds_read_b64_tr_b16 v[194:195], v10 offset:512
  ds_read_b64_tr_b16 v[196:197], v10 offset:4096
  ds_read_b64_tr_b16 v[198:199], v10 offset:4608
  ds_read_b64_tr_b16 v[200:201], v10 offset:8192
  ds_read_b64_tr_b16 v[202:203], v10 offset:8704
  ds_read_b64_tr_b16 v[204:205], v10 offset:12288
  ds_read_b64_tr_b16 v[206:207], v10 offset:12800
  ds_read_b64_tr_b16 v[224:225], v11 offset:0
  ds_read_b64_tr_b16 v[226:227], v11 offset:512
  ds_read_b64_tr_b16 v[228:229], v11 offset:4096
  ds_read_b64_tr_b16 v[230:231], v11 offset:4608
  ds_read_b64_tr_b16 v[232:233], v11 offset:8192
  ds_read_b64_tr_b16 v[234:235], v11 offset:8704
  ds_read_b64_tr_b16 v[236:237], v11 offset:12288
  ds_read_b64_tr_b16 v[238:239], v11 offset:12800
  s_waitcnt lgkmcnt(0)
  s_barrier
  s_mov_b32 s8, s32
  s_mov_b32 s9, s33
  s_mov_b32 s10, 0x800000
  s_mov_b32 s11, 0x20000
  s_xor_b32 s73, s51, 0
  s_lshl_b32 s73, s73, 2
  s_add_u32 s73, s73, s50
  s_lshl_b32 s73, s73, 20
  s_lshl_b32 s56, s65, 8
  s_add_u32 s73, s73, s56
  s_add_u32 s73, s73, 128
  s_lshl_b32 s56, s50, 15
  s_add_u32 s56, s56, 0
  s_sub_u32 s57, s73, 65536
  s_mov_b32 s58, 4
Ldma_68:
  s_mov_b32 m0, s56
  s_add_u32 s57, s57, 65536
  buffer_load_dwordx4 v18, s[8:11], s57 offen lds
  s_add_u32 s56, s56, 1024
  s_mov_b32 m0, s56
  s_add_u32 s57, s57, 65536
  buffer_load_dwordx4 v18, s[8:11], s57 offen lds
  s_add_u32 s56, s56, 1024
  s_mov_b32 m0, s56
  s_add_u32 s57, s57, 65536
  buffer_load_dwordx4 v19, s[8:11], s57 offen lds
  s_add_u32 s56, s56, 1024
  s_mov_b32 m0, s56
  s_add_u32 s57, s57, 65536
  buffer_load_dwordx4 v19, s[8:11], s57 offen lds
  s_add_u32 s56, s56, 1024
  s_sub_u32 s58, s58, 1
  s_cmp_lg_u32 s58, 0
  s_cbranch_scc1 Ldma_68
  s_waitcnt vmcnt(16)
  s_barrier
  ds_read_b64_tr_b16 v[144:145], v8 offset:16384
  ds_read_b64_tr_b16 v[146:147], v8 offset:16896
  ds_read_b64_tr_b16 v[148:149], v8 offset:20480
  ds_read_b64_tr_b16 v[150:151], v8 offset:20992
  ds_read_b64_tr_b16 v[152:153], v8 offset:24576
  ds_read_b64_tr_b16 v[154:155], v8 offset:25088
  ds_read_b64_tr_b16 v[156:157], v8 offset:28672
  ds_read_b64_tr_b16 v[158:159], v8 offset:29184
  ds_read_b64_tr_b16 v[176:177], v9 offset:16384
  ds_read_b64_tr_b16 v[178:179], v9 offset:16896
  ds_read_b64_tr_b16 v[180:181], v9 offset:20480
  ds_read_b64_tr_b16 v[182:183], v9 offset:20992
  ds_read_b64_tr_b16 v[184:185], v9 offset:24576
  ds_read_b64_tr_b16 v[186:187], v9 offset:25088
  ds_read_b64_tr_b16 v[188:189], v9 offset:28672
  ds_read_b64_tr_b16 v[190:191], v9 offset:29184
  ds_read_b64_tr_b16 v[208:209], v10 offset:16384
  ds_read_b64_tr_b16 v[210:211], v10 offset:16896
  ds_read_b64_tr_b16 v[212:213], v10 offset:20480
  ds_read_b64_tr_b16 v[214:215], v10 offset:20992
  ds_read_b64_tr_b16 v[216:217], v10 offset:24576
  ds_read_b64_tr_b16 v[218:219], v10 offset:25088
  ds_read_b64_tr_b16 v[220:221], v10 offset:28672
  ds_read_b64_tr_b16 v[222:223], v10 offset:29184
  ds_read_b64_tr_b16 v[240:241], v11 offset:16384
  ds_read_b64_tr_b16 v[242:243], v11 offset:16896
  ds_read_b64_tr_b16 v[244:245], v11 offset:20480
  ds_read_b64_tr_b16 v[246:247], v11 offset:20992
  ds_read_b64_tr_b16 v[248:249], v11 offset:24576
  ds_read_b64_tr_b16 v[250:251], v11 offset:25088
  ds_read_b64_tr_b16 v[252:253], v11 offset:28672
  ds_read_b64_tr_b16 v[254:255], v11 offset:29184
  s_waitcnt lgkmcnt(0)
  s_barrier
  s_mov_b32 s8, s32
  s_mov_b32 s9, s33
  s_mov_b32 s10, 0x800000
  s_mov_b32 s11, 0x20000
  s_xor_b32 s73, s51, 1
  s_lshl_b32 s73, s73, 2
  s_add_u32 s73, s73, s50
  s_lshl_b32 s73, s73, 20
  s_lshl_b32 s56, s65, 8
  s_add_u32 s73, s73, s56
  s_add_u32 s73, s73, 128
  s_lshl_b32 s56, s50, 15
  s_add_u32 s56, s56, 16384
  s_sub_u32 s57, s73, 65536
  s_mov_b32 s58, 4
Ldma_69:
  s_mov_b32 m0, s56
  s_add_u32 s57, s57, 65536
  buffer_load_dwordx4 v18, s[8:11], s57 offen lds
  s_add_u32 s56, s56, 1024
  s_mov_b32 m0, s56
  s_add_u32 s57, s57, 65536
  buffer_load_dwordx4 v18, s[8:11], s57 offen lds
  s_add_u32 s56, s56, 1024
  s_mov_b32 m0, s56
  s_add_u32 s57, s57, 65536
  buffer_load_dwordx4 v19, s[8:11], s57 offen lds
  s_add_u32 s56, s56, 1024
  s_mov_b32 m0, s56
  s_add_u32 s57, s57, 65536
  buffer_load_dwordx4 v19, s[8:11], s57 offen lds
  s_add_u32 s56, s56, 1024
  s_sub_u32 s58, s58, 1
  s_cmp_lg_u32 s58, 0
  s_cbranch_scc1 Ldma_69
  s_waitcnt vmcnt(16)
  s_barrier
  ds_read_b64_tr_b16 v[32:33], v8 offset:0
  ds_read_b64_tr_b16 v[34:35], v8 offset:512
  ds_read_b64_tr_b16 v[36:37], v8 offset:4096
  ds_read_b64_tr_b16 v[38:39], v8 offset:4608
  ds_read_b64_tr_b16 v[40:41], v8 offset:8192
  ds_read_b64_tr_b16 v[42:43], v8 offset:8704
  ds_read_b64_tr_b16 v[44:45], v8 offset:12288
  ds_read_b64_tr_b16 v[46:47], v8 offset:12800
  ds_read_b64_tr_b16 v[48:49], v9 offset:0
  ds_read_b64_tr_b16 v[50:51], v9 offset:512
  ds_read_b64_tr_b16 v[52:53], v9 offset:4096
  ds_read_b64_tr_b16 v[54:55], v9 offset:4608
  ds_read_b64_tr_b16 v[56:57], v9 offset:8192
  ds_read_b64_tr_b16 v[58:59], v9 offset:8704
  ds_read_b64_tr_b16 v[60:61], v9 offset:12288
  ds_read_b64_tr_b16 v[62:63], v9 offset:12800
  ds_read_b64_tr_b16 v[64:65], v10 offset:0
  ds_read_b64_tr_b16 v[66:67], v10 offset:512
  ds_read_b64_tr_b16 v[68:69], v10 offset:4096
  ds_read_b64_tr_b16 v[70:71], v10 offset:4608
  ds_read_b64_tr_b16 v[72:73], v10 offset:8192
  ds_read_b64_tr_b16 v[74:75], v10 offset:8704
  ds_read_b64_tr_b16 v[76:77], v10 offset:12288
  ds_read_b64_tr_b16 v[78:79], v10 offset:12800
  ds_read_b64_tr_b16 v[80:81], v11 offset:0
  ds_read_b64_tr_b16 v[82:83], v11 offset:512
  ds_read_b64_tr_b16 v[84:85], v11 offset:4096
  ds_read_b64_tr_b16 v[86:87], v11 offset:4608
  ds_read_b64_tr_b16 v[88:89], v11 offset:8192
  ds_read_b64_tr_b16 v[90:91], v11 offset:8704
  ds_read_b64_tr_b16 v[92:93], v11 offset:12288
  ds_read_b64_tr_b16 v[94:95], v11 offset:12800
  s_waitcnt lgkmcnt(0)
  s_barrier
  ds_write_b128 v120, v[32:35] offset:0
  ds_write_b128 v120, v[36:39] offset:1024
  ds_write_b128 v120, v[40:43] offset:8192
  ds_write_b128 v120, v[44:47] offset:9216
  ds_write_b128 v121, v[48:51] offset:0
  ds_write_b128 v121, v[52:55] offset:1024
  ds_write_b128 v121, v[56:59] offset:8192
  ds_write_b128 v121, v[60:63] offset:9216
  ds_write_b128 v122, v[64:67] offset:0
  ds_write_b128 v122, v[68:71] offset:1024
  ds_write_b128 v122, v[72:75] offset:8192
  ds_write_b128 v122, v[76:79] offset:9216
  ds_write_b128 v123, v[80:83] offset:0
  ds_write_b128 v123, v[84:87] offset:1024
  ds_write_b128 v123, v[88:91] offset:8192
  ds_write_b128 v123, v[92:95] offset:9216
  s_waitcnt lgkmcnt(0)
  s_barrier
  v_lshlrev_b32 v21, 2, v0
  buffer_load_dword v20, v21, s[20:23], 0 offen sc1
  s_waitcnt vmcnt(0)
  s_barrier
  ds_read_b64_tr_b16 v[32:33], v8 offset:16384
  ds_read_b64_tr_b16 v[34:35], v8 offset:16896
  ds_read_b64_tr_b16 v[36:37], v8 offset:20480
  ds_read_b64_tr_b16 v[38:39], v8 offset:20992
  ds_read_b64_tr_b16 v[40:41], v8 offset:24576
  ds_read_b64_tr_b16 v[42:43], v8 offset:25088
  ds_read_b64_tr_b16 v[44:45], v8 offset:28672
  ds_read_b64_tr_b16 v[46:47], v8 offset:29184
  ds_read_b64_tr_b16 v[48:49], v9 offset:16384
  ds_read_b64_tr_b16 v[50:51], v9 offset:16896
  ds_read_b64_tr_b16 v[52:53], v9 offset:20480
  ds_read_b64_tr_b16 v[54:55], v9 offset:20992
  ds_read_b64_tr_b16 v[56:57], v9 offset:24576
  ds_read_b64_tr_b16 v[58:59], v9 offset:25088
  ds_read_b64_tr_b16 v[60:61], v9 offset:28672
  ds_read_b64_tr_b16 v[62:63], v9 offset:29184
  ds_read_b64_tr_b16 v[64:65], v10 offset:16384
  ds_read_b64_tr_b16 v[66:67], v10 offset:16896
  ds_read_b64_tr_b16 v[68:69], v10 offset:20480
  ds_read_b64_tr_b16 v[70:71], v10 offset:20992
  ds_read_b64_tr_b16 v[72:73], v10 offset:24576
  ds_read_b64_tr_b16 v[74:75], v10 offset:25088
  ds_read_b64_tr_b16 v[76:77], v10 offset:28672
  ds_read_b64_tr_b16 v[78:79], v10 offset:29184
  ds_read_b64_tr_b16 v[80:81], v11 offset:16384
  ds_read_b64_tr_b16 v[82:83], v11 offset:16896
  ds_read_b64_tr_b16 v[84:85], v11 offset:20480
  ds_read_b64_tr_b16 v[86:87], v11 offset:20992
  ds_read_b64_tr_b16 v[88:89], v11 offset:24576
  ds_read_b64_tr_b16 v[90:91], v11 offset:25088
  ds_read_b64_tr_b16 v[92:93], v11 offset:28672
  ds_read_b64_tr_b16 v[94:95], v11 offset:29184
  s_waitcnt lgkmcnt(0)
  s_barrier
  ds_write_b128 v120, v[32:35] offset:16384
  ds_write_b128 v120, v[36:39] offset:17408
  ds_write_b128 v120, v[40:43] offset:24576
  ds_write_b128 v120, v[44:47] offset:25600
  ds_write_b128 v121, v[48:51] offset:16384
  ds_write_b128 v121, v[52:55] offset:17408
  ds_write_b128 v121, v[56:59] offset:24576
  ds_write_b128 v121, v[60:63] offset:25600
  ds_write_b128 v122, v[64:67] offset:16384
  ds_write_b128 v122, v[68:71] offset:17408
  ds_write_b128 v122, v[72:75] offset:24576
  ds_write_b128 v122, v[76:79] offset:25600
  ds_write_b128 v123, v[80:83] offset:16384
  ds_write_b128 v123, v[84:87] offset:17408
  ds_write_b128 v123, v[88:91] offset:24576
  ds_write_b128 v123, v[92:95] offset:25600
  v_mov_b32 v8, v120
  v_mov_b32 v9, v121
  v_mov_b32 v10, v122
  v_mov_b32 v11, v123
  s_waitcnt lgkmcnt(0)
  s_barrier
  s_branch Lwa_74
Lwa_70:
  v_lshlrev_b32 v21, 2, v0
  buffer_load_dword v20, v21, s[20:23], 0 offen sc1
  s_waitcnt vmcnt(0)
Lwa_74:
  s_cmp_eq_u32 s100, 0
  s_cbranch_scc1 Lwa_72
  s_mov_b32 s56, 0
  v_readlane_b32 s57, v20, 8
  s_add_u32 s56, s56, s57
  v_readlane_b32 s57, v20, 9
  s_add_u32 s56, s56, s57
  v_readlane_b32 s57, v20, 10
  s_add_u32 s56, s56, s57
  v_readlane_b32 s57, v20, 11
  s_add_u32 s56, s56, s57
  v_readlane_b32 s57, v20, 12
  s_add_u32 s56, s56, s57
  v_readlane_b32 s57, v20, 13
  s_add_u32 s56, s56, s57
  v_readlane_b32 s57, v20, 14
  s_add_u32 s56, s56, s57
  v_readlane_b32 s57, v20, 15
  s_add_u32 s56, s56, s57
  v_readlane_b32 s57, v20, 16
  s_add_u32 s56, s56, s57
  v_readlane_b32 s57, v20, 40
  s_add_u32 s56, s56, s57
  v_readlane_b32 s57, v20, 41
  s_add_u32 s56, s56, s57
  v_readlane_b32 s57, v20, 42
  s_add_u32 s56, s56, s57
  v_readlane_b32 s57, v20, 43
  s_add_u32 s56, s56, s57
  v_readlane_b32 s57, v20, 44
  s_add_u32 s56, s56, s57
  v_readlane_b32 s57, v20, 45
  s_add_u32 s56, s56, s57
  v_readlane_b32 s57, v20, 46
  s_add_u32 s56, s56, s57
  v_readlane_b32 s57, v20, 47
  s_add_u32 s56, s56, s57
  v_readlane_b32 s57, v20, 48
  s_add_u32 s56, s56, s57
  s_cmp_lt_u32 s56, 256
  s_cbranch_scc1 Lwa_73
  s_lshr_b32 s58, s100, 2
  v_readlane_b32 s56, v20, s58
  s_add_u32 s58, s58, 32
  v_readlane_b32 s57, v20, s58
  s_add_u32 s56, s56, s57
  s_cmp_eq_u32 s58, 48
  s_cselect_b32 s56, 0, s56
  s_cmp_lt_u32 s56, 256
  s_cbranch_scc1 L_restart
  v_readlane_b32 s56, v20, 32
  s_cmp_ge_u32 s56, 128
  s_cbranch_scc1 Lwa_71
  s_branch Lwa_73
Lwa_72:
  v_readlane_b32 s56, v20, 0
  s_cmp_ge_u32 s56, 256
  s_cbranch_scc1 Lwa_71
Lwa_73:
  s_sleep 8
  s_add_u32 s55, s55, 1
  s_bitcmp1_b32 s55, 21
  s_cbranch_scc1 L_abort
  s_branch Lwa_70
Lwa_71:
  s_mov_b32 s56, 0
  s_cmp_eq_u32 s100, 0
  s_cbranch_scc1 Lwa_75
  v_readlane_b32 s56, v20, 1
  s_and_b32 s57, s56, 0xff
  s_cmp_lt_u32 s57, 32
  s_cbranch_scc1 Lwa_73
Lwa_75:
  s_cmp_gt_u32 s56, 0x10ff
  s_cselect_b32 s39, 8192, 0
  s_add_u32 s38, s38, s39
  s_add_u32 s67, s67, s39
  s_add_u32 s75, s75, s39
  s_mov_b32 s57, 0x05040100
  s_mov_b32 s58, 0x07060302
  v_perm_b32 v32, v98, v96, s57
  v_perm_b32 v33, v99, v97, s57
  v_perm_b32 v34, v98, v96, s58
  v_perm_b32 v35, v99, v97, s58
  v_min_u32 v32, -2, v32
  v_min_u32 v33, -2, v33
  v_min_u32 v34, -2, v34
  v_min_u32 v35, -2, v35
  ds_write_b128 v4, v[32:35] offset:0
  v_perm_b32 v36, v102, v100, s57
  v_perm_b32 v37, v103, v101, s57
  v_perm_b32 v38, v102, v100, s58
  v_perm_b32 v39, v103, v101, s58
  v_min_u32 v36, -2, v36
  v_min_u32 v37, -2, v37
  v_min_u32 v38, -2, v38
  v_min_u32 v39, -2, v39
  ds_write_b128 v4, v[36:39] offset:1024
  v_perm_b32 v40, v106, v104, s57
  v_perm_b32 v41, v107, v105, s57
  v_perm_b32 v42, v106, v104, s58
  v_perm_b32 v43, v107, v105, s58
  v_min_u32 v40, -2, v40
  v_min_u32 v41, -2, v41
  v_min_u32 v42, -2, v42
  v_min_u32 v43, -2, v43
  ds_write_b128 v4, v[40:43] offset:2048
  v_perm_b32 v44, v110, v108, s57
  v_perm_b32 v45, v111, v109, s57
  v_perm_b32 v46, v110, v108, s58
  v_perm_b32 v47, v111, v109, s58
  v_min_u32 v44, -2, v44
  v_min_u32 v45, -2, v45
  v_min_u32 v46, -2, v46
  v_min_u32 v47, -2, v47
  ds_write_b128 v4, v[44:47] offset:3072
  ds_read_b128 v[80:83], v8 offset:0
  ds_read_b128 v[84:87], v8 offset:1024
  ds_read_b128 v[88:91], v8 offset:8192
  ds_read_b128 v[92:95], v8 offset:9216
  ds_read_b128 v[96:99], v9 offset:0
  ds_read_b128 v[100:103], v9 offset:1024
  ds_read_b128 v[104:107], v9 offset:8192
  ds_read_b128 v[108:111], v9 offset:9216
  s_cmp_eq_u32 s50, 3
  s_cselect_b32 s39, 0, 0x80000000
  v_mov_b32 v127, 0x80000000
  v_writelane_b32 v127, 0, 0
  ds_read_b128 v[64:67], v10 offset:0
  ds_read_b128 v[68:71], v10 offset:1024
  ds_read_b128 v[72:75], v10 offset:8192
  ds_read_b128 v[76:79], v10 offset:9216
  v_mov_b32 v124, -1
  v_mov_b32 v16, 0
  v_mov_b32 v17, 0
  v_mov_b32 v18, 0
  v_mov_b32 v19, 0
  v_mov_b32 v20, 0
  v_mov_b32 v21, 0
  v_mov_b32 v22, 0
  v_mov_b32 v23, 0
  s_waitcnt vmcnt(0) lgkmcnt(0)
  v_smfmac_f32_16x16x64_bf16 v[16:19], v[32:35], v[128:135], v3
  v_smfmac_f32_16x16x64_bf16 v[20:23], v[32:35], v[80:87], v3
  s_cmp_eq_u32 s100, 0
  s_cbranch_scc1 L_vo_e1
  s_branch L_vo_e0
L_vo_top0:
  s_and_b32 s70, s54, 3
  s_lshl_b32 s70, s70, 13
  s_add_u32 s70, s70, s66
  s_and_b32 s73, s54, 3
  s_lshl_b32 s73, s73, 14
  s_add_u32 s73, s73, s67
  s_waitcnt vmcnt(2)
  buffer_load_dwordx4 v[32:35], v1, s[4:7], s70 offen offset:0 sc1
  buffer_load_dwordx4 v[36:39], v1, s[4:7], s70 offen offset:1024 sc1
  s_waitcnt vmcnt(1)
Lm_76:
  v_max3_u32 v126, v32, v33, v34
  v_max_u32 v126, v126, v35
  v_cmp_eq_u32 vcc, -1, v126
  ds_write_b128 v4, v[32:35] offset:0
  s_cbranch_vccnz Lm_78
  s_waitcnt vmcnt(0)
Lm_77:
  v_max3_u32 v126, v36, v37, v38
  v_max_u32 v126, v126, v39
  v_cmp_eq_u32 vcc, -1, v126
  ds_write_b128 v4, v[36:39] offset:1024
  s_cbranch_vccnz Lm_79
  v_smfmac_f32_16x16x64_bf16 v[16:19], v[32:35], v[128:135], v3
  buffer_load_dwordx4 v[40:43], v1, s[4:7], s73 offen offset:0 sc1
  s_waitcnt lgkmcnt(2)
  v_smfmac_f32_16x16x64_bf16 v[20:23], v[32:35], v[80:87], v3
  buffer_load_dwordx4 v[44:47], v1, s[4:7], s73 offen offset:1024 sc1
L_vo_e0:
  s_waitcnt lgkmcnt(0)
  s_barrier
  ds_read_b128 v[56:59], v5 offset:0
  ds_read_b128 v[60:63], v5 offset:1024
  v_smfmac_f32_16x16x64_bf16 v[16:19], v[36:39], v[136:143], v3
  ds_read_b128 v[48:51], v6 offset:0
  v_smfmac_f32_16x16x64_bf16 v[20:23], v[36:39], v[88:95], v3
  ds_read_b128 v[52:55], v6 offset:1024
  ds_read_b128 v[80:83], v8 offset:16384
  ds_read_b128 v[84:87], v8 offset:17408
  ds_read_b128 v[88:91], v8 offset:24576
  s_waitcnt lgkmcnt(6)
  v_smfmac_f32_16x16x64_bf16 v[16:19], v[56:59], v[160:167], v3
  ds_read_b128 v[92:95], v8 offset:25600
  v_smfmac_f32_16x16x64_bf16 v[20:23], v[56:59], v[96:103], v3
  ds_read_b128 v[56:59], v7 offset:0
  s_waitcnt lgkmcnt(7)
  v_smfmac_f32_16x16x64_bf16 v[16:19], v[60:63], v[168:175], v3
  ds_read_b128 v[96:99], v11 offset:0
  v_smfmac_f32_16x16x64_bf16 v[20:23], v[60:63], v[104:111], v3
  ds_read_b128 v[100:103], v11 offset:1024
  s_waitcnt lgkmcnt(8)
  v_smfmac_f32_16x16x64_bf16 v[16:19], v[48:51], v[192:199], v3
  ds_read_b128 v[60:63], v7 offset:1024
  v_smfmac_f32_16x16x64_bf16 v[20:23], v[48:51], v[64:71], v3
  ds_read_b128 v[104:107], v11 offset:8192
  s_waitcnt lgkmcnt(9)
  v_smfmac_f32_16x16x64_bf16 v[16:19], v[52:55], v[200:207], v3
  ds_read_b128 v[108:111], v11 offset:9216
  v_smfmac_f32_16x16x64_bf16 v[20:23], v[52:55], v[72:79], v3
  s_waitcnt lgkmcnt(3)
  v_smfmac_f32_16x16x64_bf16 v[16:19], v[56:59], v[224:231], v3
  s_waitcnt vmcnt(1)
  ds_write_b128 v4, v[40:43] offset:2048
  v_max_u32 v126, v40, v41
  v_smfmac_f32_16x16x64_bf16 v[20:23], v[56:59], v[96:103], v3
  s_waitcnt vmcnt(0)
  ds_write_b128 v4, v[44:47] offset:3072
  v_max3_u32 v126, v126, v42, v43
  v_max3_u32 v126, v126, v44, v45
  v_max3_u32 v126, v126, v46, v47
  s_waitcnt lgkmcnt(2)
  v_smfmac_f32_16x16x64_bf16 v[16:19], v[60:63], v[232:239], v3
  ds_read_b128 v[96:99], v9 offset:16384
  v_cmp_eq_u32 vcc, -1, v126
  v_smfmac_f32_16x16x64_bf16 v[20:23], v[60:63], v[104:111], v3
  ds_read_b128 v[100:103], v9 offset:17408
  ds_read_b128 v[104:107], v9 offset:24576
  s_cbranch_vccnz Lr_81
Lr_80:
  v_smfmac_f32_16x16x64_bf16 v[16:19], v[40:43], v[144:151], v3
  s_waitcnt lgkmcnt(3)
  s_barrier
  ds_read_b128 v[56:59], v5 offset:2048
  v_smfmac_f32_16x16x64_bf16 v[20:23], v[40:43], v[80:87], v3
  ds_read_b128 v[60:63], v5 offset:3072
  v_smfmac_f32_16x16x64_bf16 v[16:19], v[44:47], v[152:159], v3
  ds_read_b128 v[108:111], v9 offset:25600
  v_smfmac_f32_16x16x64_bf16 v[20:23], v[44:47], v[88:95], v3
  ds_read_b128 v[48:51], v6 offset:2048
  ds_read_b128 v[80:83], v10 offset:16384
  ds_read_b128 v[84:87], v10 offset:17408
  s_waitcnt lgkmcnt(5)
  v_smfmac_f32_16x16x64_bf16 v[16:19], v[56:59], v[176:183], v3
  ds_read_b128 v[52:55], v6 offset:3072
  ds_read_b128 v[88:91], v10 offset:24576
  v_smfmac_f32_16x16x64_bf16 v[20:23], v[56:59], v[96:103], v3
  ds_read_b128 v[92:95], v10 offset:25600
  s_waitcnt lgkmcnt(6)
  v_smfmac_f32_16x16x64_bf16 v[16:19], v[60:63], v[184:191], v3
  ds_read_b128 v[56:59], v7 offset:2048
  ds_read_b128 v[96:99], v11 offset:16384
  v_smfmac_f32_16x16x64_bf16 v[20:23], v[60:63], v[104:111], v3
  ds_read_b128 v[100:103], v11 offset:17408
  s_waitcnt lgkmcnt(6)
  v_smfmac_f32_16x16x64_bf16 v[16:19], v[48:51], v[208:215], v3
  ds_read_b128 v[60:63], v7 offset:3072
  ds_read_b128 v[104:107], v11 offset:24576
  v_smfmac_f32_16x16x64_bf16 v[20:23], v[48:51], v[80:87], v3
  ds_read_b128 v[108:111], v11 offset:25600
  s_waitcnt lgkmcnt(6)
  v_smfmac_f32_16x16x64_bf16 v[16:19], v[52:55], v[216:223], v3
  s_and_b32 s70, s54, 3
  s_lshl_b32 s70, s70, 15
  s_add_u32 s70, s70, s69
  v_smfmac_f32_16x16x64_bf16 v[20:23], v[52:55], v[88:95], v3
  s_waitcnt lgkmcnt(3)
  v_smfmac_f32_16x16x64_bf16 v[16:19], v[56:59], v[240:247], v3
  s_waitcnt lgkmcnt(2)
  v_smfmac_f32_16x16x64_bf16 v[16:19], v[60:63], v[248:255], v3
  s_nop 2
  v_smfmac_f32_16x16x64_bf16 v[20:23], v[56:59], v[96:103], v3
  s_waitcnt lgkmcnt(0)
  s_nop 1
  v_smfmac_f32_16x16x64_bf16 v[20:23], v[60:63], v[104:111], v3
  v_add_f32 v16, v16, v17
  v_add_f32 v18, v18, v19
  v_cvt_pk_bf16_f32 v16, v16, v18
  buffer_store_dword v16, v14, s[4:7], s70 offen offset:0
  v_mov_b32 v0, v0
  v_mov_b32 v0, v0
  v_mov_b32 v0, v0
  v_mov_b32 v0, v0
  v_add_f32 v20, v20, v21
  v_add_f32 v22, v22, v23
  v_cvt_pk_bf16_f32 v20, v20, v22
  buffer_store_dword v20, v14, s[4:7], s70 offen offset:1024
  s_cmp_eq_u32 s54, 63
  s_cbranch_scc1 L_vo_end
  s_xor_b32 s70, s70, 0x10000
  buffer_store_dword v124, v14, s[4:7], s70 offen
  buffer_store_dword v124, v14, s[4:7], s70 offen offset:1024
  s_add_u32 s70, s54, 2
  s_and_b32 s70, s70, 3
  s_lshl_b32 s70, s70, 13
  s_add_u32 s70, s70, s74
  buffer_store_dword v124, v15, s[4:7], s70 offen
  s_and_b32 s70, s54, 3
  s_lshl_b32 s70, s70, 15
  s_add_u32 s70, s70, s68
  v_mov_b32 v16, 0
  v_mov_b32 v17, 0
  v_mov_b32 v18, 0
  v_mov_b32 v19, 0
  v_mov_b32 v20, 0
  v_mov_b32 v21, 0
  v_mov_b32 v22, 0
  v_mov_b32 v23, 0
  v_mov_b32 v24, 0
  v_mov_b32 v25, 0
  v_mov_b32 v26, 0
  v_mov_b32 v27, 0
  v_mov_b32 v28, 0
  v_mov_b32 v29, 0
  v_mov_b32 v30, 0
  v_mov_b32 v31, 0
  s_add_u32 s56, s54, 1
  v_mov_b32 v125, s56
  v_mov_b32 v126, 0
  v_and_b32 v112, 15, v0
  v_lshlrev_b32 v112, 2, v112
  v_lshl_add_u32 v112, s50, 7, v112
  s_add_u32 s56, s54, 1
  buffer_load_dword v113, v112, s[4:7], s3 offen sc1
  buffer_load_dword v114, v112, s[4:7], s3 offen sc1
  buffer_load_dword v115, v112, s[4:7], s3 offen sc1
  buffer_load_dword v116, v112, s[4:7], s3 offen sc1
Lh_82:
  s_waitcnt vmcnt(3)
  v_cmp_gt_u32 vcc, s56, v113
  s_cbranch_vccz Lh_83
  buffer_load_dword v113, v112, s[4:7], s3 offen sc1
  s_nop 1
  s_waitcnt vmcnt(3)
  v_cmp_gt_u32 vcc, s56, v114
  s_cbranch_vccz Lh_83
  buffer_load_dword v114, v112, s[4:7], s3 offen sc1
  s_nop 1
  s_waitcnt vmcnt(3)
  v_cmp_gt_u32 vcc, s56, v115
  s_cbranch_vccz Lh_83
  buffer_load_dword v115, v112, s[4:7], s3 offen sc1
  s_nop 1
  s_waitcnt vmcnt(3)
  v_cmp_gt_u32 vcc, s56, v116
  s_cbranch_vccz Lh_83
  buffer_load_dword v116, v112, s[4:7], s3 offen sc1
  s_nop 1
  s_waitcnt vmcnt(3)
  v_cmp_gt_u32 vcc, s56, v113
  s_cbranch_vccz Lh_83
  buffer_load_dword v113, v112, s[4:7], s3 offen sc1
  s_nop 1
  s_waitcnt vmcnt(3)
  v_cmp_gt_u32 vcc, s56, v114
  s_cbranch_vccz Lh_83
  buffer_load_dword v114, v112, s[4:7], s3 offen sc1
  s_nop 1
  s_waitcnt vmcnt(3)
  v_cmp_gt_u32 vcc, s56, v115
  s_cbranch_vccz Lh_83
  buffer_load_dword v115, v112, s[4:7], s3 offen sc1
  s_nop 1
  s_waitcnt vmcnt(3)
  v_cmp_gt_u32 vcc, s56, v116
  s_cbranch_vccz Lh_83
  buffer_load_dword v116, v112, s[4:7], s3 offen sc1
  s_nop 1
  s_waitcnt vmcnt(3)
  v_cmp_gt_u32 vcc, s56, v113
  s_cbranch_vccz Lh_83
  buffer_load_dword v113, v112, s[4:7], s3 offen sc1
  s_nop 1
  s_waitcnt vmcnt(3)
  v_cmp_gt_u32 vcc, s56, v114
  s_cbranch_vccz Lh_83
  buffer_load_dword v114, v112, s[4:7], s3 offen sc1
  s_nop 1
  s_waitcnt vmcnt(3)
  v_cmp_gt_u32 vcc, s56, v115
  s_cbranch_vccz Lh_83
  buffer_load_dword v115, v112, s[4:7], s3 offen sc1
  s_nop 1
  s_waitcnt vmcnt(3)
  v_cmp_gt_u32 vcc, s56, v116
  s_cbranch_vccz Lh_83
  buffer_load_dword v116, v112, s[4:7], s3 offen sc1
  s_add_u32 s55, s55, 1
  s_bitcmp1_b32 s55, 21
  s_cbranch_scc1 L_abort
  s_branch Lh_82
.p2align 6
Lh_83:
  s_barrier
Lg_84:
  buffer_load_dwordx4 v[32:35], v1, s[4:7], s70 offen offset:0 sc1
  s_add_u32 s71, s70, 4096
  s_and_b32 s73, s54, 3
  s_lshl_b32 s73, s73, 16
  s_add_u32 s73, s73, s38
  s_add_u32 s72, s73, 4096
  buffer_load_dwordx4 v[36:39], v1, s[4:7], s70 offen offset:1024 sc1
  s_add_u32 s53, s54, 1
  s_and_b32 s53, s53, 3
  s_lshl_b32 s53, s53, 13
  s_add_u32 s53, s53, s74
  buffer_load_dwordx4 v[40:43], v1, s[4:7], s70 offen offset:2048 sc1
  s_add_u32 s77, s54, 1
  s_and_b32 s77, s77, 3
  s_lshl_b32 s77, s77, 14
  s_add_u32 s77, s77, s75
  buffer_load_dwordx4 v[44:47], v1, s[4:7], s70 offen offset:3072 sc1
  ds_read_b128 v[80:83], v8 offset:0
  ds_read_b128 v[84:87], v8 offset:1024
  buffer_load_dwordx4 v[48:51], v1, s[4:7], s71 offen offset:0 sc1
  ds_read_b128 v[88:91], v8 offset:8192
  ds_read_b128 v[92:95], v8 offset:9216
  buffer_load_dwordx4 v[52:55], v1, s[4:7], s71 offen offset:1024 sc1
  ds_read_b128 v[96:99], v9 offset:0
  ds_read_b128 v[100:103], v9 offset:1024
  buffer_load_dwordx4 v[56:59], v1, s[4:7], s71 offen offset:2048 sc1
  ds_read_b128 v[104:107], v9 offset:8192
  ds_read_b128 v[108:111], v9 offset:9216
  buffer_load_dwordx4 v[60:63], v1, s[4:7], s71 offen offset:3072 sc1
  s_waitcnt vmcnt(7)
  v_cmp_eq_u32 vcc, -1, v35
  s_cbranch_vccnz Le_102
Lb_86:
  s_waitcnt vmcnt(6)
  v_cmp_eq_u32 vcc, -1, v39
  v_smfmac_f32_16x16x64_bf16 v[24:27], v[32:35], a[0:7], v3
  v_max3_u32 v126, v126, v32, v33
  v_smfmac_f32_16x16x64_bf16 v[28:31], v[32:35], a[8:15], v3
  v_max_u32 v126, v126, v34
  buffer_load_dwordx4 v[32:35], v1, s[4:7], s73 offen offset:0 sc1
  s_cbranch_vccnz Le_103
Lb_87:
  s_waitcnt vmcnt(6)
  v_cmp_eq_u32 vcc, -1, v43
  v_smfmac_f32_16x16x64_bf16 v[24:27], v[36:39], a[16:23], v3
  v_max3_u32 v126, v126, v36, v37
  v_smfmac_f32_16x16x64_bf16 v[28:31], v[36:39], a[24:31], v3
  v_max_u32 v126, v126, v38
  buffer_load_dwordx4 v[36:39], v1, s[4:7], s73 offen offset:1024 sc1
  s_cbranch_vccnz Le_104
Lb_88:
  s_waitcnt vmcnt(6)
  v_cmp_eq_u32 vcc, -1, v47
  v_smfmac_f32_16x16x64_bf16 v[24:27], v[40:43], a[32:39], v3
  v_max3_u32 v126, v126, v40, v41
  v_smfmac_f32_16x16x64_bf16 v[28:31], v[40:43], a[40:47], v3
  v_max_u32 v126, v126, v42
  buffer_load_dwordx4 v[40:43], v1, s[4:7], s73 offen offset:2048 sc1
  s_cbranch_vccnz Le_105
Lb_89:
  s_waitcnt vmcnt(6)
  v_cmp_eq_u32 vcc, -1, v51
  v_smfmac_f32_16x16x64_bf16 v[24:27], v[44:47], a[48:55], v3
  v_max3_u32 v126, v126, v44, v45
  v_smfmac_f32_16x16x64_bf16 v[28:31], v[44:47], a[56:63], v3
  v_max_u32 v126, v126, v46
  buffer_load_dwordx4 v[44:47], v1, s[4:7], s73 offen offset:3072 sc1
  s_cbranch_vccnz Le_106
Lb_90:
  s_waitcnt vmcnt(6)
  v_cmp_eq_u32 vcc, -1, v55
  v_smfmac_f32_16x16x64_bf16 v[24:27], v[48:51], a[64:71], v3
  v_max3_u32 v126, v126, v48, v49
  v_smfmac_f32_16x16x64_bf16 v[28:31], v[48:51], a[72:79], v3
  v_max_u32 v126, v126, v50
  buffer_load_dwordx4 v[48:51], v1, s[4:7], s72 offen offset:0 sc1
  s_cbranch_vccnz Le_107
Lb_91:
  s_waitcnt vmcnt(6)
  v_cmp_eq_u32 vcc, -1, v59
  v_smfmac_f32_16x16x64_bf16 v[24:27], v[52:55], a[80:87], v3
  v_max3_u32 v126, v126, v52, v53
  v_smfmac_f32_16x16x64_bf16 v[28:31], v[52:55], a[88:95], v3
  v_max_u32 v126, v126, v54
  buffer_load_dwordx4 v[52:55], v1, s[4:7], s72 offen offset:1024 sc1
  s_cbranch_vccnz Le_108
Lb_92:
  s_waitcnt vmcnt(6)
  v_cmp_eq_u32 vcc, -1, v63
  v_smfmac_f32_16x16x64_bf16 v[24:27], v[56:59], a[96:103], v3
  v_max3_u32 v126, v126, v56, v57
  v_smfmac_f32_16x16x64_bf16 v[28:31], v[56:59], a[104:111], v3
  v_max_u32 v126, v126, v58
  buffer_load_dwordx4 v[56:59], v1, s[4:7], s72 offen offset:2048 sc1
  s_cbranch_vccnz Le_109
Lb_93:
  s_waitcnt vmcnt(6)
  v_cmp_eq_u32 vcc, -1, v35
  v_smfmac_f32_16x16x64_bf16 v[24:27], v[60:63], a[112:119], v3
  v_max3_u32 v126, v126, v60, v61
  v_smfmac_f32_16x16x64_bf16 v[28:31], v[60:63], a[120:127], v3
  v_max_u32 v126, v126, v62
  buffer_load_dwordx4 v[60:63], v1, s[4:7], s72 offen offset:3072 sc1
  s_cbranch_vccnz Le_110
Lb_94:
  s_waitcnt vmcnt(6)
  v_cmp_eq_u32 vcc, -1, v39
  v_smfmac_f32_16x16x64_bf16 v[24:27], v[32:35], a[128:135], v3
  v_max3_u32 v126, v126, v32, v33
  v_smfmac_f32_16x16x64_bf16 v[28:31], v[32:35], a[136:143], v3
  v_max_u32 v126, v126, v34
  s_cbranch_vccnz Le_111
Lb_95:
  s_waitcnt vmcnt(5)
  v_cmp_eq_u32 vcc, -1, v43
  v_smfmac_f32_16x16x64_bf16 v[24:27], v[36:39], a[144:151], v3
  v_max3_u32 v126, v126, v36, v37
  v_smfmac_f32_16x16x64_bf16 v[28:31], v[36:39], a[152:159], v3
  v_max_u32 v126, v126, v38
  s_cbranch_vccnz Le_112
Lb_96:
  s_waitcnt vmcnt(4)
  v_cmp_eq_u32 vcc, -1, v47
  v_smfmac_f32_16x16x64_bf16 v[24:27], v[40:43], a[160:167], v3
  v_max3_u32 v126, v126, v40, v41
  v_smfmac_f32_16x16x64_bf16 v[28:31], v[40:43], a[168:175], v3
  v_max_u32 v126, v126, v42
  s_cbranch_vccnz Le_113
Lb_97:
  s_waitcnt vmcnt(3)
  v_cmp_eq_u32 vcc, -1, v51
  v_smfmac_f32_16x16x64_bf16 v[24:27], v[44:47], a[176:183], v3
  v_max3_u32 v126, v126, v44, v45
  v_smfmac_f32_16x16x64_bf16 v[28:31], v[44:47], a[184:191], v3
  v_max_u32 v126, v126, v46
  s_cbranch_vccnz Le_114
Lb_98:
  s_waitcnt vmcnt(2)
  v_cmp_eq_u32 vcc, -1, v55
  v_smfmac_f32_16x16x64_bf16 v[24:27], v[48:51], a[192:199], v3
  v_max3_u32 v126, v126, v48, v49
  v_smfmac_f32_16x16x64_bf16 v[28:31], v[48:51], a[200:207], v3
  v_max_u32 v126, v126, v50
  s_cbranch_vccnz Le_115
Lb_99:
  s_waitcnt vmcnt(1)
  v_cmp_eq_u32 vcc, -1, v59
  v_smfmac_f32_16x16x64_bf16 v[24:27], v[52:55], a[208:215], v3
  v_max3_u32 v126, v126, v52, v53
  v_smfmac_f32_16x16x64_bf16 v[28:31], v[52:55], a[216:223], v3
  v_max_u32 v126, v126, v54
  s_cbranch_vccnz Le_116
Lb_100:
  s_waitcnt vmcnt(0)
  v_cmp_eq_u32 vcc, -1, v63
  v_smfmac_f32_16x16x64_bf16 v[24:27], v[56:59], a[224:231], v3
  v_max3_u32 v126, v126, v56, v57
  v_smfmac_f32_16x16x64_bf16 v[28:31], v[56:59], a[232:239], v3
  v_max_u32 v126, v126, v58
  s_cbranch_vccnz Le_117
Lb_101:
  v_smfmac_f32_16x16x64_bf16 v[24:27], v[60:63], a[240:247], v3
  v_max3_u32 v126, v126, v60, v61
  v_smfmac_f32_16x16x64_bf16 v[28:31], v[60:63], a[248:255], v3
  buffer_store_dword v125, v127, s[4:7], s62 offen
  v_max_u32 v126, v126, v62
  v_cmp_eq_u32 vcc, -1, v126
  v_mov_b32 v0, v0
  v_mov_b32 v0, v0
  v_mov_b32 v0, v0
  v_add_f32 v116, v24, v25
  v_add_f32 v118, v26, v27
  v_add_f32 v117, v28, v29
  v_add_f32 v119, v30, v31
  ds_write_b128 v12, v[116:119]
  s_cbranch_vccnz Lg_85
  s_waitcnt lgkmcnt(0)
  s_barrier
  ds_read_b64 v[116:117], v13 offset:0
  ds_read_b64 v[118:119], v13 offset:1536
  ds_read_b64 v[120:121], v13 offset:3072
  ds_read_b64 v[122:123], v13 offset:4608
  s_waitcnt lgkmcnt(2)
  v_pk_add_f32 v[116:117], v[116:117], v[118:119]
  s_waitcnt lgkmcnt(0)
  v_pk_add_f32 v[120:121], v[120:121], v[122:123]
  v_pk_add_f32 v[116:117], v[116:117], v[120:121]
  v_cvt_pk_bf16_f32 v116, v116, v117
  buffer_store_dword v116, v15, s[4:7], s53 offen
  s_barrier
  buffer_store_dword v116, v15, s[4:7], s77 offen sc1
  s_xor_b32 s53, s77, 0x18000
  buffer_store_dword v124, v15, s[4:7], s53 offen sc1
  s_add_u32 s54, s54, 1
  s_branch L_vo_top0
Lm_78:
  buffer_load_dwordx4 v[32:35], v1, s[4:7], s70 offen offset:0 sc1
  buffer_load_dwordx4 v[36:39], v1, s[4:7], s70 offen offset:1024 sc1
  s_add_u32 s55, s55, 1
  s_bitcmp1_b32 s55, 21
  s_cbranch_scc1 L_abort
  s_waitcnt vmcnt(0)
  s_branch Lm_76
Lm_79:
  buffer_load_dwordx4 v[36:39], v1, s[4:7], s70 offen offset:1024 sc1
  s_add_u32 s55, s55, 1
  s_bitcmp1_b32 s55, 21
  s_cbranch_scc1 L_abort
  s_waitcnt vmcnt(0)
  s_branch Lm_77
Lr_81:
  buffer_load_dwordx4 v[40:43], v1, s[4:7], s73 offen offset:0 sc1
  buffer_load_dwordx4 v[44:47], v1, s[4:7], s73 offen offset:1024 sc1
  s_add_u32 s55, s55, 1
  s_bitcmp1_b32 s55, 21
  s_cbranch_scc1 L_abort
  s_waitcnt vmcnt(0)
  v_max3_u32 v126, v40, v41, v42
  v_max3_u32 v126, v126, v43, v44
  v_max3_u32 v126, v126, v45, v46
  v_max_u32 v126, v126, v47
  v_cmp_eq_u32 vcc, -1, v126
  s_cbranch_vccnz Lr_81
  ds_write_b128 v4, v[40:43] offset:2048
  ds_write_b128 v4, v[44:47] offset:3072
  s_waitcnt lgkmcnt(0)
  s_branch Lr_80
Le_102:
  s_add_u32 s55, s55, 1
  s_bitcmp1_b32 s55, 21
  s_cbranch_scc1 L_abort
  buffer_load_dwordx4 v[32:35], v1, s[4:7], s70 offen offset:0 sc1
  buffer_load_dwordx4 v[36:39], v1, s[4:7], s70 offen offset:1024 sc1
  buffer_load_dwordx4 v[40:43], v1, s[4:7], s70 offen offset:2048 sc1
  buffer_load_dwordx4 v[44:47], v1, s[4:7], s70 offen offset:3072 sc1
  s_waitcnt vmcnt(0)
  v_cmp_eq_u32 vcc, -1, v35
  s_cbranch_vccnz Le_102
  s_branch Lb_86
Le_103:
  s_add_u32 s55, s55, 1
  s_bitcmp1_b32 s55, 21
  s_cbranch_scc1 L_abort
  buffer_load_dwordx4 v[36:39], v1, s[4:7], s70 offen offset:1024 sc1
  buffer_load_dwordx4 v[40:43], v1, s[4:7], s70 offen offset:2048 sc1
  buffer_load_dwordx4 v[44:47], v1, s[4:7], s70 offen offset:3072 sc1
  buffer_load_dwordx4 v[48:51], v1, s[4:7], s71 offen offset:0 sc1
  s_waitcnt vmcnt(0)
  v_cmp_eq_u32 vcc, -1, v39
  s_cbranch_vccnz Le_103
  s_branch Lb_87
Le_104:
  s_add_u32 s55, s55, 1
  s_bitcmp1_b32 s55, 21
  s_cbranch_scc1 L_abort
  buffer_load_dwordx4 v[40:43], v1, s[4:7], s70 offen offset:2048 sc1
  buffer_load_dwordx4 v[44:47], v1, s[4:7], s70 offen offset:3072 sc1
  buffer_load_dwordx4 v[48:51], v1, s[4:7], s71 offen offset:0 sc1
  buffer_load_dwordx4 v[52:55], v1, s[4:7], s71 offen offset:1024 sc1
  s_waitcnt vmcnt(0)
  v_cmp_eq_u32 vcc, -1, v43
  s_cbranch_vccnz Le_104
  s_branch Lb_88
Le_105:
  s_add_u32 s55, s55, 1
  s_bitcmp1_b32 s55, 21
  s_cbranch_scc1 L_abort
  buffer_load_dwordx4 v[44:47], v1, s[4:7], s70 offen offset:3072 sc1
  buffer_load_dwordx4 v[48:51], v1, s[4:7], s71 offen offset:0 sc1
  buffer_load_dwordx4 v[52:55], v1, s[4:7], s71 offen offset:1024 sc1
  buffer_load_dwordx4 v[56:59], v1, s[4:7], s71 offen offset:2048 sc1
  s_waitcnt vmcnt(0)
  v_cmp_eq_u32 vcc, -1, v47
  s_cbranch_vccnz Le_105
  s_branch Lb_89
Le_106:
  s_add_u32 s55, s55, 1
  s_bitcmp1_b32 s55, 21
  s_cbranch_scc1 L_abort
  buffer_load_dwordx4 v[48:51], v1, s[4:7], s71 offen offset:0 sc1
  buffer_load_dwordx4 v[52:55], v1, s[4:7], s71 offen offset:1024 sc1
  buffer_load_dwordx4 v[56:59], v1, s[4:7], s71 offen offset:2048 sc1
  buffer_load_dwordx4 v[60:63], v1, s[4:7], s71 offen offset:3072 sc1
  s_waitcnt vmcnt(0)
  v_cmp_eq_u32 vcc, -1, v51
  s_cbranch_vccnz Le_106
  s_branch Lb_90
Le_107:
  s_add_u32 s55, s55, 1
  s_bitcmp1_b32 s55, 21
  s_cbranch_scc1 L_abort
  buffer_load_dwordx4 v[52:55], v1, s[4:7], s71 offen offset:1024 sc1
  buffer_load_dwordx4 v[56:59], v1, s[4:7], s71 offen offset:2048 sc1
  buffer_load_dwordx4 v[60:63], v1, s[4:7], s71 offen offset:3072 sc1
  buffer_load_dwordx4 v[32:35], v1, s[4:7], s73 offen offset:0 sc1
  s_waitcnt vmcnt(0)
  v_cmp_eq_u32 vcc, -1, v55
  s_cbranch_vccnz Le_107
  s_branch Lb_91
Le_108:
  s_add_u32 s55, s55, 1
  s_bitcmp1_b32 s55, 21
  s_cbranch_scc1 L_abort
  buffer_load_dwordx4 v[56:59], v1, s[4:7], s71 offen offset:2048 sc1
  buffer_load_dwordx4 v[60:63], v1, s[4:7], s71 offen offset:3072 sc1
  buffer_load_dwordx4 v[32:35], v1, s[4:7], s73 offen offset:0 sc1
  buffer_load_dwordx4 v[36:39], v1, s[4:7], s73 offen offset:1024 sc1
  s_waitcnt vmcnt(0)
  v_cmp_eq_u32 vcc, -1, v59
  s_cbranch_vccnz Le_108
  s_branch Lb_92
Le_109:
  s_add_u32 s55, s55, 1
  s_bitcmp1_b32 s55, 21
  s_cbranch_scc1 L_abort
  buffer_load_dwordx4 v[60:63], v1, s[4:7], s71 offen offset:3072 sc1
  buffer_load_dwordx4 v[32:35], v1, s[4:7], s73 offen offset:0 sc1
  buffer_load_dwordx4 v[36:39], v1, s[4:7], s73 offen offset:1024 sc1
  buffer_load_dwordx4 v[40:43], v1, s[4:7], s73 offen offset:2048 sc1
  s_waitcnt vmcnt(0)
  v_cmp_eq_u32 vcc, -1, v63
  s_cbranch_vccnz Le_109
  s_branch Lb_93
Le_110:
  s_add_u32 s55, s55, 1
  s_bitcmp1_b32 s55, 21
  s_cbranch_scc1 L_abort
  buffer_load_dwordx4 v[32:35], v1, s[4:7], s73 offen offset:0 sc1
  buffer_load_dwordx4 v[36:39], v1, s[4:7], s73 offen offset:1024 sc1
  buffer_load_dwordx4 v[40:43], v1, s[4:7], s73 offen offset:2048 sc1
  buffer_load_dwordx4 v[44:47], v1, s[4:7], s73 offen offset:3072 sc1
  s_waitcnt vmcnt(0)
  v_cmp_eq_u32 vcc, -1, v35
  s_cbranch_vccnz Le_110
  s_branch Lb_94
Le_111:
  s_add_u32 s55, s55, 1
  s_bitcmp1_b32 s55, 21
  s_cbranch_scc1 L_abort
  buffer_load_dwordx4 v[36:39], v1, s[4:7], s73 offen offset:1024 sc1
  buffer_load_dwordx4 v[40:43], v1, s[4:7], s73 offen offset:2048 sc1
  buffer_load_dwordx4 v[44:47], v1, s[4:7], s73 offen offset:3072 sc1
  buffer_load_dwordx4 v[48:51], v1, s[4:7], s72 offen offset:0 sc1
  s_waitcnt vmcnt(0)
  v_cmp_eq_u32 vcc, -1, v39
  s_cbranch_vccnz Le_111
  s_branch Lb_95
Le_112:
  s_add_u32 s55, s55, 1
  s_bitcmp1_b32 s55, 21
  s_cbranch_scc1 L_abort
  buffer_load_dwordx4 v[40:43], v1, s[4:7], s73 offen offset:2048 sc1
  buffer_load_dwordx4 v[44:47], v1, s[4:7], s73 offen offset:3072 sc1
  buffer_load_dwordx4 v[48:51], v1, s[4:7], s72 offen offset:0 sc1
  buffer_load_dwordx4 v[52:55], v1, s[4:7], s72 offen offset:1024 sc1
  s_waitcnt vmcnt(0)
  v_cmp_eq_u32 vcc, -1, v43
  s_cbranch_vccnz Le_112
  s_branch Lb_96
Le_113:
  s_add_u32 s55, s55, 1
  s_bitcmp1_b32 s55, 21
  s_cbranch_scc1 L_abort
  buffer_load_dwordx4 v[44:47], v1, s[4:7], s73 offen offset:3072 sc1
  buffer_load_dwordx4 v[48:51], v1, s[4:7], s72 offen offset:0 sc1
  buffer_load_dwordx4 v[52:55], v1, s[4:7], s72 offen offset:1024 sc1
  buffer_load_dwordx4 v[56:59], v1, s[4:7], s72 offen offset:2048 sc1
  s_waitcnt vmcnt(0)
  v_cmp_eq_u32 vcc, -1, v47
  s_cbranch_vccnz Le_113
  s_branch Lb_97
Le_114:
  s_add_u32 s55, s55, 1
  s_bitcmp1_b32 s55, 21
  s_cbranch_scc1 L_abort
  buffer_load_dwordx4 v[48:51], v1, s[4:7], s72 offen offset:0 sc1
  buffer_load_dwordx4 v[52:55], v1, s[4:7], s72 offen offset:1024 sc1
  buffer_load_dwordx4 v[56:59], v1, s[4:7], s72 offen offset:2048 sc1
  buffer_load_dwordx4 v[60:63], v1, s[4:7], s72 offen offset:3072 sc1
  s_waitcnt vmcnt(0)
  v_cmp_eq_u32 vcc, -1, v51
  s_cbranch_vccnz Le_114
  s_branch Lb_98
Le_115:
  s_add_u32 s55, s55, 1
  s_bitcmp1_b32 s55, 21
  s_cbranch_scc1 L_abort
  buffer_load_dwordx4 v[52:55], v1, s[4:7], s72 offen offset:1024 sc1
  buffer_load_dwordx4 v[56:59], v1, s[4:7], s72 offen offset:2048 sc1
  buffer_load_dwordx4 v[60:63], v1, s[4:7], s72 offen offset:3072 sc1
  s_waitcnt vmcnt(0)
  v_cmp_eq_u32 vcc, -1, v55
  s_cbranch_vccnz Le_115
  s_branch Lb_99
Le_116:
  s_add_u32 s55, s55, 1
  s_bitcmp1_b32 s55, 21
  s_cbranch_scc1 L_abort
  buffer_load_dwordx4 v[56:59], v1, s[4:7], s72 offen offset:2048 sc1
  buffer_load_dwordx4 v[60:63], v1, s[4:7], s72 offen offset:3072 sc1
  s_waitcnt vmcnt(0)
  v_cmp_eq_u32 vcc, -1, v59
  s_cbranch_vccnz Le_116
  s_branch Lb_100
Le_117:
  s_add_u32 s55, s55, 1
  s_bitcmp1_b32 s55, 21
  s_cbranch_scc1 L_abort
  buffer_load_dwordx4 v[60:63], v1, s[4:7], s72 offen offset:3072 sc1
  s_waitcnt vmcnt(0)
  v_cmp_eq_u32 vcc, -1, v63
  s_cbranch_vccnz Le_117
  s_branch Lb_101
Lg_85:
  v_mov_b32 v24, 0
  v_mov_b32 v25, 0
  v_mov_b32 v26, 0
  v_mov_b32 v27, 0
  v_mov_b32 v28, 0
  v_mov_b32 v29, 0
  v_mov_b32 v30, 0
  v_mov_b32 v31, 0
  v_mov_b32 v126, 0
  s_add_u32 s55, s55, 1
  s_bitcmp1_b32 s55, 21
  s_cbranch_scc1 L_abort
  s_branch Lg_84
L_vo_top1:
  s_and_b32 s70, s54, 3
  s_lshl_b32 s70, s70, 13
  s_add_u32 s70, s70, s66
  s_and_b32 s73, s54, 3
  s_lshl_b32 s73, s73, 14
  s_add_u32 s73, s73, s67
  s_waitcnt vmcnt(2)
  buffer_load_dwordx4 v[32:35], v1, s[4:7], s70 offen offset:0 sc1
  buffer_load_dwordx4 v[36:39], v1, s[4:7], s70 offen offset:1024 sc1
  s_waitcnt vmcnt(1)
Lm_118:
  v_max3_u32 v126, v32, v33, v34
  v_max_u32 v126, v126, v35
  v_cmp_eq_u32 vcc, -1, v126
  ds_write_b128 v4, v[32:35] offset:0
  s_cbranch_vccnz Lm_120
  s_waitcnt vmcnt(0)
Lm_119:
  v_max3_u32 v126, v36, v37, v38
  v_max_u32 v126, v126, v39
  v_cmp_eq_u32 vcc, -1, v126
  ds_write_b128 v4, v[36:39] offset:1024
  s_cbranch_vccnz Lm_121
  v_smfmac_f32_16x16x64_bf16 v[16:19], v[32:35], v[128:135], v3
  buffer_load_dwordx4 v[40:43], v1, s[4:7], s73 offen offset:0 sc1
  s_waitcnt lgkmcnt(2)
  v_smfmac_f32_16x16x64_bf16 v[20:23], v[32:35], v[80:87], v3
  buffer_load_dwordx4 v[44:47], v1, s[4:7], s73 offen offset:1024 sc1
L_vo_e1:
  s_waitcnt lgkmcnt(0)
  s_barrier
  ds_read_b128 v[56:59], v5 offset:0
  ds_read_b128 v[60:63], v5 offset:1024
  v_smfmac_f32_16x16x64_bf16 v[16:19], v[36:39], v[136:143], v3
  ds_read_b128 v[48:51], v6 offset:0
  v_smfmac_f32_16x16x64_bf16 v[20:23], v[36:39], v[88:95], v3
  ds_read_b128 v[52:55], v6 offset:1024
  ds_read_b128 v[80:83], v8 offset:16384
  ds_read_b128 v[84:87], v8 offset:17408
  ds_read_b128 v[88:91], v8 offset:24576
  s_waitcnt lgkmcnt(6)
  v_smfmac_f32_16x16x64_bf16 v[16:19], v[56:59], v[160:167], v3
  ds_read_b128 v[92:95], v8 offset:25600
  v_smfmac_f32_16x16x64_bf16 v[20:23], v[56:59], v[96:103], v3
  ds_read_b128 v[56:59], v7 offset:0
  s_waitcnt lgkmcnt(7)
  v_smfmac_f32_16x16x64_bf16 v[16:19], v[60:63], v[168:175], v3
  ds_read_b128 v[96:99], v11 offset:0
  v_smfmac_f32_16x16x64_bf16 v[20:23], v[60:63], v[104:111], v3
  ds_read_b128 v[100:103], v11 offset:1024
  s_waitcnt lgkmcnt(8)
  v_smfmac_f32_16x16x64_bf16 v[16:19], v[48:51], v[192:199], v3
  ds_read_b128 v[60:63], v7 offset:1024
  v_smfmac_f32_16x16x64_bf16 v[20:23], v[48:51], v[64:71], v3
  ds_read_b128 v[104:107], v11 offset:8192
  s_waitcnt lgkmcnt(9)
  v_smfmac_f32_16x16x64_bf16 v[16:19], v[52:55], v[200:207], v3
  ds_read_b128 v[108:111], v11 offset:9216
  v_smfmac_f32_16x16x64_bf16 v[20:23], v[52:55], v[72:79], v3
  s_waitcnt lgkmcnt(3)
  v_smfmac_f32_16x16x64_bf16 v[16:19], v[56:59], v[224:231], v3
  s_waitcnt vmcnt(1)
  ds_write_b128 v4, v[40:43] offset:2048
  v_max_u32 v126, v40, v41
  v_smfmac_f32_16x16x64_bf16 v[20:23], v[56:59], v[96:103], v3
  s_waitcnt vmcnt(0)
  ds_write_b128 v4, v[44:47] offset:3072
  v_max3_u32 v126, v126, v42, v43
  v_max3_u32 v126, v126, v44, v45
  v_max3_u32 v126, v126, v46, v47
  s_waitcnt lgkmcnt(2)
  v_smfmac_f32_16x16x64_bf16 v[16:19], v[60:63], v[232:239], v3
  ds_read_b128 v[96:99], v9 offset:16384
  v_cmp_eq_u32 vcc, -1, v126
  v_smfmac_f32_16x16x64_bf16 v[20:23], v[60:63], v[104:111], v3
  ds_read_b128 v[100:103], v9 offset:17408
  ds_read_b128 v[104:107], v9 offset:24576
  s_cbranch_vccnz Lr_123
Lr_122:
  v_smfmac_f32_16x16x64_bf16 v[16:19], v[40:43], v[144:151], v3
  s_waitcnt lgkmcnt(3)
  s_barrier
  ds_read_b128 v[56:59], v5 offset:2048
  v_smfmac_f32_16x16x64_bf16 v[20:23], v[40:43], v[80:87], v3
  ds_read_b128 v[60:63], v5 offset:3072
  v_smfmac_f32_16x16x64_bf16 v[16:19], v[44:47], v[152:159], v3
  ds_read_b128 v[108:111], v9 offset:25600
  v_smfmac_f32_16x16x64_bf16 v[20:23], v[44:47], v[88:95], v3
  ds_read_b128 v[48:51], v6 offset:2048
  ds_read_b128 v[80:83], v10 offset:16384
  ds_read_b128 v[84:87], v10 offset:17408
  s_waitcnt lgkmcnt(5)
  v_smfmac_f32_16x16x64_bf16 v[16:19], v[56:59], v[176:183], v3
  ds_read_b128 v[52:55], v6 offset:3072
  ds_read_b128 v[88:91], v10 offset:24576
  v_smfmac_f32_16x16x64_bf16 v[20:23], v[56:59], v[96:103], v3
  ds_read_b128 v[92:95], v10 offset:25600
  s_waitcnt lgkmcnt(6)
  v_smfmac_f32_16x16x64_bf16 v[16:19], v[60:63], v[184:191], v3
  ds_read_b128 v[56:59], v7 offset:2048
  ds_read_b128 v[96:99], v11 offset:16384
  v_smfmac_f32_16x16x64_bf16 v[20:23], v[60:63], v[104:111], v3
  ds_read_b128 v[100:103], v11 offset:17408
  s_waitcnt lgkmcnt(6)
  v_smfmac_f32_16x16x64_bf16 v[16:19], v[48:51], v[208:215], v3
  ds_read_b128 v[60:63], v7 offset:3072
  ds_read_b128 v[104:107], v11 offset:24576
  v_smfmac_f32_16x16x64_bf16 v[20:23], v[48:51], v[80:87], v3
  ds_read_b128 v[108:111], v11 offset:25600
  s_waitcnt lgkmcnt(6)
  v_smfmac_f32_16x16x64_bf16 v[16:19], v[52:55], v[216:223], v3
  s_and_b32 s70, s54, 3
  s_lshl_b32 s70, s70, 15
  s_add_u32 s70, s70, s69
  v_smfmac_f32_16x16x64_bf16 v[20:23], v[52:55], v[88:95], v3
  s_waitcnt lgkmcnt(3)
  v_smfmac_f32_16x16x64_bf16 v[16:19], v[56:59], v[240:247], v3
  s_waitcnt lgkmcnt(2)
  v_smfmac_f32_16x16x64_bf16 v[16:19], v[60:63], v[248:255], v3
  s_nop 2
  v_smfmac_f32_16x16x64_bf16 v[20:23], v[56:59], v[96:103], v3
  s_waitcnt lgkmcnt(0)
  s_nop 1
  v_smfmac_f32_16x16x64_bf16 v[20:23], v[60:63], v[104:111], v3
  v_add_f32 v16, v16, v17
  v_add_f32 v18, v18, v19
  v_cvt_pk_bf16_f32 v16, v16, v18
  buffer_store_dword v16, v14, s[4:7], s70 offen offset:0 sc1
  v_mov_b32 v0, v0
  v_mov_b32 v0, v0
  v_mov_b32 v0, v0
  v_mov_b32 v0, v0
  v_add_f32 v20, v20, v21
  v_add_f32 v22, v22, v23
  v_cvt_pk_bf16_f32 v20, v20, v22
  buffer_store_dword v20, v14, s[4:7], s70 offen offset:1024 sc1
  s_cmp_eq_u32 s54, 63
  s_cbranch_scc1 L_vo_end
  s_xor_b32 s70, s70, 0x10000
  buffer_store_dword v124, v14, s[4:7], s70 offen sc1
  buffer_store_dword v124, v14, s[4:7], s70 offen offset:1024 sc1
  s_add_u32 s70, s54, 2
  s_and_b32 s70, s70, 3
  s_lshl_b32 s70, s70, 13
  s_add_u32 s70, s70, s74
  buffer_store_dword v124, v15, s[4:7], s70 offen sc1
  s_and_b32 s70, s54, 3
  s_lshl_b32 s70, s70, 15
  s_add_u32 s70, s70, s68
  v_mov_b32 v16, 0
  v_mov_b32 v17, 0
  v_mov_b32 v18, 0
  v_mov_b32 v19, 0
  v_mov_b32 v20, 0
  v_mov_b32 v21, 0
  v_mov_b32 v22, 0
  v_mov_b32 v23, 0
  v_mov_b32 v24, 0
  v_mov_b32 v25, 0
  v_mov_b32 v26, 0
  v_mov_b32 v27, 0
  v_mov_b32 v28, 0
  v_mov_b32 v29, 0
  v_mov_b32 v30, 0
  v_mov_b32 v31, 0
  s_add_u32 s56, s54, 1
  v_mov_b32 v125, s56
  v_mov_b32 v126, 0
  v_and_b32 v112, 15, v0
  v_lshlrev_b32 v112, 2, v112
  v_lshl_add_u32 v112, s50, 7, v112
  s_add_u32 s56, s54, 1
  buffer_load_dword v113, v112, s[4:7], s3 offen sc1
  buffer_load_dword v114, v112, s[4:7], s3 offen sc1
  buffer_load_dword v115, v112, s[4:7], s3 offen sc1
  buffer_load_dword v116, v112, s[4:7], s3 offen sc1
Lh_124:
  s_waitcnt vmcnt(3)
  v_cmp_gt_u32 vcc, s56, v113
  s_cbranch_vccz Lh_125
  buffer_load_dword v113, v112, s[4:7], s3 offen sc1
  s_nop 1
  s_waitcnt vmcnt(3)
  v_cmp_gt_u32 vcc, s56, v114
  s_cbranch_vccz Lh_125
  buffer_load_dword v114, v112, s[4:7], s3 offen sc1
  s_nop 1
  s_waitcnt vmcnt(3)
  v_cmp_gt_u32 vcc, s56, v115
  s_cbranch_vccz Lh_125
  buffer_load_dword v115, v112, s[4:7], s3 offen sc1
  s_nop 1
  s_waitcnt vmcnt(3)
  v_cmp_gt_u32 vcc, s56, v116
  s_cbranch_vccz Lh_125
  buffer_load_dword v116, v112, s[4:7], s3 offen sc1
  s_nop 1
  s_waitcnt vmcnt(3)
  v_cmp_gt_u32 vcc, s56, v113
  s_cbranch_vccz Lh_125
  buffer_load_dword v113, v112, s[4:7], s3 offen sc1
  s_nop 1
  s_waitcnt vmcnt(3)
  v_cmp_gt_u32 vcc, s56, v114
  s_cbranch_vccz Lh_125
  buffer_load_dword v114, v112, s[4:7], s3 offen sc1
  s_nop 1
  s_waitcnt vmcnt(3)
  v_cmp_gt_u32 vcc, s56, v115
  s_cbranch_vccz Lh_125
  buffer_load_dword v115, v112, s[4:7], s3 offen sc1
  s_nop 1
  s_waitcnt vmcnt(3)
  v_cmp_gt_u32 vcc, s56, v116
  s_cbranch_vccz Lh_125
  buffer_load_dword v116, v112, s[4:7], s3 offen sc1
  s_nop 1
  s_waitcnt vmcnt(3)
  v_cmp_gt_u32 vcc, s56, v113
  s_cbranch_vccz Lh_125
  buffer_load_dword v113, v112, s[4:7], s3 offen sc1
  s_nop 1
  s_waitcnt vmcnt(3)
  v_cmp_gt_u32 vcc, s56, v114
  s_cbranch_vccz Lh_125
  buffer_load_dword v114, v112, s[4:7], s3 offen sc1
  s_nop 1
  s_waitcnt vmcnt(3)
  v_cmp_gt_u32 vcc, s56, v115
  s_cbranch_vccz Lh_125
  buffer_load_dword v115, v112, s[4:7], s3 offen sc1
  s_nop 1
  s_waitcnt vmcnt(3)
  v_cmp_gt_u32 vcc, s56, v116
  s_cbranch_vccz Lh_125
  buffer_load_dword v116, v112, s[4:7], s3 offen sc1
  s_add_u32 s55, s55, 1
  s_bitcmp1_b32 s55, 21
  s_cbranch_scc1 L_abort
  s_branch Lh_124
.p2align 6
Lh_125:
  s_barrier
Lg_126:
  buffer_load_dwordx4 v[32:35], v1, s[4:7], s70 offen offset:0 sc1
  s_add_u32 s71, s70, 4096
  s_and_b32 s73, s54, 3
  s_lshl_b32 s73, s73, 16
  s_add_u32 s73, s73, s38
  s_add_u32 s72, s73, 4096
  buffer_load_dwordx4 v[36:39], v1, s[4:7], s70 offen offset:1024 sc1
  s_add_u32 s53, s54, 1
  s_and_b32 s53, s53, 3
  s_lshl_b32 s53, s53, 13
  s_add_u32 s53, s53, s74
  buffer_load_dwordx4 v[40:43], v1, s[4:7], s70 offen offset:2048 sc1
  s_add_u32 s77, s54, 1
  s_and_b32 s77, s77, 3
  s_lshl_b32 s77, s77, 14
  s_add_u32 s77, s77, s75
  buffer_load_dwordx4 v[44:47], v1, s[4:7], s70 offen offset:3072 sc1
  ds_read_b128 v[80:83], v8 offset:0
  ds_read_b128 v[84:87], v8 offset:1024
  buffer_load_dwordx4 v[48:51], v1, s[4:7], s71 offen offset:0 sc1
  ds_read_b128 v[88:91], v8 offset:8192
  ds_read_b128 v[92:95], v8 offset:9216
  buffer_load_dwordx4 v[52:55], v1, s[4:7], s71 offen offset:1024 sc1
  ds_read_b128 v[96:99], v9 offset:0
  ds_read_b128 v[100:103], v9 offset:1024
  buffer_load_dwordx4 v[56:59], v1, s[4:7], s71 offen offset:2048 sc1
  ds_read_b128 v[104:107], v9 offset:8192
  ds_read_b128 v[108:111], v9 offset:9216
  buffer_load_dwordx4 v[60:63], v1, s[4:7], s71 offen offset:3072 sc1
  s_waitcnt vmcnt(7)
  v_cmp_eq_u32 vcc, -1, v35
  s_cbranch_vccnz Le_144
Lb_128:
  s_waitcnt vmcnt(6)
  v_cmp_eq_u32 vcc, -1, v39
  v_smfmac_f32_16x16x64_bf16 v[24:27], v[32:35], a[0:7], v3
  v_max3_u32 v126, v126, v32, v33
  v_smfmac_f32_16x16x64_bf16 v[28:31], v[32:35], a[8:15], v3
  v_max_u32 v126, v126, v34
  buffer_load_dwordx4 v[32:35], v1, s[4:7], s73 offen offset:0 sc1
  s_cbranch_vccnz Le_145
Lb_129:
  s_waitcnt vmcnt(6)
  v_cmp_eq_u32 vcc, -1, v43
  v_smfmac_f32_16x16x64_bf16 v[24:27], v[36:39], a[16:23], v3
  v_max3_u32 v126, v126, v36, v37
  v_smfmac_f32_16x16x64_bf16 v[28:31], v[36:39], a[24:31], v3
  v_max_u32 v126, v126, v38
  buffer_load_dwordx4 v[36:39], v1, s[4:7], s73 offen offset:1024 sc1
  s_cbranch_vccnz Le_146
Lb_130:
  s_waitcnt vmcnt(6)
  v_cmp_eq_u32 vcc, -1, v47
  v_smfmac_f32_16x16x64_bf16 v[24:27], v[40:43], a[32:39], v3
  v_max3_u32 v126, v126, v40, v41
  v_smfmac_f32_16x16x64_bf16 v[28:31], v[40:43], a[40:47], v3
  v_max_u32 v126, v126, v42
  buffer_load_dwordx4 v[40:43], v1, s[4:7], s73 offen offset:2048 sc1
  s_cbranch_vccnz Le_147
Lb_131:
  s_waitcnt vmcnt(6)
  v_cmp_eq_u32 vcc, -1, v51
  v_smfmac_f32_16x16x64_bf16 v[24:27], v[44:47], a[48:55], v3
  v_max3_u32 v126, v126, v44, v45
  v_smfmac_f32_16x16x64_bf16 v[28:31], v[44:47], a[56:63], v3
  v_max_u32 v126, v126, v46
  buffer_load_dwordx4 v[44:47], v1, s[4:7], s73 offen offset:3072 sc1
  s_cbranch_vccnz Le_148
Lb_132:
  s_waitcnt vmcnt(6)
  v_cmp_eq_u32 vcc, -1, v55
  v_smfmac_f32_16x16x64_bf16 v[24:27], v[48:51], a[64:71], v3
  v_max3_u32 v126, v126, v48, v49
  v_smfmac_f32_16x16x64_bf16 v[28:31], v[48:51], a[72:79], v3
  v_max_u32 v126, v126, v50
  buffer_load_dwordx4 v[48:51], v1, s[4:7], s72 offen offset:0 sc1
  s_cbranch_vccnz Le_149
Lb_133:
  s_waitcnt vmcnt(6)
  v_cmp_eq_u32 vcc, -1, v59
  v_smfmac_f32_16x16x64_bf16 v[24:27], v[52:55], a[80:87], v3
  v_max3_u32 v126, v126, v52, v53
  v_smfmac_f32_16x16x64_bf16 v[28:31], v[52:55], a[88:95], v3
  v_max_u32 v126, v126, v54
  buffer_load_dwordx4 v[52:55], v1, s[4:7], s72 offen offset:1024 sc1
  s_cbranch_vccnz Le_150
Lb_134:
  s_waitcnt vmcnt(6)
  v_cmp_eq_u32 vcc, -1, v63
  v_smfmac_f32_16x16x64_bf16 v[24:27], v[56:59], a[96:103], v3
  v_max3_u32 v126, v126, v56, v57
  v_smfmac_f32_16x16x64_bf16 v[28:31], v[56:59], a[104:111], v3
  v_max_u32 v126, v126, v58
  buffer_load_dwordx4 v[56:59], v1, s[4:7], s72 offen offset:2048 sc1
  s_cbranch_vccnz Le_151
Lb_135:
  s_waitcnt vmcnt(6)
  v_cmp_eq_u32 vcc, -1, v35
  v_smfmac_f32_16x16x64_bf16 v[24:27], v[60:63], a[112:119], v3
  v_max3_u32 v126, v126, v60, v61
  v_smfmac_f32_16x16x64_bf16 v[28:31], v[60:63], a[120:127], v3
  v_max_u32 v126, v126, v62
  buffer_load_dwordx4 v[60:63], v1, s[4:7], s72 offen offset:3072 sc1
  s_cbranch_vccnz Le_152
Lb_136:
  s_waitcnt vmcnt(6)
  v_cmp_eq_u32 vcc, -1, v39
  v_smfmac_f32_16x16x64_bf16 v[24:27], v[32:35], a[128:135], v3
  v_max3_u32 v126, v126, v32, v33
  v_smfmac_f32_16x16x64_bf16 v[28:31], v[32:35], a[136:143], v3
  v_max_u32 v126, v126, v34
  s_cbranch_vccnz Le_153
Lb_137:
  s_waitcnt vmcnt(5)
  v_cmp_eq_u32 vcc, -1, v43
  v_smfmac_f32_16x16x64_bf16 v[24:27], v[36:39], a[144:151], v3
  v_max3_u32 v126, v126, v36, v37
  v_smfmac_f32_16x16x64_bf16 v[28:31], v[36:39], a[152:159], v3
  v_max_u32 v126, v126, v38
  s_cbranch_vccnz Le_154
Lb_138:
  s_waitcnt vmcnt(4)
  v_cmp_eq_u32 vcc, -1, v47
  v_smfmac_f32_16x16x64_bf16 v[24:27], v[40:43], a[160:167], v3
  v_max3_u32 v126, v126, v40, v41
  v_smfmac_f32_16x16x64_bf16 v[28:31], v[40:43], a[168:175], v3
  v_max_u32 v126, v126, v42
  s_cbranch_vccnz Le_155
Lb_139:
  s_waitcnt vmcnt(3)
  v_cmp_eq_u32 vcc, -1, v51
  v_smfmac_f32_16x16x64_bf16 v[24:27], v[44:47], a[176:183], v3
  v_max3_u32 v126, v126, v44, v45
  v_smfmac_f32_16x16x64_bf16 v[28:31], v[44:47], a[184:191], v3
  v_max_u32 v126, v126, v46
  s_cbranch_vccnz Le_156
Lb_140:
  s_waitcnt vmcnt(2)
  v_cmp_eq_u32 vcc, -1, v55
  v_smfmac_f32_16x16x64_bf16 v[24:27], v[48:51], a[192:199], v3
  v_max3_u32 v126, v126, v48, v49
  v_smfmac_f32_16x16x64_bf16 v[28:31], v[48:51], a[200:207], v3
  v_max_u32 v126, v126, v50
  s_cbranch_vccnz Le_157
Lb_141:
  s_waitcnt vmcnt(1)
  v_cmp_eq_u32 vcc, -1, v59
  v_smfmac_f32_16x16x64_bf16 v[24:27], v[52:55], a[208:215], v3
  v_max3_u32 v126, v126, v52, v53
  v_smfmac_f32_16x16x64_bf16 v[28:31], v[52:55], a[216:223], v3
  v_max_u32 v126, v126, v54
  s_cbranch_vccnz Le_158
Lb_142:
  s_waitcnt vmcnt(0)
  v_cmp_eq_u32 vcc, -1, v63
  v_smfmac_f32_16x16x64_bf16 v[24:27], v[56:59], a[224:231], v3
  v_max3_u32 v126, v126, v56, v57
  v_smfmac_f32_16x16x64_bf16 v[28:31], v[56:59], a[232:239], v3
  v_max_u32 v126, v126, v58
  s_cbranch_vccnz Le_159
Lb_143:
  v_smfmac_f32_16x16x64_bf16 v[24:27], v[60:63], a[240:247], v3
  v_max3_u32 v126, v126, v60, v61
  v_smfmac_f32_16x16x64_bf16 v[28:31], v[60:63], a[248:255], v3
  buffer_store_dword v125, v127, s[4:7], s62 offen sc1
  v_max_u32 v126, v126, v62
  v_cmp_eq_u32 vcc, -1, v126
  v_mov_b32 v0, v0
  v_mov_b32 v0, v0
  v_mov_b32 v0, v0
  v_add_f32 v116, v24, v25
  v_add_f32 v118, v26, v27
  v_add_f32 v117, v28, v29
  v_add_f32 v119, v30, v31
  ds_write_b128 v12, v[116:119]
  s_cbranch_vccnz Lg_127
  s_waitcnt lgkmcnt(0)
  s_barrier
  ds_read_b64 v[116:117], v13 offset:0
  ds_read_b64 v[118:119], v13 offset:1536
  ds_read_b64 v[120:121], v13 offset:3072
  ds_read_b64 v[122:123], v13 offset:4608
  s_waitcnt lgkmcnt(2)
  v_pk_add_f32 v[116:117], v[116:117], v[118:119]
  s_waitcnt lgkmcnt(0)
  v_pk_add_f32 v[120:121], v[120:121], v[122:123]
  v_pk_add_f32 v[116:117], v[116:117], v[120:121]
  v_cvt_pk_bf16_f32 v116, v116, v117
  buffer_store_dword v116, v15, s[4:7], s53 offen sc1
  s_barrier
  buffer_store_dword v116, v15, s[4:7], s77 offen sc1
  s_xor_b32 s53, s77, 0x18000
  buffer_store_dword v124, v15, s[4:7], s53 offen sc1
  s_add_u32 s54, s54, 1
  s_branch L_vo_top1
Lm_120:
  buffer_load_dwordx4 v[32:35], v1, s[4:7], s70 offen offset:0 sc1
  buffer_load_dwordx4 v[36:39], v1, s[4:7], s70 offen offset:1024 sc1
  s_add_u32 s55, s55, 1
  s_bitcmp1_b32 s55, 21
  s_cbranch_scc1 L_abort
  s_waitcnt vmcnt(0)
  s_branch Lm_118
Lm_121:
  buffer_load_dwordx4 v[36:39], v1, s[4:7], s70 offen offset:1024 sc1
  s_add_u32 s55, s55, 1
  s_bitcmp1_b32 s55, 21
  s_cbranch_scc1 L_abort
  s_waitcnt vmcnt(0)
  s_branch Lm_119
Lr_123:
  buffer_load_dwordx4 v[40:43], v1, s[4:7], s73 offen offset:0 sc1
  buffer_load_dwordx4 v[44:47], v1, s[4:7], s73 offen offset:1024 sc1
  s_add_u32 s55, s55, 1
  s_bitcmp1_b32 s55, 21
  s_cbranch_scc1 L_abort
  s_waitcnt vmcnt(0)
  v_max3_u32 v126, v40, v41, v42
  v_max3_u32 v126, v126, v43, v44
  v_max3_u32 v126, v126, v45, v46
  v_max_u32 v126, v126, v47
  v_cmp_eq_u32 vcc, -1, v126
  s_cbranch_vccnz Lr_123
  ds_write_b128 v4, v[40:43] offset:2048
  ds_write_b128 v4, v[44:47] offset:3072
  s_waitcnt lgkmcnt(0)
  s_branch Lr_122
Le_144:
  s_add_u32 s55, s55, 1
  s_bitcmp1_b32 s55, 21
  s_cbranch_scc1 L_abort
  buffer_load_dwordx4 v[32:35], v1, s[4:7], s70 offen offset:0 sc1
  buffer_load_dwordx4 v[36:39], v1, s[4:7], s70 offen offset:1024 sc1
  buffer_load_dwordx4 v[40:43], v1, s[4:7], s70 offen offset:2048 sc1
  buffer_load_dwordx4 v[44:47], v1, s[4:7], s70 offen offset:3072 sc1
  s_waitcnt vmcnt(0)
  v_cmp_eq_u32 vcc, -1, v35
  s_cbranch_vccnz Le_144
  s_branch Lb_128
Le_145:
  s_add_u32 s55, s55, 1
  s_bitcmp1_b32 s55, 21
  s_cbranch_scc1 L_abort
  buffer_load_dwordx4 v[36:39], v1, s[4:7], s70 offen offset:1024 sc1
  buffer_load_dwordx4 v[40:43], v1, s[4:7], s70 offen offset:2048 sc1
  buffer_load_dwordx4 v[44:47], v1, s[4:7], s70 offen offset:3072 sc1
  buffer_load_dwordx4 v[48:51], v1, s[4:7], s71 offen offset:0 sc1
  s_waitcnt vmcnt(0)
  v_cmp_eq_u32 vcc, -1, v39
  s_cbranch_vccnz Le_145
  s_branch Lb_129
Le_146:
  s_add_u32 s55, s55, 1
  s_bitcmp1_b32 s55, 21
  s_cbranch_scc1 L_abort
  buffer_load_dwordx4 v[40:43], v1, s[4:7], s70 offen offset:2048 sc1
  buffer_load_dwordx4 v[44:47], v1, s[4:7], s70 offen offset:3072 sc1
  buffer_load_dwordx4 v[48:51], v1, s[4:7], s71 offen offset:0 sc1
  buffer_load_dwordx4 v[52:55], v1, s[4:7], s71 offen offset:1024 sc1
  s_waitcnt vmcnt(0)
  v_cmp_eq_u32 vcc, -1, v43
  s_cbranch_vccnz Le_146
  s_branch Lb_130
Le_147:
  s_add_u32 s55, s55, 1
  s_bitcmp1_b32 s55, 21
  s_cbranch_scc1 L_abort
  buffer_load_dwordx4 v[44:47], v1, s[4:7], s70 offen offset:3072 sc1
  buffer_load_dwordx4 v[48:51], v1, s[4:7], s71 offen offset:0 sc1
  buffer_load_dwordx4 v[52:55], v1, s[4:7], s71 offen offset:1024 sc1
  buffer_load_dwordx4 v[56:59], v1, s[4:7], s71 offen offset:2048 sc1
  s_waitcnt vmcnt(0)
  v_cmp_eq_u32 vcc, -1, v47
  s_cbranch_vccnz Le_147
  s_branch Lb_131
Le_148:
  s_add_u32 s55, s55, 1
  s_bitcmp1_b32 s55, 21
  s_cbranch_scc1 L_abort
  buffer_load_dwordx4 v[48:51], v1, s[4:7], s71 offen offset:0 sc1
  buffer_load_dwordx4 v[52:55], v1, s[4:7], s71 offen offset:1024 sc1
  buffer_load_dwordx4 v[56:59], v1, s[4:7], s71 offen offset:2048 sc1
  buffer_load_dwordx4 v[60:63], v1, s[4:7], s71 offen offset:3072 sc1
  s_waitcnt vmcnt(0)
  v_cmp_eq_u32 vcc, -1, v51
  s_cbranch_vccnz Le_148
  s_branch Lb_132
Le_149:
  s_add_u32 s55, s55, 1
  s_bitcmp1_b32 s55, 21
  s_cbranch_scc1 L_abort
  buffer_load_dwordx4 v[52:55], v1, s[4:7], s71 offen offset:1024 sc1
  buffer_load_dwordx4 v[56:59], v1, s[4:7], s71 offen offset:2048 sc1
  buffer_load_dwordx4 v[60:63], v1, s[4:7], s71 offen offset:3072 sc1
  buffer_load_dwordx4 v[32:35], v1, s[4:7], s73 offen offset:0 sc1
  s_waitcnt vmcnt(0)
  v_cmp_eq_u32 vcc, -1, v55
  s_cbranch_vccnz Le_149
  s_branch Lb_133
Le_150:
  s_add_u32 s55, s55, 1
  s_bitcmp1_b32 s55, 21
  s_cbranch_scc1 L_abort
  buffer_load_dwordx4 v[56:59], v1, s[4:7], s71 offen offset:2048 sc1
  buffer_load_dwordx4 v[60:63], v1, s[4:7], s71 offen offset:3072 sc1
  buffer_load_dwordx4 v[32:35], v1, s[4:7], s73 offen offset:0 sc1
  buffer_load_dwordx4 v[36:39], v1, s[4:7], s73 offen offset:1024 sc1
  s_waitcnt vmcnt(0)
  v_cmp_eq_u32 vcc, -1, v59
  s_cbranch_vccnz Le_150
  s_branch Lb_134
Le_151:
  s_add_u32 s55, s55, 1
  s_bitcmp1_b32 s55, 21
  s_cbranch_scc1 L_abort
  buffer_load_dwordx4 v[60:63], v1, s[4:7], s71 offen offset:3072 sc1
  buffer_load_dwordx4 v[32:35], v1, s[4:7], s73 offen offset:0 sc1
  buffer_load_dwordx4 v[36:39], v1, s[4:7], s73 offen offset:1024 sc1
  buffer_load_dwordx4 v[40:43], v1, s[4:7], s73 offen offset:2048 sc1
  s_waitcnt vmcnt(0)
  v_cmp_eq_u32 vcc, -1, v63
  s_cbranch_vccnz Le_151
  s_branch Lb_135
Le_152:
  s_add_u32 s55, s55, 1
  s_bitcmp1_b32 s55, 21
  s_cbranch_scc1 L_abort
  buffer_load_dwordx4 v[32:35], v1, s[4:7], s73 offen offset:0 sc1
  buffer_load_dwordx4 v[36:39], v1, s[4:7], s73 offen offset:1024 sc1
  buffer_load_dwordx4 v[40:43], v1, s[4:7], s73 offen offset:2048 sc1
  buffer_load_dwordx4 v[44:47], v1, s[4:7], s73 offen offset:3072 sc1
  s_waitcnt vmcnt(0)
  v_cmp_eq_u32 vcc, -1, v35
  s_cbranch_vccnz Le_152
  s_branch Lb_136
Le_153:
  s_add_u32 s55, s55, 1
  s_bitcmp1_b32 s55, 21
  s_cbranch_scc1 L_abort
  buffer_load_dwordx4 v[36:39], v1, s[4:7], s73 offen offset:1024 sc1
  buffer_load_dwordx4 v[40:43], v1, s[4:7], s73 offen offset:2048 sc1
  buffer_load_dwordx4 v[44:47], v1, s[4:7], s73 offen offset:3072 sc1
  buffer_load_dwordx4 v[48:51], v1, s[4:7], s72 offen offset:0 sc1
  s_waitcnt vmcnt(0)
  v_cmp_eq_u32 vcc, -1, v39
  s_cbranch_vccnz Le_153
  s_branch Lb_137
Le_154:
  s_add_u32 s55, s55, 1
  s_bitcmp1_b32 s55, 21
  s_cbranch_scc1 L_abort
  buffer_load_dwordx4 v[40:43], v1, s[4:7], s73 offen offset:2048 sc1
  buffer_load_dwordx4 v[44:47], v1, s[4:7], s73 offen offset:3072 sc1
  buffer_load_dwordx4 v[48:51], v1, s[4:7], s72 offen offset:0 sc1
  buffer_load_dwordx4 v[52:55], v1, s[4:7], s72 offen offset:1024 sc1
  s_waitcnt vmcnt(0)
  v_cmp_eq_u32 vcc, -1, v43
  s_cbranch_vccnz Le_154
  s_branch Lb_138
Le_155:
  s_add_u32 s55, s55, 1
  s_bitcmp1_b32 s55, 21
  s_cbranch_scc1 L_abort
  buffer_load_dwordx4 v[44:47], v1, s[4:7], s73 offen offset:3072 sc1
  buffer_load_dwordx4 v[48:51], v1, s[4:7], s72 offen offset:0 sc1
  buffer_load_dwordx4 v[52:55], v1, s[4:7], s72 offen offset:1024 sc1
  buffer_load_dwordx4 v[56:59], v1, s[4:7], s72 offen offset:2048 sc1
  s_waitcnt vmcnt(0)
  v_cmp_eq_u32 vcc, -1, v47
  s_cbranch_vccnz Le_155
  s_branch Lb_139
Le_156:
  s_add_u32 s55, s55, 1
  s_bitcmp1_b32 s55, 21
  s_cbranch_scc1 L_abort
  buffer_load_dwordx4 v[48:51], v1, s[4:7], s72 offen offset:0 sc1
  buffer_load_dwordx4 v[52:55], v1, s[4:7], s72 offen offset:1024 sc1
  buffer_load_dwordx4 v[56:59], v1, s[4:7], s72 offen offset:2048 sc1
  buffer_load_dwordx4 v[60:63], v1, s[4:7], s72 offen offset:3072 sc1
  s_waitcnt vmcnt(0)
  v_cmp_eq_u32 vcc, -1, v51
  s_cbranch_vccnz Le_156
  s_branch Lb_140
Le_157:
  s_add_u32 s55, s55, 1
  s_bitcmp1_b32 s55, 21
  s_cbranch_scc1 L_abort
  buffer_load_dwordx4 v[52:55], v1, s[4:7], s72 offen offset:1024 sc1
  buffer_load_dwordx4 v[56:59], v1, s[4:7], s72 offen offset:2048 sc1
  buffer_load_dwordx4 v[60:63], v1, s[4:7], s72 offen offset:3072 sc1
  s_waitcnt vmcnt(0)
  v_cmp_eq_u32 vcc, -1, v55
  s_cbranch_vccnz Le_157
  s_branch Lb_141
Le_158:
  s_add_u32 s55, s55, 1
  s_bitcmp1_b32 s55, 21
  s_cbranch_scc1 L_abort
  buffer_load_dwordx4 v[56:59], v1, s[4:7], s72 offen offset:2048 sc1
  buffer_load_dwordx4 v[60:63], v1, s[4:7], s72 offen offset:3072 sc1
  s_waitcnt vmcnt(0)
  v_cmp_eq_u32 vcc, -1, v59
  s_cbranch_vccnz Le_158
  s_branch Lb_142
Le_159:
  s_add_u32 s55, s55, 1
  s_bitcmp1_b32 s55, 21
  s_cbranch_scc1 L_abort
  buffer_load_dwordx4 v[60:63], v1, s[4:7], s72 offen offset:3072 sc1
  s_waitcnt vmcnt(0)
  v_cmp_eq_u32 vcc, -1, v63
  s_cbranch_vccnz Le_159
  s_branch Lb_143
Lg_127:
  v_mov_b32 v24, 0
  v_mov_b32 v25, 0
  v_mov_b32 v26, 0
  v_mov_b32 v27, 0
  v_mov_b32 v28, 0
  v_mov_b32 v29, 0
  v_mov_b32 v30, 0
  v_mov_b32 v31, 0
  v_mov_b32 v126, 0
  s_add_u32 s55, s55, 1
  s_bitcmp1_b32 s55, 21
  s_cbranch_scc1 L_abort
  s_branch Lg_126
L_vo_end:
  s_branch L_end
L_pk:
  v_lshlrev_b32 v1, 4, v0
  s_mul_i32 s67, s52, 0x202000
  s_lshl_b32 s56, s52, 2
  s_add_u32 s56, s56, s50
  s_lshl_b32 s56, s56, 11
  v_and_b32 v127, 31, v0
  v_lshlrev_b32 v127, 6, v127
  buffer_load_dword v6, v127, s[12:15], s56 offen
  s_cmp_lg_u32 s50, 0
  s_cbranch_scc1 Lar_160
  s_cmp_eq_u32 s100, 0
  s_cbranch_scc0 Lar_160
  s_mov_b32 s56, 0
  v_mov_b32 v126, 1
  s_mov_b64 exec, 1
  buffer_atomic_add v126, off, s[20:23], s56 sc1
  s_mov_b64 exec, -1
Lar_160:
  s_mov_b32 s8, s30
  s_mov_b32 s9, s31
  s_mov_b32 s10, 0x800000
  s_mov_b32 s11, 0x20000
  v_lshrrev_b32 v126, 3, v0
  v_lshlrev_b32 v2, 13, v126
  v_and_b32 v126, 2, v126
  v_xor_b32 v126, v126, v0
  v_and_b32 v126, 7, v126
  v_lshlrev_b32 v126, 4, v126
  v_xor_b32 v3, 64, v126
  v_add_u32 v3, v3, v2
  v_add_u32 v2, v126, v2
  v_lshrrev_b32 v126, 4, v0
  v_lshlrev_b32 v126, 3, v126
  v_bfe_u32 v127, v0, 2, 2
  v_add_u32 v126, v126, v127
  v_lshrrev_b32 v127, 5, v0
  v_lshlrev_b32 v127, 1, v127
  v_bfe_u32 v4, v0, 3, 1
  v_or_b32 v127, v127, v4
  v_lshlrev_b32 v126, 7, v126
  v_xor_b32 v127, s50, v127
  v_and_b32 v4, 3, v0
  v_lshl_add_u32 v126, v4, 3, v126
  v_lshl_add_u32 v126, v127, 5, v126
  v_xor_b32 v68, 0, v126
  v_add_u32 v72, 0x10000, v68
  v_xor_b32 v69, 32, v126
  v_add_u32 v73, 0x10000, v69
  v_xor_b32 v70, 64, v126
  v_add_u32 v74, 0x10000, v70
  v_xor_b32 v71, 96, v126
  v_add_u32 v75, 0x10000, v71
  s_lshl_b32 s60, s52, 8
  s_mul_i32 s56, s50, 2097152
  s_add_u32 s60, s60, s56
  s_lshl_b32 s56, s50, 15
  s_add_u32 s56, s56, 0
  s_sub_u32 s57, s60, 65536
  s_mov_b32 s58, 4
Ldma_161:
  s_mov_b32 m0, s56
  s_add_u32 s57, s57, 65536
  buffer_load_dwordx4 v2, s[8:11], s57 offen lds
  s_add_u32 s56, s56, 1024
  s_mov_b32 m0, s56
  s_add_u32 s57, s57, 65536
  buffer_load_dwordx4 v2, s[8:11], s57 offen lds
  s_add_u32 s56, s56, 1024
  s_mov_b32 m0, s56
  s_add_u32 s57, s57, 65536
  buffer_load_dwordx4 v3, s[8:11], s57 offen lds
  s_add_u32 s56, s56, 1024
  s_mov_b32 m0, s56
  s_add_u32 s57, s57, 65536
  buffer_load_dwordx4 v3, s[8:11], s57 offen lds
  s_add_u32 s56, s56, 1024
  s_sub_u32 s58, s58, 1
  s_cmp_lg_u32 s58, 0
  s_cbranch_scc1 Ldma_161
  s_lshl_b32 s60, s52, 8
  s_mul_i32 s56, s50, 2097152
  s_add_u32 s60, s60, s56
  s_add_u32 s60, s60, 1048576
  s_lshl_b32 s56, s50, 15
  s_add_u32 s56, s56, 16384
  s_sub_u32 s57, s60, 65536
  s_mov_b32 s58, 4
Ldma_162:
  s_mov_b32 m0, s56
  s_add_u32 s57, s57, 65536
  buffer_load_dwordx4 v2, s[8:11], s57 offen lds
  s_add_u32 s56, s56, 1024
  s_mov_b32 m0, s56
  s_add_u32 s57, s57, 65536
  buffer_load_dwordx4 v2, s[8:11], s57 offen lds
  s_add_u32 s56, s56, 1024
  s_mov_b32 m0, s56
  s_add_u32 s57, s57, 65536
  buffer_load_dwordx4 v3, s[8:11], s57 offen lds
  s_add_u32 s56, s56, 1024
  s_mov_b32 m0, s56
  s_add_u32 s57, s57, 65536
  buffer_load_dwordx4 v3, s[8:11], s57 offen lds
  s_add_u32 s56, s56, 1024
  s_sub_u32 s58, s58, 1
  s_cmp_lg_u32 s58, 0
  s_cbranch_scc1 Ldma_162
  s_waitcnt vmcnt(16)
  s_barrier
  ds_read_b64_tr_b16 a[0:1], v68 offset:0
  ds_read_b64_tr_b16 a[2:3], v68 offset:512
  ds_read_b64_tr_b16 a[4:5], v68 offset:4096
  ds_read_b64_tr_b16 a[6:7], v68 offset:4608
  ds_read_b64_tr_b16 a[8:9], v68 offset:8192
  ds_read_b64_tr_b16 a[10:11], v68 offset:8704
  ds_read_b64_tr_b16 a[12:13], v68 offset:12288
  ds_read_b64_tr_b16 a[14:15], v68 offset:12800
  ds_read_b64_tr_b16 a[32:33], v68 offset:32768
  ds_read_b64_tr_b16 a[34:35], v68 offset:33280
  ds_read_b64_tr_b16 a[36:37], v68 offset:36864
  ds_read_b64_tr_b16 a[38:39], v68 offset:37376
  ds_read_b64_tr_b16 a[40:41], v68 offset:40960
  ds_read_b64_tr_b16 a[42:43], v68 offset:41472
  ds_read_b64_tr_b16 a[44:45], v68 offset:45056
  ds_read_b64_tr_b16 a[46:47], v68 offset:45568
  ds_read_b64_tr_b16 a[64:65], v72 offset:0
  ds_read_b64_tr_b16 a[66:67], v72 offset:512
  ds_read_b64_tr_b16 a[68:69], v72 offset:4096
  ds_read_b64_tr_b16 a[70:71], v72 offset:4608
  ds_read_b64_tr_b16 a[72:73], v72 offset:8192
  ds_read_b64_tr_b16 a[74:75], v72 offset:8704
  ds_read_b64_tr_b16 a[76:77], v72 offset:12288
  ds_read_b64_tr_b16 a[78:79], v72 offset:12800
  ds_read_b64_tr_b16 a[96:97], v72 offset:32768
  ds_read_b64_tr_b16 a[98:99], v72 offset:33280
  ds_read_b64_tr_b16 a[100:101], v72 offset:36864
  ds_read_b64_tr_b16 a[102:103], v72 offset:37376
  ds_read_b64_tr_b16 a[104:105], v72 offset:40960
  ds_read_b64_tr_b16 a[106:107], v72 offset:41472
  ds_read_b64_tr_b16 a[108:109], v72 offset:45056
  ds_read_b64_tr_b16 a[110:111], v72 offset:45568
Lro_163:
  s_waitcnt lgkmcnt(0)
  s_barrier
  s_lshl_b32 s60, s52, 8
  s_add_u32 s60, s60, 128
  s_mul_i32 s56, s50, 2097152
  s_add_u32 s60, s60, s56
  s_lshl_b32 s56, s50, 15
  s_add_u32 s56, s56, 0
  s_sub_u32 s57, s60, 65536
  s_mov_b32 s58, 4
Ldma_164:
  s_mov_b32 m0, s56
  s_add_u32 s57, s57, 65536
  buffer_load_dwordx4 v2, s[8:11], s57 offen lds
  s_add_u32 s56, s56, 1024
  s_mov_b32 m0, s56
  s_add_u32 s57, s57, 65536
  buffer_load_dwordx4 v2, s[8:11], s57 offen lds
  s_add_u32 s56, s56, 1024
  s_mov_b32 m0, s56
  s_add_u32 s57, s57, 65536
  buffer_load_dwordx4 v3, s[8:11], s57 offen lds
  s_add_u32 s56, s56, 1024
  s_mov_b32 m0, s56
  s_add_u32 s57, s57, 65536
  buffer_load_dwordx4 v3, s[8:11], s57 offen lds
  s_add_u32 s56, s56, 1024
  s_sub_u32 s58, s58, 1
  s_cmp_lg_u32 s58, 0
  s_cbranch_scc1 Ldma_164
  s_waitcnt vmcnt(16)
  s_barrier
  ds_read_b64_tr_b16 a[16:17], v68 offset:16384
  ds_read_b64_tr_b16 a[18:19], v68 offset:16896
  ds_read_b64_tr_b16 a[20:21], v68 offset:20480
  ds_read_b64_tr_b16 a[22:23], v68 offset:20992
  ds_read_b64_tr_b16 a[24:25], v68 offset:24576
  ds_read_b64_tr_b16 a[26:27], v68 offset:25088
  ds_read_b64_tr_b16 a[28:29], v68 offset:28672
  ds_read_b64_tr_b16 a[30:31], v68 offset:29184
  ds_read_b64_tr_b16 a[48:49], v68 offset:49152
  ds_read_b64_tr_b16 a[50:51], v68 offset:49664
  ds_read_b64_tr_b16 a[52:53], v68 offset:53248
  ds_read_b64_tr_b16 a[54:55], v68 offset:53760
  ds_read_b64_tr_b16 a[56:57], v68 offset:57344
  ds_read_b64_tr_b16 a[58:59], v68 offset:57856
  ds_read_b64_tr_b16 a[60:61], v68 offset:61440
  ds_read_b64_tr_b16 a[62:63], v68 offset:61952
  ds_read_b64_tr_b16 a[80:81], v72 offset:16384
  ds_read_b64_tr_b16 a[82:83], v72 offset:16896
  ds_read_b64_tr_b16 a[84:85], v72 offset:20480
  ds_read_b64_tr_b16 a[86:87], v72 offset:20992
  ds_read_b64_tr_b16 a[88:89], v72 offset:24576
  ds_read_b64_tr_b16 a[90:91], v72 offset:25088
  ds_read_b64_tr_b16 a[92:93], v72 offset:28672
  ds_read_b64_tr_b16 a[94:95], v72 offset:29184
  ds_read_b64_tr_b16 a[112:113], v72 offset:49152
  ds_read_b64_tr_b16 a[114:115], v72 offset:49664
  ds_read_b64_tr_b16 a[116:117], v72 offset:53248
  ds_read_b64_tr_b16 a[118:119], v72 offset:53760
  ds_read_b64_tr_b16 a[120:121], v72 offset:57344
  ds_read_b64_tr_b16 a[122:123], v72 offset:57856
  ds_read_b64_tr_b16 a[124:125], v72 offset:61440
  ds_read_b64_tr_b16 a[126:127], v72 offset:61952
Lro_165:
  s_waitcnt lgkmcnt(0)
  s_barrier
  s_lshl_b32 s60, s52, 8
  s_add_u32 s60, s60, 128
  s_mul_i32 s56, s50, 2097152
  s_add_u32 s60, s60, s56
  s_add_u32 s60, s60, 1048576
  s_lshl_b32 s56, s50, 15
  s_add_u32 s56, s56, 16384
  s_sub_u32 s57, s60, 65536
  s_mov_b32 s58, 4
Ldma_166:
  s_mov_b32 m0, s56
  s_add_u32 s57, s57, 65536
  buffer_load_dwordx4 v2, s[8:11], s57 offen lds
  s_add_u32 s56, s56, 1024
  s_mov_b32 m0, s56
  s_add_u32 s57, s57, 65536
  buffer_load_dwordx4 v2, s[8:11], s57 offen lds
  s_add_u32 s56, s56, 1024
  s_mov_b32 m0, s56
  s_add_u32 s57, s57, 65536
  buffer_load_dwordx4 v3, s[8:11], s57 offen lds
  s_add_u32 s56, s56, 1024
  s_mov_b32 m0, s56
  s_add_u32 s57, s57, 65536
  buffer_load_dwordx4 v3, s[8:11], s57 offen lds
  s_add_u32 s56, s56, 1024
  s_sub_u32 s58, s58, 1
  s_cmp_lg_u32 s58, 0
  s_cbranch_scc1 Ldma_166
  s_waitcnt vmcnt(16)
  s_barrier
  ds_read_b64_tr_b16 a[128:129], v68 offset:0
  ds_read_b64_tr_b16 a[130:131], v68 offset:512
  ds_read_b64_tr_b16 a[132:133], v68 offset:4096
  ds_read_b64_tr_b16 a[134:135], v68 offset:4608
  ds_read_b64_tr_b16 a[136:137], v68 offset:8192
  ds_read_b64_tr_b16 a[138:139], v68 offset:8704
  ds_read_b64_tr_b16 a[140:141], v68 offset:12288
  ds_read_b64_tr_b16 a[142:143], v68 offset:12800
  ds_read_b64_tr_b16 a[160:161], v68 offset:32768
  ds_read_b64_tr_b16 a[162:163], v68 offset:33280
  ds_read_b64_tr_b16 a[164:165], v68 offset:36864
  ds_read_b64_tr_b16 a[166:167], v68 offset:37376
  ds_read_b64_tr_b16 a[168:169], v68 offset:40960
  ds_read_b64_tr_b16 a[170:171], v68 offset:41472
  ds_read_b64_tr_b16 a[172:173], v68 offset:45056
  ds_read_b64_tr_b16 a[174:175], v68 offset:45568
  ds_read_b64_tr_b16 a[192:193], v72 offset:0
  ds_read_b64_tr_b16 a[194:195], v72 offset:512
  ds_read_b64_tr_b16 a[196:197], v72 offset:4096
  ds_read_b64_tr_b16 a[198:199], v72 offset:4608
  ds_read_b64_tr_b16 a[200:201], v72 offset:8192
  ds_read_b64_tr_b16 a[202:203], v72 offset:8704
  ds_read_b64_tr_b16 a[204:205], v72 offset:12288
  ds_read_b64_tr_b16 a[206:207], v72 offset:12800
  ds_read_b64_tr_b16 a[224:225], v72 offset:32768
  ds_read_b64_tr_b16 a[226:227], v72 offset:33280
  ds_read_b64_tr_b16 a[228:229], v72 offset:36864
  ds_read_b64_tr_b16 a[230:231], v72 offset:37376
  ds_read_b64_tr_b16 a[232:233], v72 offset:40960
  ds_read_b64_tr_b16 a[234:235], v72 offset:41472
  ds_read_b64_tr_b16 a[236:237], v72 offset:45056
  ds_read_b64_tr_b16 a[238:239], v72 offset:45568
Lro_167:
  s_waitcnt lgkmcnt(0)
  s_barrier
  v_lshlrev_b32 v37, 2, v0
  buffer_load_dword v36, v37, s[20:23], 0 offen sc1
  s_waitcnt vmcnt(0)
  s_barrier
  ds_read_b64_tr_b16 a[144:145], v68 offset:16384
  ds_read_b64_tr_b16 a[146:147], v68 offset:16896
  ds_read_b64_tr_b16 a[148:149], v68 offset:20480
  ds_read_b64_tr_b16 a[150:151], v68 offset:20992
  ds_read_b64_tr_b16 a[152:153], v68 offset:24576
  ds_read_b64_tr_b16 a[154:155], v68 offset:25088
  ds_read_b64_tr_b16 a[156:157], v68 offset:28672
  ds_read_b64_tr_b16 a[158:159], v68 offset:29184
  ds_read_b64_tr_b16 a[176:177], v68 offset:49152
  ds_read_b64_tr_b16 a[178:179], v68 offset:49664
  ds_read_b64_tr_b16 a[180:181], v68 offset:53248
  ds_read_b64_tr_b16 a[182:183], v68 offset:53760
  ds_read_b64_tr_b16 a[184:185], v68 offset:57344
  ds_read_b64_tr_b16 a[186:187], v68 offset:57856
  ds_read_b64_tr_b16 a[188:189], v68 offset:61440
  ds_read_b64_tr_b16 a[190:191], v68 offset:61952
  ds_read_b64_tr_b16 a[208:209], v72 offset:16384
  ds_read_b64_tr_b16 a[210:211], v72 offset:16896
  ds_read_b64_tr_b16 a[212:213], v72 offset:20480
  ds_read_b64_tr_b16 a[214:215], v72 offset:20992
  ds_read_b64_tr_b16 a[216:217], v72 offset:24576
  ds_read_b64_tr_b16 a[218:219], v72 offset:25088
  ds_read_b64_tr_b16 a[220:221], v72 offset:28672
  ds_read_b64_tr_b16 a[222:223], v72 offset:29184
  ds_read_b64_tr_b16 a[240:241], v72 offset:49152
  ds_read_b64_tr_b16 a[242:243], v72 offset:49664
  ds_read_b64_tr_b16 a[244:245], v72 offset:53248
  ds_read_b64_tr_b16 a[246:247], v72 offset:53760
  ds_read_b64_tr_b16 a[248:249], v72 offset:57344
  ds_read_b64_tr_b16 a[250:251], v72 offset:57856
  ds_read_b64_tr_b16 a[252:253], v72 offset:61440
  ds_read_b64_tr_b16 a[254:255], v72 offset:61952
Lro_168:
  s_waitcnt lgkmcnt(0)
  s_barrier
  s_branch Lwa_173
Lwa_169:
  v_lshlrev_b32 v37, 2, v0
  buffer_load_dword v36, v37, s[20:23], 0 offen sc1
  s_waitcnt vmcnt(0)
Lwa_173:
  s_cmp_eq_u32 s100, 0
  s_cbranch_scc1 Lwa_171
  s_mov_b32 s56, 0
  v_readlane_b32 s57, v36, 8
  s_add_u32 s56, s56, s57
  v_readlane_b32 s57, v36, 9
  s_add_u32 s56, s56, s57
  v_readlane_b32 s57, v36, 10
  s_add_u32 s56, s56, s57
  v_readlane_b32 s57, v36, 11
  s_add_u32 s56, s56, s57
  v_readlane_b32 s57, v36, 12
  s_add_u32 s56, s56, s57
  v_readlane_b32 s57, v36, 13
  s_add_u32 s56, s56, s57
  v_readlane_b32 s57, v36, 14
  s_add_u32 s56, s56, s57
  v_readlane_b32 s57, v36, 15
  s_add_u32 s56, s56, s57
  v_readlane_b32 s57, v36, 16
  s_add_u32 s56, s56, s57
  v_readlane_b32 s57, v36, 40
  s_add_u32 s56, s56, s57
  v_readlane_b32 s57, v36, 41
  s_add_u32 s56, s56, s57
  v_readlane_b32 s57, v36, 42
  s_add_u32 s56, s56, s57
  v_readlane_b32 s57, v36, 43
  s_add_u32 s56, s56, s57
  v_readlane_b32 s57, v36, 44
  s_add_u32 s56, s56, s57
  v_readlane_b32 s57, v36, 45
  s_add_u32 s56, s56, s57
  v_readlane_b32 s57, v36, 46
  s_add_u32 s56, s56, s57
  v_readlane_b32 s57, v36, 47
  s_add_u32 s56, s56, s57
  v_readlane_b32 s57, v36, 48
  s_add_u32 s56, s56, s57
  s_cmp_lt_u32 s56, 256
  s_cbranch_scc1 Lwa_172
  s_lshr_b32 s58, s100, 2
  v_readlane_b32 s56, v36, s58
  s_add_u32 s58, s58, 32
  v_readlane_b32 s57, v36, s58
  s_add_u32 s56, s56, s57
  s_cmp_eq_u32 s58, 48
  s_cselect_b32 s56, 0, s56
  s_cmp_lt_u32 s56, 256
  s_cbranch_scc1 L_restart
  v_readlane_b32 s56, v36, 32
  s_cmp_ge_u32 s56, 128
  s_cbranch_scc1 Lwa_170
  s_branch Lwa_172
Lwa_171:
  v_readlane_b32 s56, v36, 0
  s_cmp_ge_u32 s56, 256
  s_cbranch_scc1 Lwa_170
Lwa_172:
  s_sleep 8
  s_add_u32 s55, s55, 1
  s_bitcmp1_b32 s55, 21
  s_cbranch_scc1 L_abort
  s_branch Lwa_169
Lwa_170:
  s_mov_b32 s61, 0
  s_mov_b32 s62, 64
  s_mov_b32 s71, 0
  s_lshl_b32 s56, s50, 3
  s_add_u32 s56, s56, 0
  s_and_b32 s57, s56, 15
  v_xor_b32 v126, s57, v0
  s_lshl_b32 s56, s56, 11
  v_lshl_add_u32 v8, v126, 4, s56
  s_lshl_b32 s56, s50, 3
  s_add_u32 s56, s56, 1
  s_and_b32 s57, s56, 15
  v_xor_b32 v126, s57, v0
  s_lshl_b32 s56, s56, 11
  v_lshl_add_u32 v9, v126, 4, s56
  s_lshl_b32 s56, s50, 3
  s_add_u32 s56, s56, 2
  s_and_b32 s57, s56, 15
  v_xor_b32 v126, s57, v0
  s_lshl_b32 s56, s56, 11
  v_lshl_add_u32 v10, v126, 4, s56
  s_lshl_b32 s56, s50, 3
  s_add_u32 s56, s56, 3
  s_and_b32 s57, s56, 15
  v_xor_b32 v126, s57, v0
  s_lshl_b32 s56, s56, 11
  v_lshl_add_u32 v11, v126, 4, s56
  s_lshl_b32 s56, s50, 3
  s_add_u32 s56, s56, 4
  s_and_b32 s57, s56, 15
  v_xor_b32 v126, s57, v0
  s_lshl_b32 s56, s56, 11
  v_lshl_add_u32 v12, v126, 4, s56
  s_lshl_b32 s56, s50, 3
  s_add_u32 s56, s56, 5
  s_and_b32 s57, s56, 15
  v_xor_b32 v126, s57, v0
  s_lshl_b32 s56, s56, 11
  v_lshl_add_u32 v13, v126, 4, s56
  s_lshl_b32 s56, s50, 3
  s_add_u32 s56, s56, 6
  s_and_b32 s57, s56, 15
  v_xor_b32 v126, s57, v0
  s_lshl_b32 s56, s56, 11
  v_lshl_add_u32 v14, v126, 4, s56
  s_lshl_b32 s56, s50, 3
  s_add_u32 s56, s56, 7
  s_and_b32 s57, s56, 15
  v_xor_b32 v126, s57, v0
  s_lshl_b32 s56, s56, 11
  v_lshl_add_u32 v15, v126, 4, s56
  v_lshrrev_b32 v126, 4, v0
  v_add_u32 v126, 0, v126
  v_and_b32 v127, 15, v0
  v_xor_b32 v126, v126, v127
  v_lshlrev_b32 v126, 4, v126
  v_lshl_add_u32 v16, v127, 11, v126
  v_lshrrev_b32 v126, 4, v0
  v_add_u32 v126, 4, v126
  v_and_b32 v127, 15, v0
  v_xor_b32 v126, v126, v127
  v_lshlrev_b32 v126, 4, v126
  v_lshl_add_u32 v17, v127, 11, v126
  v_lshrrev_b32 v126, 4, v0
  v_add_u32 v126, 8, v126
  v_and_b32 v127, 15, v0
  v_xor_b32 v126, v126, v127
  v_lshlrev_b32 v126, 4, v126
  v_lshl_add_u32 v18, v127, 11, v126
  v_lshrrev_b32 v126, 4, v0
  v_add_u32 v126, 12, v126
  v_and_b32 v127, 15, v0
  v_xor_b32 v126, v126, v127
  v_lshlrev_b32 v126, 4, v126
  v_lshl_add_u32 v19, v127, 11, v126
  s_mov_b32 s56, s52
  s_lshl_b32 s56, s56, 2
  s_add_u32 s56, s56, s50
  s_mul_i32 s56, s56, 512
  v_lshl_add_u32 v5, v0, 6, s56
  v_cmp_gt_u32 vcc, 8, v0
  v_mov_b32 v7, 0x80000000
  s_nop 0
  v_cndmask_b32 v5, v7, v5, vcc
  s_add_u32 s70, s61, 0
  s_sub_u32 s56, s62, 1
  s_min_u32 s70, s70, s56
  s_lshl_b32 s70, s70, 16
  buffer_load_dword v6, v5, s[12:15], s70 offen
  s_add_u32 s70, s61, 1
  s_sub_u32 s56, s62, 1
  s_min_u32 s70, s70, s56
  s_lshl_b32 s70, s70, 16
  buffer_load_dword v6, v5, s[12:15], s70 offen
  s_add_u32 s70, s61, 2
  s_sub_u32 s56, s62, 1
  s_min_u32 s70, s70, s56
  s_lshl_b32 s70, s70, 16
  buffer_load_dword v6, v5, s[12:15], s70 offen
  s_lshl_b32 s65, s50, 14
  s_add_u32 s63, s61, 0
  s_sub_u32 s56, s62, 1
  s_min_u32 s63, s63, s56
  s_lshl_b32 s63, s63, 16
  s_add_u32 m0, s65, 0
  s_nop 0
  buffer_load_dwordx4 v8, s[12:15], s63 offen lds
  buffer_load_dwordx4 v8, s[12:15], s63 offen offset:1024 lds
  s_add_u32 m0, s65, 2048
  s_nop 0
  buffer_load_dwordx4 v9, s[12:15], s63 offen lds
  buffer_load_dwordx4 v9, s[12:15], s63 offen offset:1024 lds
  s_add_u32 m0, s65, 4096
  s_nop 0
  buffer_load_dwordx4 v10, s[12:15], s63 offen lds
  buffer_load_dwordx4 v10, s[12:15], s63 offen offset:1024 lds
  s_add_u32 m0, s65, 6144
  s_nop 0
  buffer_load_dwordx4 v11, s[12:15], s63 offen lds
  buffer_load_dwordx4 v11, s[12:15], s63 offen offset:1024 lds
  s_add_u32 m0, s65, 8192
  s_nop 0
  buffer_load_dwordx4 v12, s[12:15], s63 offen lds
  buffer_load_dwordx4 v12, s[12:15], s63 offen offset:1024 lds
  s_add_u32 m0, s65, 10240
  s_nop 0
  buffer_load_dwordx4 v13, s[12:15], s63 offen lds
  buffer_load_dwordx4 v13, s[12:15], s63 offen offset:1024 lds
  s_add_u32 m0, s65, 12288
  s_nop 0
  buffer_load_dwordx4 v14, s[12:15], s63 offen lds
  buffer_load_dwordx4 v14, s[12:15], s63 offen offset:1024 lds
  s_add_u32 m0, s65, 14336
  s_nop 0
  buffer_load_dwordx4 v15, s[12:15], s63 offen lds
  buffer_load_dwordx4 v15, s[12:15], s63 offen offset:1024 lds
  s_waitcnt vmcnt(0)
L_pk_loop:
  s_waitcnt vmcnt(3)
  s_barrier
  ds_read_b128 v[36:39], v16 offset:0
  ds_read_b128 v[40:43], v16 offset:32768
  ds_read_b128 v[44:47], v17 offset:0
  ds_read_b128 v[48:51], v17 offset:32768
  ds_read_b128 v[52:55], v18 offset:0
  ds_read_b128 v[56:59], v18 offset:32768
  s_xor_b32 s65, s65, 0x10000
  s_add_u32 s63, s61, 1
  s_sub_u32 s56, s62, 1
  s_min_u32 s63, s63, s56
  s_lshl_b32 s63, s63, 16
  s_add_u32 s70, s61, 3
  s_sub_u32 s56, s62, 1
  s_min_u32 s70, s70, s56
  s_lshl_b32 s70, s70, 16
  s_waitcnt lgkmcnt(4)
  v_mfma_f32_16x16x32_bf16 v[20:23], a[0:3], v[36:39], 0
  ds_read_b128 v[60:63], v19 offset:0
  v_mfma_f32_16x16x32_bf16 v[24:27], a[128:131], v[36:39], 0
  ds_read_b128 v[64:67], v19 offset:32768
  s_add_u32 m0, s65, 0
  v_mfma_f32_16x16x32_bf16 v[28:31], a[0:3], v[40:43], 0
  buffer_load_dwordx4 v8, s[12:15], s63 offen lds
  v_mfma_f32_16x16x32_bf16 v[32:35], a[128:131], v[40:43], 0
  s_waitcnt lgkmcnt(4)
  v_mfma_f32_16x16x32_bf16 v[20:23], a[4:7], v[44:47], v[20:23]
  ds_read_b128 v[36:39], v16 offset:256
  v_mfma_f32_16x16x32_bf16 v[24:27], a[132:135], v[44:47], v[24:27]
  ds_read_b128 v[40:43], v16 offset:33024
  v_mfma_f32_16x16x32_bf16 v[28:31], a[4:7], v[48:51], v[28:31]
  buffer_load_dwordx4 v8, s[12:15], s63 offen offset:1024 lds
  v_mfma_f32_16x16x32_bf16 v[32:35], a[132:135], v[48:51], v[32:35]
  s_waitcnt lgkmcnt(4)
  v_mfma_f32_16x16x32_bf16 v[20:23], a[8:11], v[52:55], v[20:23]
  ds_read_b128 v[44:47], v17 offset:256
  v_mfma_f32_16x16x32_bf16 v[24:27], a[136:139], v[52:55], v[24:27]
  ds_read_b128 v[48:51], v17 offset:33024
  s_add_u32 m0, s65, 2048
  v_mfma_f32_16x16x32_bf16 v[28:31], a[8:11], v[56:59], v[28:31]
  buffer_load_dwordx4 v9, s[12:15], s63 offen lds
  v_mfma_f32_16x16x32_bf16 v[32:35], a[136:139], v[56:59], v[32:35]
  s_waitcnt lgkmcnt(4)
  v_mfma_f32_16x16x32_bf16 v[20:23], a[12:15], v[60:63], v[20:23]
  ds_read_b128 v[52:55], v18 offset:256
  v_mfma_f32_16x16x32_bf16 v[24:27], a[140:143], v[60:63], v[24:27]
  ds_read_b128 v[56:59], v18 offset:33024
  v_mfma_f32_16x16x32_bf16 v[28:31], a[12:15], v[64:67], v[28:31]
  buffer_load_dwordx4 v9, s[12:15], s63 offen offset:1024 lds
  v_mfma_f32_16x16x32_bf16 v[32:35], a[140:143], v[64:67], v[32:35]
  s_waitcnt lgkmcnt(4)
  v_mfma_f32_16x16x32_bf16 v[20:23], a[16:19], v[36:39], v[20:23]
  ds_read_b128 v[60:63], v19 offset:256
  v_mfma_f32_16x16x32_bf16 v[24:27], a[144:147], v[36:39], v[24:27]
  ds_read_b128 v[64:67], v19 offset:33024
  s_add_u32 m0, s65, 4096
  v_mfma_f32_16x16x32_bf16 v[28:31], a[16:19], v[40:43], v[28:31]
  buffer_load_dwordx4 v10, s[12:15], s63 offen lds
  v_mfma_f32_16x16x32_bf16 v[32:35], a[144:147], v[40:43], v[32:35]
  s_waitcnt lgkmcnt(4)
  v_mfma_f32_16x16x32_bf16 v[20:23], a[20:23], v[44:47], v[20:23]
  ds_read_b128 v[36:39], v16 offset:512
  v_mfma_f32_16x16x32_bf16 v[24:27], a[148:151], v[44:47], v[24:27]
  ds_read_b128 v[40:43], v16 offset:33280
  v_mfma_f32_16x16x32_bf16 v[28:31], a[20:23], v[48:51], v[28:31]
  buffer_load_dwordx4 v10, s[12:15], s63 offen offset:1024 lds
  v_mfma_f32_16x16x32_bf16 v[32:35], a[148:151], v[48:51], v[32:35]
  s_waitcnt lgkmcnt(4)
  v_mfma_f32_16x16x32_bf16 v[20:23], a[24:27], v[52:55], v[20:23]
  ds_read_b128 v[44:47], v17 offset:512
  v_mfma_f32_16x16x32_bf16 v[24:27], a[152:155], v[52:55], v[24:27]
  ds_read_b128 v[48:51], v17 offset:33280
  s_add_u32 m0, s65, 6144
  v_mfma_f32_16x16x32_bf16 v[28:31], a[24:27], v[56:59], v[28:31]
  buffer_load_dwordx4 v11, s[12:15], s63 offen lds
  v_mfma_f32_16x16x32_bf16 v[32:35], a[152:155], v[56:59], v[32:35]
  s_waitcnt lgkmcnt(4)
  v_mfma_f32_16x16x32_bf16 v[20:23], a[28:31], v[60:63], v[20:23]
  ds_read_b128 v[52:55], v18 offset:512
  v_mfma_f32_16x16x32_bf16 v[24:27], a[156:159], v[60:63], v[24:27]
  ds_read_b128 v[56:59], v18 offset:33280
  v_mfma_f32_16x16x32_bf16 v[28:31], a[28:31], v[64:67], v[28:31]
  buffer_load_dwordx4 v11, s[12:15], s63 offen offset:1024 lds
  v_mfma_f32_16x16x32_bf16 v[32:35], a[156:159], v[64:67], v[32:35]
  s_waitcnt lgkmcnt(4)
  v_mfma_f32_16x16x32_bf16 v[20:23], a[32:35], v[36:39], v[20:23]
  ds_read_b128 v[60:63], v19 offset:512
  v_mfma_f32_16x16x32_bf16 v[24:27], a[160:163], v[36:39], v[24:27]
  ds_read_b128 v[64:67], v19 offset:33280
  s_add_u32 m0, s65, 8192
  v_mfma_f32_16x16x32_bf16 v[28:31], a[32:35], v[40:43], v[28:31]
  buffer_load_dwordx4 v12, s[12:15], s63 offen lds
  v_mfma_f32_16x16x32_bf16 v[32:35], a[160:163], v[40:43], v[32:35]
  s_waitcnt lgkmcnt(4)
  v_mfma_f32_16x16x32_bf16 v[20:23], a[36:39], v[44:47], v[20:23]
  ds_read_b128 v[36:39], v16 offset:768
  v_mfma_f32_16x16x32_bf16 v[24:27], a[164:167], v[44:47], v[24:27]
  ds_read_b128 v[40:43], v16 offset:33536
  v_mfma_f32_16x16x32_bf16 v[28:31], a[36:39], v[48:51], v[28:31]
  buffer_load_dwordx4 v12, s[12:15], s63 offen offset:1024 lds
  v_mfma_f32_16x16x32_bf16 v[32:35], a[164:167], v[48:51], v[32:35]
  s_waitcnt lgkmcnt(4)
  v_mfma_f32_16x16x32_bf16 v[20:23], a[40:43], v[52:55], v[20:23]
  ds_read_b128 v[44:47], v17 offset:768
  v_mfma_f32_16x16x32_bf16 v[24:27], a[168:171], v[52:55], v[24:27]
  ds_read_b128 v[48:51], v17 offset:33536
  s_add_u32 m0, s65, 10240
  v_mfma_f32_16x16x32_bf16 v[28:31], a[40:43], v[56:59], v[28:31]
  buffer_load_dwordx4 v13, s[12:15], s63 offen lds
  v_mfma_f32_16x16x32_bf16 v[32:35], a[168:171], v[56:59], v[32:35]
  s_waitcnt lgkmcnt(4)
  v_mfma_f32_16x16x32_bf16 v[20:23], a[44:47], v[60:63], v[20:23]
  ds_read_b128 v[52:55], v18 offset:768
  v_mfma_f32_16x16x32_bf16 v[24:27], a[172:175], v[60:63], v[24:27]
  ds_read_b128 v[56:59], v18 offset:33536
  v_mfma_f32_16x16x32_bf16 v[28:31], a[44:47], v[64:67], v[28:31]
  buffer_load_dwordx4 v13, s[12:15], s63 offen offset:1024 lds
  v_mfma_f32_16x16x32_bf16 v[32:35], a[172:175], v[64:67], v[32:35]
  s_waitcnt lgkmcnt(4)
  v_mfma_f32_16x16x32_bf16 v[20:23], a[48:51], v[36:39], v[20:23]
  ds_read_b128 v[60:63], v19 offset:768
  v_mfma_f32_16x16x32_bf16 v[24:27], a[176:179], v[36:39], v[24:27]
  ds_read_b128 v[64:67], v19 offset:33536
  s_add_u32 m0, s65, 12288
  v_mfma_f32_16x16x32_bf16 v[28:31], a[48:51], v[40:43], v[28:31]
  buffer_load_dwordx4 v14, s[12:15], s63 offen lds
  v_mfma_f32_16x16x32_bf16 v[32:35], a[176:179], v[40:43], v[32:35]
  s_waitcnt lgkmcnt(4)
  v_mfma_f32_16x16x32_bf16 v[20:23], a[52:55], v[44:47], v[20:23]
  ds_read_b128 v[36:39], v16 offset:1024
  v_mfma_f32_16x16x32_bf16 v[24:27], a[180:183], v[44:47], v[24:27]
  ds_read_b128 v[40:43], v16 offset:33792
  v_mfma_f32_16x16x32_bf16 v[28:31], a[52:55], v[48:51], v[28:31]
  buffer_load_dwordx4 v14, s[12:15], s63 offen offset:1024 lds
  v_mfma_f32_16x16x32_bf16 v[32:35], a[180:183], v[48:51], v[32:35]
  s_waitcnt lgkmcnt(4)
  v_mfma_f32_16x16x32_bf16 v[20:23], a[56:59], v[52:55], v[20:23]
  ds_read_b128 v[44:47], v17 offset:1024
  v_mfma_f32_16x16x32_bf16 v[24:27], a[184:187], v[52:55], v[24:27]
  ds_read_b128 v[48:51], v17 offset:33792
  s_add_u32 m0, s65, 14336
  v_mfma_f32_16x16x32_bf16 v[28:31], a[56:59], v[56:59], v[28:31]
  buffer_load_dwordx4 v15, s[12:15], s63 offen lds
  v_mfma_f32_16x16x32_bf16 v[32:35], a[184:187], v[56:59], v[32:35]
  s_waitcnt lgkmcnt(4)
  v_mfma_f32_16x16x32_bf16 v[20:23], a[60:63], v[60:63], v[20:23]
  ds_read_b128 v[52:55], v18 offset:1024
  v_mfma_f32_16x16x32_bf16 v[24:27], a[188:191], v[60:63], v[24:27]
  ds_read_b128 v[56:59], v18 offset:33792
  v_mfma_f32_16x16x32_bf16 v[28:31], a[60:63], v[64:67], v[28:31]
  buffer_load_dwordx4 v15, s[12:15], s63 offen offset:1024 lds
  v_mfma_f32_16x16x32_bf16 v[32:35], a[188:191], v[64:67], v[32:35]
  s_waitcnt lgkmcnt(4)
  v_mfma_f32_16x16x32_bf16 v[20:23], a[64:67], v[36:39], v[20:23]
  ds_read_b128 v[60:63], v19 offset:1024
  v_mfma_f32_16x16x32_bf16 v[24:27], a[192:195], v[36:39], v[24:27]
  ds_read_b128 v[64:67], v19 offset:33792
  v_mfma_f32_16x16x32_bf16 v[28:31], a[64:67], v[40:43], v[28:31]
  buffer_load_dword v6, v5, s[12:15], s70 offen
  v_mfma_f32_16x16x32_bf16 v[32:35], a[192:195], v[40:43], v[32:35]
  s_waitcnt lgkmcnt(4)
  v_mfma_f32_16x16x32_bf16 v[20:23], a[68:71], v[44:47], v[20:23]
  ds_read_b128 v[36:39], v16 offset:1280
  v_mfma_f32_16x16x32_bf16 v[24:27], a[196:199], v[44:47], v[24:27]
  ds_read_b128 v[40:43], v16 offset:34048
  v_mfma_f32_16x16x32_bf16 v[28:31], a[68:71], v[48:51], v[28:31]
  buffer_store_dwordx4 v[68:71], v7, s[4:7], s71 offen sc1
  s_add_u32 s71, s71, 4096
  v_mfma_f32_16x16x32_bf16 v[32:35], a[196:199], v[48:51], v[32:35]
  s_waitcnt lgkmcnt(4)
  v_mfma_f32_16x16x32_bf16 v[20:23], a[72:75], v[52:55], v[20:23]
  ds_read_b128 v[44:47], v17 offset:1280
  v_mfma_f32_16x16x32_bf16 v[24:27], a[200:203], v[52:55], v[24:27]
  ds_read_b128 v[48:51], v17 offset:34048
  v_mfma_f32_16x16x32_bf16 v[28:31], a[72:75], v[56:59], v[28:31]
  buffer_store_dwordx4 v[72:75], v7, s[4:7], s71 offen sc1
  v_mfma_f32_16x16x32_bf16 v[32:35], a[200:203], v[56:59], v[32:35]
  s_waitcnt lgkmcnt(4)
  v_mfma_f32_16x16x32_bf16 v[20:23], a[76:79], v[60:63], v[20:23]
  ds_read_b128 v[52:55], v18 offset:1280
  v_mfma_f32_16x16x32_bf16 v[24:27], a[204:207], v[60:63], v[24:27]
  ds_read_b128 v[56:59], v18 offset:34048
  v_mfma_f32_16x16x32_bf16 v[28:31], a[76:79], v[64:67], v[28:31]
  v_mfma_f32_16x16x32_bf16 v[32:35], a[204:207], v[64:67], v[32:35]
  s_waitcnt lgkmcnt(4)
  v_mfma_f32_16x16x32_bf16 v[20:23], a[80:83], v[36:39], v[20:23]
  ds_read_b128 v[60:63], v19 offset:1280
  v_mfma_f32_16x16x32_bf16 v[24:27], a[208:211], v[36:39], v[24:27]
  ds_read_b128 v[64:67], v19 offset:34048
  v_mfma_f32_16x16x32_bf16 v[28:31], a[80:83], v[40:43], v[28:31]
  v_mfma_f32_16x16x32_bf16 v[32:35], a[208:211], v[40:43], v[32:35]
  s_waitcnt lgkmcnt(4)
  v_mfma_f32_16x16x32_bf16 v[20:23], a[84:87], v[44:47], v[20:23]
  ds_read_b128 v[36:39], v16 offset:1536
  v_mfma_f32_16x16x32_bf16 v[24:27], a[212:215], v[44:47], v[24:27]
  ds_read_b128 v[40:43], v16 offset:34304
  v_mfma_f32_16x16x32_bf16 v[28:31], a[84:87], v[48:51], v[28:31]
  v_mfma_f32_16x16x32_bf16 v[32:35], a[212:215], v[48:51], v[32:35]
  s_waitcnt lgkmcnt(4)
  v_mfma_f32_16x16x32_bf16 v[20:23], a[88:91], v[52:55], v[20:23]
  ds_read_b128 v[44:47], v17 offset:1536
  v_mfma_f32_16x16x32_bf16 v[24:27], a[216:219], v[52:55], v[24:27]
  ds_read_b128 v[48:51], v17 offset:34304
  v_mfma_f32_16x16x32_bf16 v[28:31], a[88:91], v[56:59], v[28:31]
  v_mfma_f32_16x16x32_bf16 v[32:35], a[216:219], v[56:59], v[32:35]
  s_waitcnt lgkmcnt(4)
  v_mfma_f32_16x16x32_bf16 v[20:23], a[92:95], v[60:63], v[20:23]
  ds_read_b128 v[52:55], v18 offset:1536
  v_mfma_f32_16x16x32_bf16 v[24:27], a[220:223], v[60:63], v[24:27]
  ds_read_b128 v[56:59], v18 offset:34304
  v_mfma_f32_16x16x32_bf16 v[28:31], a[92:95], v[64:67], v[28:31]
  v_mfma_f32_16x16x32_bf16 v[32:35], a[220:223], v[64:67], v[32:35]
  s_waitcnt lgkmcnt(4)
  v_mfma_f32_16x16x32_bf16 v[20:23], a[96:99], v[36:39], v[20:23]
  ds_read_b128 v[60:63], v19 offset:1536
  v_mfma_f32_16x16x32_bf16 v[24:27], a[224:227], v[36:39], v[24:27]
  ds_read_b128 v[64:67], v19 offset:34304
  v_mfma_f32_16x16x32_bf16 v[28:31], a[96:99], v[40:43], v[28:31]
  v_mfma_f32_16x16x32_bf16 v[32:35], a[224:227], v[40:43], v[32:35]
  s_waitcnt lgkmcnt(4)
  v_mfma_f32_16x16x32_bf16 v[20:23], a[100:103], v[44:47], v[20:23]
  ds_read_b128 v[36:39], v16 offset:1792
  v_mfma_f32_16x16x32_bf16 v[24:27], a[228:231], v[44:47], v[24:27]
  ds_read_b128 v[40:43], v16 offset:34560
  v_mfma_f32_16x16x32_bf16 v[28:31], a[100:103], v[48:51], v[28:31]
  v_mfma_f32_16x16x32_bf16 v[32:35], a[228:231], v[48:51], v[32:35]
  s_waitcnt lgkmcnt(4)
  v_mfma_f32_16x16x32_bf16 v[20:23], a[104:107], v[52:55], v[20:23]
  ds_read_b128 v[44:47], v17 offset:1792
  v_mfma_f32_16x16x32_bf16 v[24:27], a[232:235], v[52:55], v[24:27]
  ds_read_b128 v[48:51], v17 offset:34560
  v_mfma_f32_16x16x32_bf16 v[28:31], a[104:107], v[56:59], v[28:31]
  v_mfma_f32_16x16x32_bf16 v[32:35], a[232:235], v[56:59], v[32:35]
  s_waitcnt lgkmcnt(4)
  v_mfma_f32_16x16x32_bf16 v[20:23], a[108:111], v[60:63], v[20:23]
  ds_read_b128 v[52:55], v18 offset:1792
  v_mfma_f32_16x16x32_bf16 v[24:27], a[236:239], v[60:63], v[24:27]
  ds_read_b128 v[56:59], v18 offset:34560
  v_mfma_f32_16x16x32_bf16 v[28:31], a[108:111], v[64:67], v[28:31]
  v_mfma_f32_16x16x32_bf16 v[32:35], a[236:239], v[64:67], v[32:35]
  s_waitcnt lgkmcnt(4)
  v_mfma_f32_16x16x32_bf16 v[20:23], a[112:115], v[36:39], v[20:23]
  ds_read_b128 v[60:63], v19 offset:1792
  v_mfma_f32_16x16x32_bf16 v[24:27], a[240:243], v[36:39], v[24:27]
  ds_read_b128 v[64:67], v19 offset:34560
  v_mfma_f32_16x16x32_bf16 v[28:31], a[112:115], v[40:43], v[28:31]
  v_mfma_f32_16x16x32_bf16 v[32:35], a[240:243], v[40:43], v[32:35]
  s_waitcnt lgkmcnt(4)
  v_mfma_f32_16x16x32_bf16 v[20:23], a[116:119], v[44:47], v[20:23]
  v_xor_b32 v16, 0x10000, v16
  v_mfma_f32_16x16x32_bf16 v[24:27], a[244:247], v[44:47], v[24:27]
  v_mfma_f32_16x16x32_bf16 v[28:31], a[116:119], v[48:51], v[28:31]
  v_mfma_f32_16x16x32_bf16 v[32:35], a[244:247], v[48:51], v[32:35]
  s_waitcnt lgkmcnt(2)
  v_mfma_f32_16x16x32_bf16 v[20:23], a[120:123], v[52:55], v[20:23]
  v_xor_b32 v17, 0x10000, v17
  v_mfma_f32_16x16x32_bf16 v[24:27], a[248:251], v[52:55], v[24:27]
  v_mfma_f32_16x16x32_bf16 v[28:31], a[120:123], v[56:59], v[28:31]
  s_waitcnt vmcnt(0)
  s_barrier
  s_mov_b32 s64, s61
  s_cmp_lg_u32 s50, 0
  s_cbranch_scc1 Lsg_175
  v_mov_b32 v126, s64
  s_lshl_b32 s59, s2, 7
  s_mov_b64 exec, 1
  buffer_store_dword v126, off, s[4:7], s59 sc1
  s_mov_b64 exec, -1
Lsg_175:
  v_mfma_f32_16x16x32_bf16 v[32:35], a[248:251], v[56:59], v[32:35]
  s_waitcnt lgkmcnt(0)
  v_mfma_f32_16x16x32_bf16 v[20:23], a[124:127], v[60:63], v[20:23]
  v_xor_b32 v18, 0x10000, v18
  v_mfma_f32_16x16x32_bf16 v[24:27], a[252:255], v[60:63], v[24:27]
  v_xor_b32 v19, 0x10000, v19
  v_mfma_f32_16x16x32_bf16 v[28:31], a[124:127], v[64:67], v[28:31]
  v_mfma_f32_16x16x32_bf16 v[32:35], a[252:255], v[64:67], v[32:35]
  s_lshl_b32 s71, s61, 13
  s_add_u32 s71, s71, s67
  s_lshl_b32 s56, s50, 10
  s_add_u32 s71, s71, s56
  s_add_u32 s71, s71, 0x1000000
  v_mov_b32 v7, v1
  v_cvt_pk_bf16_f32 v68, v20, v24
  v_cvt_pk_bf16_f32 v69, v21, v25
  v_cvt_pk_bf16_f32 v70, v22, v26
  v_cvt_pk_bf16_f32 v71, v23, v27
  v_cvt_pk_bf16_f32 v72, v28, v32
  v_cvt_pk_bf16_f32 v73, v29, v33
  v_cvt_pk_bf16_f32 v74, v30, v34
  v_cvt_pk_bf16_f32 v75, v31, v35
  s_cmp_ge_u32 s61, 3
  s_cbranch_scc1 Lkp_176
  buffer_store_dwordx4 v[68:71], v7, s[4:7], s71 offen sc1
  s_add_u32 s71, s71, 4096
  buffer_store_dwordx4 v[72:75], v7, s[4:7], s71 offen sc1
  v_mov_b32 v7, 0x80000000
  s_add_u32 s64, s61, 1
  s_waitcnt vmcnt(0)
  s_barrier
  s_cmp_lg_u32 s50, 0
  s_cbranch_scc1 Lsg_177
  v_mov_b32 v126, s64
  s_lshl_b32 s59, s2, 7
  s_mov_b64 exec, 1
  buffer_store_dword v126, off, s[4:7], s59 sc1
  s_mov_b64 exec, -1
Lsg_177:
Lkp_176:
  s_add_u32 s61, s61, 1
  s_cmp_lt_u32 s61, s62
  s_cbranch_scc1 L_pk_loop
  buffer_store_dwordx4 v[68:71], v7, s[4:7], s71 offen sc1
  s_add_u32 s71, s71, 4096
  buffer_store_dwordx4 v[72:75], v7, s[4:7], s71 offen sc1
  s_waitcnt vmcnt(0)
  s_barrier
  s_cmp_lg_u32 s50, 0
  s_cbranch_scc1 Lsg_178
  v_mov_b32 v126, 64
  s_lshl_b32 s59, s2, 7
  s_mov_b64 exec, 1
  buffer_store_dword v126, off, s[4:7], s59 sc1
  s_mov_b64 exec, -1
Lsg_178:
  s_branch L_g3_help
L_pv:
  v_lshlrev_b32 v1, 4, v0
  s_mul_i32 s67, s52, 0x202000
  s_lshl_b32 s56, s52, 2
  s_add_u32 s56, s56, s50
  s_lshl_b32 s56, s56, 11
  v_and_b32 v127, 31, v0
  v_lshlrev_b32 v127, 6, v127
  buffer_load_dword v6, v127, s[12:15], s56 offen
  s_cmp_lg_u32 s50, 0
  s_cbranch_scc1 Lar_179
  s_cmp_eq_u32 s100, 0
  s_cbranch_scc0 Lar_179
  s_mov_b32 s56, 0
  v_mov_b32 v126, 1
  s_mov_b64 exec, 1
  buffer_atomic_add v126, off, s[20:23], s56 sc1
  s_mov_b64 exec, -1
Lar_179:
  s_mov_b32 s8, s32
  s_mov_b32 s9, s33
  s_mov_b32 s10, 0x800000
  s_mov_b32 s11, 0x20000
  v_lshrrev_b32 v126, 3, v0
  v_lshlrev_b32 v2, 13, v126
  v_and_b32 v126, 2, v126
  v_xor_b32 v126, v126, v0
  v_and_b32 v126, 7, v126
  v_lshlrev_b32 v126, 4, v126
  v_xor_b32 v3, 64, v126
  v_add_u32 v3, v3, v2
  v_add_u32 v2, v126, v2
  v_lshrrev_b32 v126, 4, v0
  v_lshlrev_b32 v126, 3, v126
  v_bfe_u32 v127, v0, 2, 2
  v_add_u32 v126, v126, v127
  v_lshrrev_b32 v127, 5, v0
  v_lshlrev_b32 v127, 1, v127
  v_bfe_u32 v4, v0, 3, 1
  v_or_b32 v127, v127, v4
  v_lshlrev_b32 v126, 7, v126
  s_and_b32 s56, s50, 1
  s_lshl_b32 s56, s56, 1
  v_xor_b32 v127, s56, v127
  v_and_b32 v4, 3, v0
  v_lshl_add_u32 v126, v4, 3, v126
  v_lshl_add_u32 v126, v127, 5, v126
  v_xor_b32 v68, 0, v126
  v_add_u32 v72, 0x10000, v68
  v_xor_b32 v69, 32, v126
  v_add_u32 v73, 0x10000, v69
  v_xor_b32 v70, 64, v126
  v_add_u32 v74, 0x10000, v70
  v_xor_b32 v71, 96, v126
  v_add_u32 v75, 0x10000, v71
  s_lshl_b32 s60, s52, 8
  s_mul_i32 s56, s50, 2097152
  s_add_u32 s60, s60, s56
  s_lshl_b32 s56, s50, 15
  s_add_u32 s56, s56, 0
  s_sub_u32 s57, s60, 65536
  s_mov_b32 s58, 4
Ldma_180:
  s_mov_b32 m0, s56
  s_add_u32 s57, s57, 65536
  buffer_load_dwordx4 v2, s[8:11], s57 offen lds
  s_add_u32 s56, s56, 1024
  s_mov_b32 m0, s56
  s_add_u32 s57, s57, 65536
  buffer_load_dwordx4 v2, s[8:11], s57 offen lds
  s_add_u32 s56, s56, 1024
  s_mov_b32 m0, s56
  s_add_u32 s57, s57, 65536
  buffer_load_dwordx4 v3, s[8:11], s57 offen lds
  s_add_u32 s56, s56, 1024
  s_mov_b32 m0, s56
  s_add_u32 s57, s57, 65536
  buffer_load_dwordx4 v3, s[8:11], s57 offen lds
  s_add_u32 s56, s56, 1024
  s_sub_u32 s58, s58, 1
  s_cmp_lg_u32 s58, 0
  s_cbranch_scc1 Ldma_180
  s_lshl_b32 s60, s52, 8
  s_mul_i32 s56, s50, 2097152
  s_add_u32 s60, s60, s56
  s_add_u32 s60, s60, 1048576
  s_lshl_b32 s56, s50, 15
  s_add_u32 s56, s56, 16384
  s_sub_u32 s57, s60, 65536
  s_mov_b32 s58, 4
Ldma_181:
  s_mov_b32 m0, s56
  s_add_u32 s57, s57, 65536
  buffer_load_dwordx4 v2, s[8:11], s57 offen lds
  s_add_u32 s56, s56, 1024
  s_mov_b32 m0, s56
  s_add_u32 s57, s57, 65536
  buffer_load_dwordx4 v2, s[8:11], s57 offen lds
  s_add_u32 s56, s56, 1024
  s_mov_b32 m0, s56
  s_add_u32 s57, s57, 65536
  buffer_load_dwordx4 v3, s[8:11], s57 offen lds
  s_add_u32 s56, s56, 1024
  s_mov_b32 m0, s56
  s_add_u32 s57, s57, 65536
  buffer_load_dwordx4 v3, s[8:11], s57 offen lds
  s_add_u32 s56, s56, 1024
  s_sub_u32 s58, s58, 1
  s_cmp_lg_u32 s58, 0
  s_cbranch_scc1 Ldma_181
  s_waitcnt vmcnt(16)
  s_barrier
  s_lshr_b32 s56, s50, 1
  s_cmp_lg_u32 s56, 0
  s_cbranch_scc1 Lro_182
  ds_read_b64_tr_b16 a[0:1], v68 offset:0
  ds_read_b64_tr_b16 a[2:3], v68 offset:512
  ds_read_b64_tr_b16 a[4:5], v68 offset:4096
  ds_read_b64_tr_b16 a[6:7], v68 offset:4608
  ds_read_b64_tr_b16 a[8:9], v68 offset:8192
  ds_read_b64_tr_b16 a[10:11], v68 offset:8704
  ds_read_b64_tr_b16 a[12:13], v68 offset:12288
  ds_read_b64_tr_b16 a[14:15], v68 offset:12800
  ds_read_b64_tr_b16 a[32:33], v68 offset:32768
  ds_read_b64_tr_b16 a[34:35], v68 offset:33280
  ds_read_b64_tr_b16 a[36:37], v68 offset:36864
  ds_read_b64_tr_b16 a[38:39], v68 offset:37376
  ds_read_b64_tr_b16 a[40:41], v68 offset:40960
  ds_read_b64_tr_b16 a[42:43], v68 offset:41472
  ds_read_b64_tr_b16 a[44:45], v68 offset:45056
  ds_read_b64_tr_b16 a[46:47], v68 offset:45568
  ds_read_b64_tr_b16 a[64:65], v72 offset:0
  ds_read_b64_tr_b16 a[66:67], v72 offset:512
  ds_read_b64_tr_b16 a[68:69], v72 offset:4096
  ds_read_b64_tr_b16 a[70:71], v72 offset:4608
  ds_read_b64_tr_b16 a[72:73], v72 offset:8192
  ds_read_b64_tr_b16 a[74:75], v72 offset:8704
  ds_read_b64_tr_b16 a[76:77], v72 offset:12288
  ds_read_b64_tr_b16 a[78:79], v72 offset:12800
  ds_read_b64_tr_b16 a[96:97], v72 offset:32768
  ds_read_b64_tr_b16 a[98:99], v72 offset:33280
  ds_read_b64_tr_b16 a[100:101], v72 offset:36864
  ds_read_b64_tr_b16 a[102:103], v72 offset:37376
  ds_read_b64_tr_b16 a[104:105], v72 offset:40960
  ds_read_b64_tr_b16 a[106:107], v72 offset:41472
  ds_read_b64_tr_b16 a[108:109], v72 offset:45056
  ds_read_b64_tr_b16 a[110:111], v72 offset:45568
  ds_read_b64_tr_b16 a[128:129], v69 offset:0
  ds_read_b64_tr_b16 a[130:131], v69 offset:512
  ds_read_b64_tr_b16 a[132:133], v69 offset:4096
  ds_read_b64_tr_b16 a[134:135], v69 offset:4608
  ds_read_b64_tr_b16 a[136:137], v69 offset:8192
  ds_read_b64_tr_b16 a[138:139], v69 offset:8704
  ds_read_b64_tr_b16 a[140:141], v69 offset:12288
  ds_read_b64_tr_b16 a[142:143], v69 offset:12800
  ds_read_b64_tr_b16 a[160:161], v69 offset:32768
  ds_read_b64_tr_b16 a[162:163], v69 offset:33280
  ds_read_b64_tr_b16 a[164:165], v69 offset:36864
  ds_read_b64_tr_b16 a[166:167], v69 offset:37376
  ds_read_b64_tr_b16 a[168:169], v69 offset:40960
  ds_read_b64_tr_b16 a[170:171], v69 offset:41472
  ds_read_b64_tr_b16 a[172:173], v69 offset:45056
  ds_read_b64_tr_b16 a[174:175], v69 offset:45568
  ds_read_b64_tr_b16 a[192:193], v73 offset:0
  ds_read_b64_tr_b16 a[194:195], v73 offset:512
  ds_read_b64_tr_b16 a[196:197], v73 offset:4096
  ds_read_b64_tr_b16 a[198:199], v73 offset:4608
  ds_read_b64_tr_b16 a[200:201], v73 offset:8192
  ds_read_b64_tr_b16 a[202:203], v73 offset:8704
  ds_read_b64_tr_b16 a[204:205], v73 offset:12288
  ds_read_b64_tr_b16 a[206:207], v73 offset:12800
  ds_read_b64_tr_b16 a[224:225], v73 offset:32768
  ds_read_b64_tr_b16 a[226:227], v73 offset:33280
  ds_read_b64_tr_b16 a[228:229], v73 offset:36864
  ds_read_b64_tr_b16 a[230:231], v73 offset:37376
  ds_read_b64_tr_b16 a[232:233], v73 offset:40960
  ds_read_b64_tr_b16 a[234:235], v73 offset:41472
  ds_read_b64_tr_b16 a[236:237], v73 offset:45056
  ds_read_b64_tr_b16 a[238:239], v73 offset:45568
Lro_182:
  s_waitcnt lgkmcnt(0)
  s_barrier
  s_lshl_b32 s60, s52, 8
  s_add_u32 s60, s60, 128
  s_mul_i32 s56, s50, 2097152
  s_add_u32 s60, s60, s56
  s_lshl_b32 s56, s50, 15
  s_add_u32 s56, s56, 0
  s_sub_u32 s57, s60, 65536
  s_mov_b32 s58, 4
Ldma_183:
  s_mov_b32 m0, s56
  s_add_u32 s57, s57, 65536
  buffer_load_dwordx4 v2, s[8:11], s57 offen lds
  s_add_u32 s56, s56, 1024
  s_mov_b32 m0, s56
  s_add_u32 s57, s57, 65536
  buffer_load_dwordx4 v2, s[8:11], s57 offen lds
  s_add_u32 s56, s56, 1024
  s_mov_b32 m0, s56
  s_add_u32 s57, s57, 65536
  buffer_load_dwordx4 v3, s[8:11], s57 offen lds
  s_add_u32 s56, s56, 1024
  s_mov_b32 m0, s56
  s_add_u32 s57, s57, 65536
  buffer_load_dwordx4 v3, s[8:11], s57 offen lds
  s_add_u32 s56, s56, 1024
  s_sub_u32 s58, s58, 1
  s_cmp_lg_u32 s58, 0
  s_cbranch_scc1 Ldma_183
  s_waitcnt vmcnt(16)
  s_barrier
  s_lshr_b32 s56, s50, 1
  s_cmp_lg_u32 s56, 0
  s_cbranch_scc1 Lro_184
  ds_read_b64_tr_b16 a[16:17], v68 offset:16384
  ds_read_b64_tr_b16 a[18:19], v68 offset:16896
  ds_read_b64_tr_b16 a[20:21], v68 offset:20480
  ds_read_b64_tr_b16 a[22:23], v68 offset:20992
  ds_read_b64_tr_b16 a[24:25], v68 offset:24576
  ds_read_b64_tr_b16 a[26:27], v68 offset:25088
  ds_read_b64_tr_b16 a[28:29], v68 offset:28672
  ds_read_b64_tr_b16 a[30:31], v68 offset:29184
  ds_read_b64_tr_b16 a[48:49], v68 offset:49152
  ds_read_b64_tr_b16 a[50:51], v68 offset:49664
  ds_read_b64_tr_b16 a[52:53], v68 offset:53248
  ds_read_b64_tr_b16 a[54:55], v68 offset:53760
  ds_read_b64_tr_b16 a[56:57], v68 offset:57344
  ds_read_b64_tr_b16 a[58:59], v68 offset:57856
  ds_read_b64_tr_b16 a[60:61], v68 offset:61440
  ds_read_b64_tr_b16 a[62:63], v68 offset:61952
  ds_read_b64_tr_b16 a[80:81], v72 offset:16384
  ds_read_b64_tr_b16 a[82:83], v72 offset:16896
  ds_read_b64_tr_b16 a[84:85], v72 offset:20480
  ds_read_b64_tr_b16 a[86:87], v72 offset:20992
  ds_read_b64_tr_b16 a[88:89], v72 offset:24576
  ds_read_b64_tr_b16 a[90:91], v72 offset:25088
  ds_read_b64_tr_b16 a[92:93], v72 offset:28672
  ds_read_b64_tr_b16 a[94:95], v72 offset:29184
  ds_read_b64_tr_b16 a[112:113], v72 offset:49152
  ds_read_b64_tr_b16 a[114:115], v72 offset:49664
  ds_read_b64_tr_b16 a[116:117], v72 offset:53248
  ds_read_b64_tr_b16 a[118:119], v72 offset:53760
  ds_read_b64_tr_b16 a[120:121], v72 offset:57344
  ds_read_b64_tr_b16 a[122:123], v72 offset:57856
  ds_read_b64_tr_b16 a[124:125], v72 offset:61440
  ds_read_b64_tr_b16 a[126:127], v72 offset:61952
  ds_read_b64_tr_b16 a[144:145], v69 offset:16384
  ds_read_b64_tr_b16 a[146:147], v69 offset:16896
  ds_read_b64_tr_b16 a[148:149], v69 offset:20480
  ds_read_b64_tr_b16 a[150:151], v69 offset:20992
  ds_read_b64_tr_b16 a[152:153], v69 offset:24576
  ds_read_b64_tr_b16 a[154:155], v69 offset:25088
  ds_read_b64_tr_b16 a[156:157], v69 offset:28672
  ds_read_b64_tr_b16 a[158:159], v69 offset:29184
  ds_read_b64_tr_b16 a[176:177], v69 offset:49152
  ds_read_b64_tr_b16 a[178:179], v69 offset:49664
  ds_read_b64_tr_b16 a[180:181], v69 offset:53248
  ds_read_b64_tr_b16 a[182:183], v69 offset:53760
  ds_read_b64_tr_b16 a[184:185], v69 offset:57344
  ds_read_b64_tr_b16 a[186:187], v69 offset:57856
  ds_read_b64_tr_b16 a[188:189], v69 offset:61440
  ds_read_b64_tr_b16 a[190:191], v69 offset:61952
  ds_read_b64_tr_b16 a[208:209], v73 offset:16384
  ds_read_b64_tr_b16 a[210:211], v73 offset:16896
  ds_read_b64_tr_b16 a[212:213], v73 offset:20480
  ds_read_b64_tr_b16 a[214:215], v73 offset:20992
  ds_read_b64_tr_b16 a[216:217], v73 offset:24576
  ds_read_b64_tr_b16 a[218:219], v73 offset:25088
  ds_read_b64_tr_b16 a[220:221], v73 offset:28672
  ds_read_b64_tr_b16 a[222:223], v73 offset:29184
  ds_read_b64_tr_b16 a[240:241], v73 offset:49152
  ds_read_b64_tr_b16 a[242:243], v73 offset:49664
  ds_read_b64_tr_b16 a[244:245], v73 offset:53248
  ds_read_b64_tr_b16 a[246:247], v73 offset:53760
  ds_read_b64_tr_b16 a[248:249], v73 offset:57344
  ds_read_b64_tr_b16 a[250:251], v73 offset:57856
  ds_read_b64_tr_b16 a[252:253], v73 offset:61440
  ds_read_b64_tr_b16 a[254:255], v73 offset:61952
Lro_184:
  s_waitcnt lgkmcnt(0)
  s_barrier
  s_lshl_b32 s60, s52, 8
  s_add_u32 s60, s60, 128
  s_mul_i32 s56, s50, 2097152
  s_add_u32 s60, s60, s56
  s_add_u32 s60, s60, 1048576
  s_lshl_b32 s56, s50, 15
  s_add_u32 s56, s56, 16384
  s_sub_u32 s57, s60, 65536
  s_mov_b32 s58, 4
Ldma_185:
  s_mov_b32 m0, s56
  s_add_u32 s57, s57, 65536
  buffer_load_dwordx4 v2, s[8:11], s57 offen lds
  s_add_u32 s56, s56, 1024
  s_mov_b32 m0, s56
  s_add_u32 s57, s57, 65536
  buffer_load_dwordx4 v2, s[8:11], s57 offen lds
  s_add_u32 s56, s56, 1024
  s_mov_b32 m0, s56
  s_add_u32 s57, s57, 65536
  buffer_load_dwordx4 v3, s[8:11], s57 offen lds
  s_add_u32 s56, s56, 1024
  s_mov_b32 m0, s56
  s_add_u32 s57, s57, 65536
  buffer_load_dwordx4 v3, s[8:11], s57 offen lds
  s_add_u32 s56, s56, 1024
  s_sub_u32 s58, s58, 1
  s_cmp_lg_u32 s58, 0
  s_cbranch_scc1 Ldma_185
  s_waitcnt vmcnt(16)
  s_barrier
  s_lshr_b32 s56, s50, 1
  s_cmp_lg_u32 s56, 1
  s_cbranch_scc1 Lro_186
  ds_read_b64_tr_b16 a[0:1], v68 offset:0
  ds_read_b64_tr_b16 a[2:3], v68 offset:512
  ds_read_b64_tr_b16 a[4:5], v68 offset:4096
  ds_read_b64_tr_b16 a[6:7], v68 offset:4608
  ds_read_b64_tr_b16 a[8:9], v68 offset:8192
  ds_read_b64_tr_b16 a[10:11], v68 offset:8704
  ds_read_b64_tr_b16 a[12:13], v68 offset:12288
  ds_read_b64_tr_b16 a[14:15], v68 offset:12800
  ds_read_b64_tr_b16 a[32:33], v68 offset:32768
  ds_read_b64_tr_b16 a[34:35], v68 offset:33280
  ds_read_b64_tr_b16 a[36:37], v68 offset:36864
  ds_read_b64_tr_b16 a[38:39], v68 offset:37376
  ds_read_b64_tr_b16 a[40:41], v68 offset:40960
  ds_read_b64_tr_b16 a[42:43], v68 offset:41472
  ds_read_b64_tr_b16 a[44:45], v68 offset:45056
  ds_read_b64_tr_b16 a[46:47], v68 offset:45568
  ds_read_b64_tr_b16 a[64:65], v72 offset:0
  ds_read_b64_tr_b16 a[66:67], v72 offset:512
  ds_read_b64_tr_b16 a[68:69], v72 offset:4096
  ds_read_b64_tr_b16 a[70:71], v72 offset:4608
  ds_read_b64_tr_b16 a[72:73], v72 offset:8192
  ds_read_b64_tr_b16 a[74:75], v72 offset:8704
  ds_read_b64_tr_b16 a[76:77], v72 offset:12288
  ds_read_b64_tr_b16 a[78:79], v72 offset:12800
  ds_read_b64_tr_b16 a[96:97], v72 offset:32768
  ds_read_b64_tr_b16 a[98:99], v72 offset:33280
  ds_read_b64_tr_b16 a[100:101], v72 offset:36864
  ds_read_b64_tr_b16 a[102:103], v72 offset:37376
  ds_read_b64_tr_b16 a[104:105], v72 offset:40960
  ds_read_b64_tr_b16 a[106:107], v72 offset:41472
  ds_read_b64_tr_b16 a[108:109], v72 offset:45056
  ds_read_b64_tr_b16 a[110:111], v72 offset:45568
  ds_read_b64_tr_b16 a[128:129], v69 offset:0
  ds_read_b64_tr_b16 a[130:131], v69 offset:512
  ds_read_b64_tr_b16 a[132:133], v69 offset:4096
  ds_read_b64_tr_b16 a[134:135], v69 offset:4608
  ds_read_b64_tr_b16 a[136:137], v69 offset:8192
  ds_read_b64_tr_b16 a[138:139], v69 offset:8704
  ds_read_b64_tr_b16 a[140:141], v69 offset:12288
  ds_read_b64_tr_b16 a[142:143], v69 offset:12800
  ds_read_b64_tr_b16 a[160:161], v69 offset:32768
  ds_read_b64_tr_b16 a[162:163], v69 offset:33280
  ds_read_b64_tr_b16 a[164:165], v69 offset:36864
  ds_read_b64_tr_b16 a[166:167], v69 offset:37376
  ds_read_b64_tr_b16 a[168:169], v69 offset:40960
  ds_read_b64_tr_b16 a[170:171], v69 offset:41472
  ds_read_b64_tr_b16 a[172:173], v69 offset:45056
  ds_read_b64_tr_b16 a[174:175], v69 offset:45568
  ds_read_b64_tr_b16 a[192:193], v73 offset:0
  ds_read_b64_tr_b16 a[194:195], v73 offset:512
  ds_read_b64_tr_b16 a[196:197], v73 offset:4096
  ds_read_b64_tr_b16 a[198:199], v73 offset:4608
  ds_read_b64_tr_b16 a[200:201], v73 offset:8192
  ds_read_b64_tr_b16 a[202:203], v73 offset:8704
  ds_read_b64_tr_b16 a[204:205], v73 offset:12288
  ds_read_b64_tr_b16 a[206:207], v73 offset:12800
  ds_read_b64_tr_b16 a[224:225], v73 offset:32768
  ds_read_b64_tr_b16 a[226:227], v73 offset:33280
  ds_read_b64_tr_b16 a[228:229], v73 offset:36864
  ds_read_b64_tr_b16 a[230:231], v73 offset:37376
  ds_read_b64_tr_b16 a[232:233], v73 offset:40960
  ds_read_b64_tr_b16 a[234:235], v73 offset:41472
  ds_read_b64_tr_b16 a[236:237], v73 offset:45056
  ds_read_b64_tr_b16 a[238:239], v73 offset:45568
Lro_186:
  s_waitcnt lgkmcnt(0)
  s_barrier
  v_lshlrev_b32 v37, 2, v0
  buffer_load_dword v36, v37, s[20:23], 0 offen sc1
  s_waitcnt vmcnt(0)
  s_barrier
  s_lshr_b32 s56, s50, 1
  s_cmp_lg_u32 s56, 1
  s_cbranch_scc1 Lro_187
  ds_read_b64_tr_b16 a[16:17], v68 offset:16384
  ds_read_b64_tr_b16 a[18:19], v68 offset:16896
  ds_read_b64_tr_b16 a[20:21], v68 offset:20480
  ds_read_b64_tr_b16 a[22:23], v68 offset:20992
  ds_read_b64_tr_b16 a[24:25], v68 offset:24576
  ds_read_b64_tr_b16 a[26:27], v68 offset:25088
  ds_read_b64_tr_b16 a[28:29], v68 offset:28672
  ds_read_b64_tr_b16 a[30:31], v68 offset:29184
  ds_read_b64_tr_b16 a[48:49], v68 offset:49152
  ds_read_b64_tr_b16 a[50:51], v68 offset:49664
  ds_read_b64_tr_b16 a[52:53], v68 offset:53248
  ds_read_b64_tr_b16 a[54:55], v68 offset:53760
  ds_read_b64_tr_b16 a[56:57], v68 offset:57344
  ds_read_b64_tr_b16 a[58:59], v68 offset:57856
  ds_read_b64_tr_b16 a[60:61], v68 offset:61440
  ds_read_b64_tr_b16 a[62:63], v68 offset:61952
  ds_read_b64_tr_b16 a[80:81], v72 offset:16384
  ds_read_b64_tr_b16 a[82:83], v72 offset:16896
  ds_read_b64_tr_b16 a[84:85], v72 offset:20480
  ds_read_b64_tr_b16 a[86:87], v72 offset:20992
  ds_read_b64_tr_b16 a[88:89], v72 offset:24576
  ds_read_b64_tr_b16 a[90:91], v72 offset:25088
  ds_read_b64_tr_b16 a[92:93], v72 offset:28672
  ds_read_b64_tr_b16 a[94:95], v72 offset:29184
  ds_read_b64_tr_b16 a[112:113], v72 offset:49152
  ds_read_b64_tr_b16 a[114:115], v72 offset:49664
  ds_read_b64_tr_b16 a[116:117], v72 offset:53248
  ds_read_b64_tr_b16 a[118:119], v72 offset:53760
  ds_read_b64_tr_b16 a[120:121], v72 offset:57344
  ds_read_b64_tr_b16 a[122:123], v72 offset:57856
  ds_read_b64_tr_b16 a[124:125], v72 offset:61440
  ds_read_b64_tr_b16 a[126:127], v72 offset:61952
  ds_read_b64_tr_b16 a[144:145], v69 offset:16384
  ds_read_b64_tr_b16 a[146:147], v69 offset:16896
  ds_read_b64_tr_b16 a[148:149], v69 offset:20480
  ds_read_b64_tr_b16 a[150:151], v69 offset:20992
  ds_read_b64_tr_b16 a[152:153], v69 offset:24576
  ds_read_b64_tr_b16 a[154:155], v69 offset:25088
  ds_read_b64_tr_b16 a[156:157], v69 offset:28672
  ds_read_b64_tr_b16 a[158:159], v69 offset:29184
  ds_read_b64_tr_b16 a[176:177], v69 offset:49152
  ds_read_b64_tr_b16 a[178:179], v69 offset:49664
  ds_read_b64_tr_b16 a[180:181], v69 offset:53248
  ds_read_b64_tr_b16 a[182:183], v69 offset:53760
  ds_read_b64_tr_b16 a[184:185], v69 offset:57344
  ds_read_b64_tr_b16 a[186:187], v69 offset:57856
  ds_read_b64_tr_b16 a[188:189], v69 offset:61440
  ds_read_b64_tr_b16 a[190:191], v69 offset:61952
  ds_read_b64_tr_b16 a[208:209], v73 offset:16384
  ds_read_b64_tr_b16 a[210:211], v73 offset:16896
  ds_read_b64_tr_b16 a[212:213], v73 offset:20480
  ds_read_b64_tr_b16 a[214:215], v73 offset:20992
  ds_read_b64_tr_b16 a[216:217], v73 offset:24576
  ds_read_b64_tr_b16 a[218:219], v73 offset:25088
  ds_read_b64_tr_b16 a[220:221], v73 offset:28672
  ds_read_b64_tr_b16 a[222:223], v73 offset:29184
  ds_read_b64_tr_b16 a[240:241], v73 offset:49152
  ds_read_b64_tr_b16 a[242:243], v73 offset:49664
  ds_read_b64_tr_b16 a[244:245], v73 offset:53248
  ds_read_b64_tr_b16 a[246:247], v73 offset:53760
  ds_read_b64_tr_b16 a[248:249], v73 offset:57344
  ds_read_b64_tr_b16 a[250:251], v73 offset:57856
  ds_read_b64_tr_b16 a[252:253], v73 offset:61440
  ds_read_b64_tr_b16 a[254:255], v73 offset:61952
Lro_187:
  s_waitcnt lgkmcnt(0)
  s_barrier
  s_branch Lwa_192
Lwa_188:
  v_lshlrev_b32 v37, 2, v0
  buffer_load_dword v36, v37, s[20:23], 0 offen sc1
  s_waitcnt vmcnt(0)
Lwa_192:
  s_cmp_eq_u32 s100, 0
  s_cbranch_scc1 Lwa_190
  s_mov_b32 s56, 0
  v_readlane_b32 s57, v36, 8
  s_add_u32 s56, s56, s57
  v_readlane_b32 s57, v36, 9
  s_add_u32 s56, s56, s57
  v_readlane_b32 s57, v36, 10
  s_add_u32 s56, s56, s57
  v_readlane_b32 s57, v36, 11
  s_add_u32 s56, s56, s57
  v_readlane_b32 s57, v36, 12
  s_add_u32 s56, s56, s57
  v_readlane_b32 s57, v36, 13
  s_add_u32 s56, s56, s57
  v_readlane_b32 s57, v36, 14
  s_add_u32 s56, s56, s57
  v_readlane_b32 s57, v36, 15
  s_add_u32 s56, s56, s57
  v_readlane_b32 s57, v36, 16
  s_add_u32 s56, s56, s57
  v_readlane_b32 s57, v36, 40
  s_add_u32 s56, s56, s57
  v_readlane_b32 s57, v36, 41
  s_add_u32 s56, s56, s57
  v_readlane_b32 s57, v36, 42
  s_add_u32 s56, s56, s57
  v_readlane_b32 s57, v36, 43
  s_add_u32 s56, s56, s57
  v_readlane_b32 s57, v36, 44
  s_add_u32 s56, s56, s57
  v_readlane_b32 s57, v36, 45
  s_add_u32 s56, s56, s57
  v_readlane_b32 s57, v36, 46
  s_add_u32 s56, s56, s57
  v_readlane_b32 s57, v36, 47
  s_add_u32 s56, s56, s57
  v_readlane_b32 s57, v36, 48
  s_add_u32 s56, s56, s57
  s_cmp_lt_u32 s56, 256
  s_cbranch_scc1 Lwa_191
  s_lshr_b32 s58, s100, 2
  v_readlane_b32 s56, v36, s58
  s_add_u32 s58, s58, 32
  v_readlane_b32 s57, v36, s58
  s_add_u32 s56, s56, s57
  s_cmp_eq_u32 s58, 48
  s_cselect_b32 s56, 0, s56
  s_cmp_lt_u32 s56, 256
  s_cbranch_scc1 L_restart
  v_readlane_b32 s56, v36, 32
  s_cmp_ge_u32 s56, 128
  s_cbranch_scc1 Lwa_189
  s_branch Lwa_191
Lwa_190:
  v_readlane_b32 s56, v36, 0
  s_cmp_ge_u32 s56, 256
  s_cbranch_scc1 Lwa_189
Lwa_191:
  s_sleep 8
  s_add_u32 s55, s55, 1
  s_bitcmp1_b32 s55, 21
  s_cbranch_scc1 L_abort
  s_branch Lwa_188
Lwa_189:
  s_mov_b32 s61, 0
  s_mov_b32 s62, 64
  s_mov_b32 s71, 0
  s_lshl_b32 s56, s50, 3
  s_add_u32 s56, s56, 0
  s_and_b32 s57, s56, 15
  v_xor_b32 v126, s57, v0
  s_lshl_b32 s56, s56, 11
  v_lshl_add_u32 v8, v126, 4, s56
  s_lshl_b32 s56, s50, 3
  s_add_u32 s56, s56, 1
  s_and_b32 s57, s56, 15
  v_xor_b32 v126, s57, v0
  s_lshl_b32 s56, s56, 11
  v_lshl_add_u32 v9, v126, 4, s56
  s_lshl_b32 s56, s50, 3
  s_add_u32 s56, s56, 2
  s_and_b32 s57, s56, 15
  v_xor_b32 v126, s57, v0
  s_lshl_b32 s56, s56, 11
  v_lshl_add_u32 v10, v126, 4, s56
  s_lshl_b32 s56, s50, 3
  s_add_u32 s56, s56, 3
  s_and_b32 s57, s56, 15
  v_xor_b32 v126, s57, v0
  s_lshl_b32 s56, s56, 11
  v_lshl_add_u32 v11, v126, 4, s56
  s_lshl_b32 s56, s50, 3
  s_add_u32 s56, s56, 4
  s_and_b32 s57, s56, 15
  v_xor_b32 v126, s57, v0
  s_lshl_b32 s56, s56, 11
  v_lshl_add_u32 v12, v126, 4, s56
  s_lshl_b32 s56, s50, 3
  s_add_u32 s56, s56, 5
  s_and_b32 s57, s56, 15
  v_xor_b32 v126, s57, v0
  s_lshl_b32 s56, s56, 11
  v_lshl_add_u32 v13, v126, 4, s56
  s_lshl_b32 s56, s50, 3
  s_add_u32 s56, s56, 6
  s_and_b32 s57, s56, 15
  v_xor_b32 v126, s57, v0
  s_lshl_b32 s56, s56, 11
  v_lshl_add_u32 v14, v126, 4, s56
  s_lshl_b32 s56, s50, 3
  s_add_u32 s56, s56, 7
  s_and_b32 s57, s56, 15
  v_xor_b32 v126, s57, v0
  s_lshl_b32 s56, s56, 11
  v_lshl_add_u32 v15, v126, 4, s56
  v_lshrrev_b32 v126, 4, v0
  v_add_u32 v126, 0, v126
  v_and_b32 v127, 15, v0
  v_xor_b32 v126, v126, v127
  v_lshlrev_b32 v126, 4, v126
  v_lshl_add_u32 v16, v127, 11, v126
  v_lshrrev_b32 v126, 4, v0
  v_add_u32 v126, 4, v126
  v_and_b32 v127, 15, v0
  v_xor_b32 v126, v126, v127
  v_lshlrev_b32 v126, 4, v126
  v_lshl_add_u32 v17, v127, 11, v126
  v_lshrrev_b32 v126, 4, v0
  v_add_u32 v126, 8, v126
  v_and_b32 v127, 15, v0
  v_xor_b32 v126, v126, v127
  v_lshlrev_b32 v126, 4, v126
  v_lshl_add_u32 v18, v127, 11, v126
  v_lshrrev_b32 v126, 4, v0
  v_add_u32 v126, 12, v126
  v_and_b32 v127, 15, v0
  v_xor_b32 v126, v126, v127
  v_lshlrev_b32 v126, 4, v126
  v_lshl_add_u32 v19, v127, 11, v126
  s_mov_b32 s56, s52
  s_lshl_b32 s56, s56, 2
  s_add_u32 s56, s56, s50
  s_mul_i32 s56, s56, 512
  v_lshl_add_u32 v5, v0, 6, s56
  v_cmp_gt_u32 vcc, 8, v0
  v_mov_b32 v7, 0x80000000
  s_nop 0
  v_cndmask_b32 v5, v7, v5, vcc
  s_add_u32 s70, s61, 0
  s_sub_u32 s56, s62, 1
  s_min_u32 s70, s70, s56
  s_lshl_b32 s70, s70, 16
  buffer_load_dword v6, v5, s[12:15], s70 offen
  s_add_u32 s70, s61, 1
  s_sub_u32 s56, s62, 1
  s_min_u32 s70, s70, s56
  s_lshl_b32 s70, s70, 16
  buffer_load_dword v6, v5, s[12:15], s70 offen
  s_add_u32 s70, s61, 2
  s_sub_u32 s56, s62, 1
  s_min_u32 s70, s70, s56
  s_lshl_b32 s70, s70, 16
  buffer_load_dword v6, v5, s[12:15], s70 offen
  s_lshl_b32 s65, s50, 14
  s_add_u32 s63, s61, 0
  s_sub_u32 s56, s62, 1
  s_min_u32 s63, s63, s56
  s_lshl_b32 s63, s63, 16
  s_add_u32 m0, s65, 0
  s_nop 0
  buffer_load_dwordx4 v8, s[12:15], s63 offen lds
  buffer_load_dwordx4 v8, s[12:15], s63 offen offset:1024 lds
  s_add_u32 m0, s65, 2048
  s_nop 0
  buffer_load_dwordx4 v9, s[12:15], s63 offen lds
  buffer_load_dwordx4 v9, s[12:15], s63 offen offset:1024 lds
  s_add_u32 m0, s65, 4096
  s_nop 0
  buffer_load_dwordx4 v10, s[12:15], s63 offen lds
  buffer_load_dwordx4 v10, s[12:15], s63 offen offset:1024 lds
  s_add_u32 m0, s65, 6144
  s_nop 0
  buffer_load_dwordx4 v11, s[12:15], s63 offen lds
  buffer_load_dwordx4 v11, s[12:15], s63 offen offset:1024 lds
  s_add_u32 m0, s65, 8192
  s_nop 0
  buffer_load_dwordx4 v12, s[12:15], s63 offen lds
  buffer_load_dwordx4 v12, s[12:15], s63 offen offset:1024 lds
  s_add_u32 m0, s65, 10240
  s_nop 0
  buffer_load_dwordx4 v13, s[12:15], s63 offen lds
  buffer_load_dwordx4 v13, s[12:15], s63 offen offset:1024 lds
  s_add_u32 m0, s65, 12288
  s_nop 0
  buffer_load_dwordx4 v14, s[12:15], s63 offen lds
  buffer_load_dwordx4 v14, s[12:15], s63 offen offset:1024 lds
  s_add_u32 m0, s65, 14336
  s_nop 0
  buffer_load_dwordx4 v15, s[12:15], s63 offen lds
  buffer_load_dwordx4 v15, s[12:15], s63 offen offset:1024 lds
  s_waitcnt vmcnt(0)
L_pv_loop:
  s_waitcnt vmcnt(3)
  s_barrier
  ds_read_b128 v[36:39], v16 offset:0
  ds_read_b128 v[40:43], v16 offset:32768
  ds_read_b128 v[44:47], v17 offset:0
  ds_read_b128 v[48:51], v17 offset:32768
  ds_read_b128 v[52:55], v18 offset:0
  ds_read_b128 v[56:59], v18 offset:32768
  s_xor_b32 s65, s65, 0x10000
  s_add_u32 s63, s61, 1
  s_sub_u32 s56, s62, 1
  s_min_u32 s63, s63, s56
  s_lshl_b32 s63, s63, 16
  s_add_u32 s70, s61, 3
  s_sub_u32 s56, s62, 1
  s_min_u32 s70, s70, s56
  s_lshl_b32 s70, s70, 16
  s_waitcnt lgkmcnt(4)
  v_mfma_f32_16x16x32_bf16 v[20:23], v[36:39], a[0:3], 0
  ds_read_b128 v[60:63], v19 offset:0
  v_mfma_f32_16x16x32_bf16 v[24:27], v[36:39], a[128:131], 0
  ds_read_b128 v[64:67], v19 offset:32768
  s_add_u32 m0, s65, 0
  v_mfma_f32_16x16x32_bf16 v[28:31], v[40:43], a[0:3], 0
  buffer_load_dwordx4 v8, s[12:15], s63 offen lds
  v_mfma_f32_16x16x32_bf16 v[32:35], v[40:43], a[128:131], 0
  s_waitcnt lgkmcnt(4)
  v_mfma_f32_16x16x32_bf16 v[20:23], v[44:47], a[4:7], v[20:23]
  ds_read_b128 v[36:39], v16 offset:256
  v_mfma_f32_16x16x32_bf16 v[24:27], v[44:47], a[132:135], v[24:27]
  ds_read_b128 v[40:43], v16 offset:33024
  v_mfma_f32_16x16x32_bf16 v[28:31], v[48:51], a[4:7], v[28:31]
  buffer_load_dwordx4 v8, s[12:15], s63 offen offset:1024 lds
  v_mfma_f32_16x16x32_bf16 v[32:35], v[48:51], a[132:135], v[32:35]
  s_waitcnt lgkmcnt(4)
  v_mfma_f32_16x16x32_bf16 v[20:23], v[52:55], a[8:11], v[20:23]
  ds_read_b128 v[44:47], v17 offset:256
  v_mfma_f32_16x16x32_bf16 v[24:27], v[52:55], a[136:139], v[24:27]
  ds_read_b128 v[48:51], v17 offset:33024
  s_add_u32 m0, s65, 2048
  v_mfma_f32_16x16x32_bf16 v[28:31], v[56:59], a[8:11], v[28:31]
  buffer_load_dwordx4 v9, s[12:15], s63 offen lds
  v_mfma_f32_16x16x32_bf16 v[32:35], v[56:59], a[136:139], v[32:35]
  s_waitcnt lgkmcnt(4)
  v_mfma_f32_16x16x32_bf16 v[20:23], v[60:63], a[12:15], v[20:23]
  ds_read_b128 v[52:55], v18 offset:256
  v_mfma_f32_16x16x32_bf16 v[24:27], v[60:63], a[140:143], v[24:27]
  ds_read_b128 v[56:59], v18 offset:33024
  v_mfma_f32_16x16x32_bf16 v[28:31], v[64:67], a[12:15], v[28:31]
  buffer_load_dwordx4 v9, s[12:15], s63 offen offset:1024 lds
  v_mfma_f32_16x16x32_bf16 v[32:35], v[64:67], a[140:143], v[32:35]
  s_waitcnt lgkmcnt(4)
  v_mfma_f32_16x16x32_bf16 v[20:23], v[36:39], a[16:19], v[20:23]
  ds_read_b128 v[60:63], v19 offset:256
  v_mfma_f32_16x16x32_bf16 v[24:27], v[36:39], a[144:147], v[24:27]
  ds_read_b128 v[64:67], v19 offset:33024
  s_add_u32 m0, s65, 4096
  v_mfma_f32_16x16x32_bf16 v[28:31], v[40:43], a[16:19], v[28:31]
  buffer_load_dwordx4 v10, s[12:15], s63 offen lds
  v_mfma_f32_16x16x32_bf16 v[32:35], v[40:43], a[144:147], v[32:35]
  s_waitcnt lgkmcnt(4)
  v_mfma_f32_16x16x32_bf16 v[20:23], v[44:47], a[20:23], v[20:23]
  ds_read_b128 v[36:39], v16 offset:512
  v_mfma_f32_16x16x32_bf16 v[24:27], v[44:47], a[148:151], v[24:27]
  ds_read_b128 v[40:43], v16 offset:33280
  v_mfma_f32_16x16x32_bf16 v[28:31], v[48:51], a[20:23], v[28:31]
  buffer_load_dwordx4 v10, s[12:15], s63 offen offset:1024 lds
  v_mfma_f32_16x16x32_bf16 v[32:35], v[48:51], a[148:151], v[32:35]
  s_waitcnt lgkmcnt(4)
  v_mfma_f32_16x16x32_bf16 v[20:23], v[52:55], a[24:27], v[20:23]
  ds_read_b128 v[44:47], v17 offset:512
  v_mfma_f32_16x16x32_bf16 v[24:27], v[52:55], a[152:155], v[24:27]
  ds_read_b128 v[48:51], v17 offset:33280
  s_add_u32 m0, s65, 6144
  v_mfma_f32_16x16x32_bf16 v[28:31], v[56:59], a[24:27], v[28:31]
  buffer_load_dwordx4 v11, s[12:15], s63 offen lds
  v_mfma_f32_16x16x32_bf16 v[32:35], v[56:59], a[152:155], v[32:35]
  s_waitcnt lgkmcnt(4)
  v_mfma_f32_16x16x32_bf16 v[20:23], v[60:63], a[28:31], v[20:23]
  ds_read_b128 v[52:55], v18 offset:512
  v_mfma_f32_16x16x32_bf16 v[24:27], v[60:63], a[156:159], v[24:27]
  ds_read_b128 v[56:59], v18 offset:33280
  v_mfma_f32_16x16x32_bf16 v[28:31], v[64:67], a[28:31], v[28:31]
  buffer_load_dwordx4 v11, s[12:15], s63 offen offset:1024 lds
  v_mfma_f32_16x16x32_bf16 v[32:35], v[64:67], a[156:159], v[32:35]
  s_waitcnt lgkmcnt(4)
  v_mfma_f32_16x16x32_bf16 v[20:23], v[36:39], a[32:35], v[20:23]
  ds_read_b128 v[60:63], v19 offset:512
  v_mfma_f32_16x16x32_bf16 v[24:27], v[36:39], a[160:163], v[24:27]
  ds_read_b128 v[64:67], v19 offset:33280
  s_add_u32 m0, s65, 8192
  v_mfma_f32_16x16x32_bf16 v[28:31], v[40:43], a[32:35], v[28:31]
  buffer_load_dwordx4 v12, s[12:15], s63 offen lds
  v_mfma_f32_16x16x32_bf16 v[32:35], v[40:43], a[160:163], v[32:35]
  s_waitcnt lgkmcnt(4)
  v_mfma_f32_16x16x32_bf16 v[20:23], v[44:47], a[36:39], v[20:23]
  ds_read_b128 v[36:39], v16 offset:768
  v_mfma_f32_16x16x32_bf16 v[24:27], v[44:47], a[164:167], v[24:27]
  ds_read_b128 v[40:43], v16 offset:33536
  v_mfma_f32_16x16x32_bf16 v[28:31], v[48:51], a[36:39], v[28:31]
  buffer_load_dwordx4 v12, s[12:15], s63 offen offset:1024 lds
  v_mfma_f32_16x16x32_bf16 v[32:35], v[48:51], a[164:167], v[32:35]
  s_waitcnt lgkmcnt(4)
  v_mfma_f32_16x16x32_bf16 v[20:23], v[52:55], a[40:43], v[20:23]
  ds_read_b128 v[44:47], v17 offset:768
  v_mfma_f32_16x16x32_bf16 v[24:27], v[52:55], a[168:171], v[24:27]
  ds_read_b128 v[48:51], v17 offset:33536
  s_add_u32 m0, s65, 10240
  v_mfma_f32_16x16x32_bf16 v[28:31], v[56:59], a[40:43], v[28:31]
  buffer_load_dwordx4 v13, s[12:15], s63 offen lds
  v_mfma_f32_16x16x32_bf16 v[32:35], v[56:59], a[168:171], v[32:35]
  s_waitcnt lgkmcnt(4)
  v_mfma_f32_16x16x32_bf16 v[20:23], v[60:63], a[44:47], v[20:23]
  ds_read_b128 v[52:55], v18 offset:768
  v_mfma_f32_16x16x32_bf16 v[24:27], v[60:63], a[172:175], v[24:27]
  ds_read_b128 v[56:59], v18 offset:33536
  v_mfma_f32_16x16x32_bf16 v[28:31], v[64:67], a[44:47], v[28:31]
  buffer_load_dwordx4 v13, s[12:15], s63 offen offset:1024 lds
  v_mfma_f32_16x16x32_bf16 v[32:35], v[64:67], a[172:175], v[32:35]
  s_waitcnt lgkmcnt(4)
  v_mfma_f32_16x16x32_bf16 v[20:23], v[36:39], a[48:51], v[20:23]
  ds_read_b128 v[60:63], v19 offset:768
  v_mfma_f32_16x16x32_bf16 v[24:27], v[36:39], a[176:179], v[24:27]
  ds_read_b128 v[64:67], v19 offset:33536
  s_add_u32 m0, s65, 12288
  v_mfma_f32_16x16x32_bf16 v[28:31], v[40:43], a[48:51], v[28:31]
  buffer_load_dwordx4 v14, s[12:15], s63 offen lds
  v_mfma_f32_16x16x32_bf16 v[32:35], v[40:43], a[176:179], v[32:35]
  s_waitcnt lgkmcnt(4)
  v_mfma_f32_16x16x32_bf16 v[20:23], v[44:47], a[52:55], v[20:23]
  ds_read_b128 v[36:39], v16 offset:1024
  v_mfma_f32_16x16x32_bf16 v[24:27], v[44:47], a[180:183], v[24:27]
  ds_read_b128 v[40:43], v16 offset:33792
  v_mfma_f32_16x16x32_bf16 v[28:31], v[48:51], a[52:55], v[28:31]
  buffer_load_dwordx4 v14, s[12:15], s63 offen offset:1024 lds
  v_mfma_f32_16x16x32_bf16 v[32:35], v[48:51], a[180:183], v[32:35]
  s_waitcnt lgkmcnt(4)
  v_mfma_f32_16x16x32_bf16 v[20:23], v[52:55], a[56:59], v[20:23]
  ds_read_b128 v[44:47], v17 offset:1024
  v_mfma_f32_16x16x32_bf16 v[24:27], v[52:55], a[184:187], v[24:27]
  ds_read_b128 v[48:51], v17 offset:33792
  s_add_u32 m0, s65, 14336
  v_mfma_f32_16x16x32_bf16 v[28:31], v[56:59], a[56:59], v[28:31]
  buffer_load_dwordx4 v15, s[12:15], s63 offen lds
  v_mfma_f32_16x16x32_bf16 v[32:35], v[56:59], a[184:187], v[32:35]
  s_waitcnt lgkmcnt(4)
  v_mfma_f32_16x16x32_bf16 v[20:23], v[60:63], a[60:63], v[20:23]
  ds_read_b128 v[52:55], v18 offset:1024
  v_mfma_f32_16x16x32_bf16 v[24:27], v[60:63], a[188:191], v[24:27]
  ds_read_b128 v[56:59], v18 offset:33792
  v_mfma_f32_16x16x32_bf16 v[28:31], v[64:67], a[60:63], v[28:31]
  buffer_load_dwordx4 v15, s[12:15], s63 offen offset:1024 lds
  v_mfma_f32_16x16x32_bf16 v[32:35], v[64:67], a[188:191], v[32:35]
  s_waitcnt lgkmcnt(4)
  v_mfma_f32_16x16x32_bf16 v[20:23], v[36:39], a[64:67], v[20:23]
  ds_read_b128 v[60:63], v19 offset:1024
  v_mfma_f32_16x16x32_bf16 v[24:27], v[36:39], a[192:195], v[24:27]
  ds_read_b128 v[64:67], v19 offset:33792
  v_mfma_f32_16x16x32_bf16 v[28:31], v[40:43], a[64:67], v[28:31]
  buffer_load_dword v6, v5, s[12:15], s70 offen
  v_mfma_f32_16x16x32_bf16 v[32:35], v[40:43], a[192:195], v[32:35]
  s_waitcnt lgkmcnt(4)
  v_mfma_f32_16x16x32_bf16 v[20:23], v[44:47], a[68:71], v[20:23]
  ds_read_b128 v[36:39], v16 offset:1280
  v_mfma_f32_16x16x32_bf16 v[24:27], v[44:47], a[196:199], v[24:27]
  ds_read_b128 v[40:43], v16 offset:34048
  v_mfma_f32_16x16x32_bf16 v[28:31], v[48:51], a[68:71], v[28:31]
  buffer_store_dwordx4 v[68:71], v7, s[4:7], s71 offen sc1
  s_add_u32 s71, s71, 1024
  v_mfma_f32_16x16x32_bf16 v[32:35], v[48:51], a[196:199], v[32:35]
  s_waitcnt lgkmcnt(4)
  v_mfma_f32_16x16x32_bf16 v[20:23], v[52:55], a[72:75], v[20:23]
  ds_read_b128 v[44:47], v17 offset:1280
  v_mfma_f32_16x16x32_bf16 v[24:27], v[52:55], a[200:203], v[24:27]
  ds_read_b128 v[48:51], v17 offset:34048
  v_mfma_f32_16x16x32_bf16 v[28:31], v[56:59], a[72:75], v[28:31]
  buffer_store_dwordx4 v[72:75], v7, s[4:7], s71 offen sc1
  v_mfma_f32_16x16x32_bf16 v[32:35], v[56:59], a[200:203], v[32:35]
  s_waitcnt lgkmcnt(4)
  v_mfma_f32_16x16x32_bf16 v[20:23], v[60:63], a[76:79], v[20:23]
  ds_read_b128 v[52:55], v18 offset:1280
  v_mfma_f32_16x16x32_bf16 v[24:27], v[60:63], a[204:207], v[24:27]
  ds_read_b128 v[56:59], v18 offset:34048
  v_mfma_f32_16x16x32_bf16 v[28:31], v[64:67], a[76:79], v[28:31]
  v_mfma_f32_16x16x32_bf16 v[32:35], v[64:67], a[204:207], v[32:35]
  s_waitcnt lgkmcnt(4)
  v_mfma_f32_16x16x32_bf16 v[20:23], v[36:39], a[80:83], v[20:23]
  ds_read_b128 v[60:63], v19 offset:1280
  v_mfma_f32_16x16x32_bf16 v[24:27], v[36:39], a[208:211], v[24:27]
  ds_read_b128 v[64:67], v19 offset:34048
  v_mfma_f32_16x16x32_bf16 v[28:31], v[40:43], a[80:83], v[28:31]
  v_mfma_f32_16x16x32_bf16 v[32:35], v[40:43], a[208:211], v[32:35]
  s_waitcnt lgkmcnt(4)
  v_mfma_f32_16x16x32_bf16 v[20:23], v[44:47], a[84:87], v[20:23]
  ds_read_b128 v[36:39], v16 offset:1536
  v_mfma_f32_16x16x32_bf16 v[24:27], v[44:47], a[212:215], v[24:27]
  ds_read_b128 v[40:43], v16 offset:34304
  v_mfma_f32_16x16x32_bf16 v[28:31], v[48:51], a[84:87], v[28:31]
  v_mfma_f32_16x16x32_bf16 v[32:35], v[48:51], a[212:215], v[32:35]
  s_waitcnt lgkmcnt(4)
  v_mfma_f32_16x16x32_bf16 v[20:23], v[52:55], a[88:91], v[20:23]
  ds_read_b128 v[44:47], v17 offset:1536
  v_mfma_f32_16x16x32_bf16 v[24:27], v[52:55], a[216:219], v[24:27]
  ds_read_b128 v[48:51], v17 offset:34304
  v_mfma_f32_16x16x32_bf16 v[28:31], v[56:59], a[88:91], v[28:31]
  v_mfma_f32_16x16x32_bf16 v[32:35], v[56:59], a[216:219], v[32:35]
  s_waitcnt lgkmcnt(4)
  v_mfma_f32_16x16x32_bf16 v[20:23], v[60:63], a[92:95], v[20:23]
  ds_read_b128 v[52:55], v18 offset:1536
  v_mfma_f32_16x16x32_bf16 v[24:27], v[60:63], a[220:223], v[24:27]
  ds_read_b128 v[56:59], v18 offset:34304
  v_mfma_f32_16x16x32_bf16 v[28:31], v[64:67], a[92:95], v[28:31]
  v_mfma_f32_16x16x32_bf16 v[32:35], v[64:67], a[220:223], v[32:35]
  s_waitcnt lgkmcnt(4)
  v_mfma_f32_16x16x32_bf16 v[20:23], v[36:39], a[96:99], v[20:23]
  ds_read_b128 v[60:63], v19 offset:1536
  v_mfma_f32_16x16x32_bf16 v[24:27], v[36:39], a[224:227], v[24:27]
  ds_read_b128 v[64:67], v19 offset:34304
  v_mfma_f32_16x16x32_bf16 v[28:31], v[40:43], a[96:99], v[28:31]
  v_mfma_f32_16x16x32_bf16 v[32:35], v[40:43], a[224:227], v[32:35]
  s_waitcnt lgkmcnt(4)
  v_mfma_f32_16x16x32_bf16 v[20:23], v[44:47], a[100:103], v[20:23]
  ds_read_b128 v[36:39], v16 offset:1792
  v_mfma_f32_16x16x32_bf16 v[24:27], v[44:47], a[228:231], v[24:27]
  ds_read_b128 v[40:43], v16 offset:34560
  v_mfma_f32_16x16x32_bf16 v[28:31], v[48:51], a[100:103], v[28:31]
  v_mfma_f32_16x16x32_bf16 v[32:35], v[48:51], a[228:231], v[32:35]
  s_waitcnt lgkmcnt(4)
  v_mfma_f32_16x16x32_bf16 v[20:23], v[52:55], a[104:107], v[20:23]
  ds_read_b128 v[44:47], v17 offset:1792
  v_mfma_f32_16x16x32_bf16 v[24:27], v[52:55], a[232:235], v[24:27]
  ds_read_b128 v[48:51], v17 offset:34560
  v_mfma_f32_16x16x32_bf16 v[28:31], v[56:59], a[104:107], v[28:31]
  v_mfma_f32_16x16x32_bf16 v[32:35], v[56:59], a[232:235], v[32:35]
  s_waitcnt lgkmcnt(4)
  v_mfma_f32_16x16x32_bf16 v[20:23], v[60:63], a[108:111], v[20:23]
  ds_read_b128 v[52:55], v18 offset:1792
  v_mfma_f32_16x16x32_bf16 v[24:27], v[60:63], a[236:239], v[24:27]
  ds_read_b128 v[56:59], v18 offset:34560
  v_mfma_f32_16x16x32_bf16 v[28:31], v[64:67], a[108:111], v[28:31]
  v_mfma_f32_16x16x32_bf16 v[32:35], v[64:67], a[236:239], v[32:35]
  s_waitcnt lgkmcnt(4)
  v_mfma_f32_16x16x32_bf16 v[20:23], v[36:39], a[112:115], v[20:23]
  ds_read_b128 v[60:63], v19 offset:1792
  v_mfma_f32_16x16x32_bf16 v[24:27], v[36:39], a[240:243], v[24:27]
  ds_read_b128 v[64:67], v19 offset:34560
  v_mfma_f32_16x16x32_bf16 v[28:31], v[40:43], a[112:115], v[28:31]
  v_mfma_f32_16x16x32_bf16 v[32:35], v[40:43], a[240:243], v[32:35]
  s_waitcnt lgkmcnt(4)
  v_mfma_f32_16x16x32_bf16 v[20:23], v[44:47], a[116:119], v[20:23]
  v_xor_b32 v16, 0x10000, v16
  v_mfma_f32_16x16x32_bf16 v[24:27], v[44:47], a[244:247], v[24:27]
  v_mfma_f32_16x16x32_bf16 v[28:31], v[48:51], a[116:119], v[28:31]
  v_mfma_f32_16x16x32_bf16 v[32:35], v[48:51], a[244:247], v[32:35]
  s_waitcnt lgkmcnt(2)
  v_mfma_f32_16x16x32_bf16 v[20:23], v[52:55], a[120:123], v[20:23]
  v_xor_b32 v17, 0x10000, v17
  v_mfma_f32_16x16x32_bf16 v[24:27], v[52:55], a[248:251], v[24:27]
  v_mfma_f32_16x16x32_bf16 v[28:31], v[56:59], a[120:123], v[28:31]
  s_waitcnt vmcnt(0)
  s_barrier
  s_mov_b32 s64, s61
  s_cmp_lg_u32 s50, 0
  s_cbranch_scc1 Lsg_194
  v_mov_b32 v126, s64
  s_lshl_b32 s59, s2, 7
  s_mov_b64 exec, 1
  buffer_store_dword v126, off, s[4:7], s59 sc1
  s_mov_b64 exec, -1
Lsg_194:
  v_mfma_f32_16x16x32_bf16 v[32:35], v[56:59], a[248:251], v[32:35]
  s_waitcnt lgkmcnt(0)
  v_mfma_f32_16x16x32_bf16 v[20:23], v[60:63], a[124:127], v[20:23]
  v_xor_b32 v18, 0x10000, v18
  v_mfma_f32_16x16x32_bf16 v[24:27], v[60:63], a[252:255], v[24:27]
  v_xor_b32 v19, 0x10000, v19
  v_mfma_f32_16x16x32_bf16 v[28:31], v[64:67], a[124:127], v[28:31]
  v_mfma_f32_16x16x32_bf16 v[32:35], v[64:67], a[252:255], v[32:35]
  s_lshl_b32 s71, s61, 13
  s_add_u32 s71, s71, s67
  s_lshl_b32 s56, s50, 11
  s_add_u32 s71, s71, s56
  s_add_u32 s71, s71, 0x1080000
  v_mov_b32 v7, v1
  v_cvt_pk_bf16_f32 v68, v20, v21
  v_cvt_pk_bf16_f32 v69, v22, v23
  v_cvt_pk_bf16_f32 v70, v28, v29
  v_cvt_pk_bf16_f32 v71, v30, v31
  v_cvt_pk_bf16_f32 v72, v24, v25
  v_cvt_pk_bf16_f32 v73, v26, v27
  v_cvt_pk_bf16_f32 v74, v32, v33
  v_cvt_pk_bf16_f32 v75, v34, v35
  s_cmp_ge_u32 s61, 3
  s_cbranch_scc1 Lkp_195
  buffer_store_dwordx4 v[68:71], v7, s[4:7], s71 offen sc1
  s_add_u32 s71, s71, 1024
  buffer_store_dwordx4 v[72:75], v7, s[4:7], s71 offen sc1
  v_mov_b32 v7, 0x80000000
  s_add_u32 s64, s61, 1
  s_waitcnt vmcnt(0)
  s_barrier
  s_cmp_lg_u32 s50, 0
  s_cbranch_scc1 Lsg_196
  v_mov_b32 v126, s64
  s_lshl_b32 s59, s2, 7
  s_mov_b64 exec, 1
  buffer_store_dword v126, off, s[4:7], s59 sc1
  s_mov_b64 exec, -1
Lsg_196:
Lkp_195:
  s_add_u32 s61, s61, 1
  s_cmp_lt_u32 s61, s62
  s_cbranch_scc1 L_pv_loop
  buffer_store_dwordx4 v[68:71], v7, s[4:7], s71 offen sc1
  s_add_u32 s71, s71, 1024
  buffer_store_dwordx4 v[72:75], v7, s[4:7], s71 offen sc1
  s_waitcnt vmcnt(0)
  s_barrier
  s_cmp_lg_u32 s50, 0
  s_cbranch_scc1 Lsg_197
  v_mov_b32 v126, 64
  s_lshl_b32 s59, s2, 7
  s_mov_b64 exec, 1
  buffer_store_dword v126, off, s[4:7], s59 sc1
  s_mov_b64 exec, -1
Lsg_197:
  s_branch L_g3_help
L_qa:
  v_lshlrev_b32 v1, 4, v0
  s_mul_i32 s67, s52, 0x202000
  s_cmp_eq_u32 s50, 0
  s_cselect_b32 s8, s34, s8
  s_cselect_b32 s9, s35, s9
  s_cmp_eq_u32 s50, 1
  s_cselect_b32 s8, s28, s8
  s_cselect_b32 s9, s29, s9
  s_cmp_eq_u32 s50, 2
  s_cselect_b32 s8, s30, s8
  s_cselect_b32 s9, s31, s9
  s_cmp_eq_u32 s50, 3
  s_cselect_b32 s8, s32, s8
  s_cselect_b32 s9, s33, s9
  s_sub_u32 s56, s51, 2
  s_lshl_b32 s56, s56, 5
  s_add_u32 s56, s56, s52
  s_lshl_b32 s56, s56, 16
  v_lshlrev_b32 v127, 10, v0
  buffer_load_dword v6, v127, s[8:11], s56 offen offset:384
  s_sub_u32 s56, s51, 2
  s_lshl_b32 s56, s56, 5
  s_add_u32 s56, s56, s52
  s_lshl_b32 s56, s56, 2
  s_add_u32 s56, s56, s50
  s_lshl_b32 s56, s56, 10
  v_lshl_add_u32 v68, v0, 4, s56
  v_mov_b32 v69, 0x80000000
  v_mov_b32 v72, 0
  v_mov_b32 v73, 0
  v_mov_b32 v74, 0
  v_mov_b32 v75, 0
  v_cmp_gt_u32 vcc, 0x9000, v68
  s_mov_b32 s56, 0x0
  s_nop 0
  v_cndmask_b32 v70, v69, v68, vcc
  buffer_store_dwordx4 v[72:75], v70, s[4:7], s56 offen sc1
  s_nop 1
  v_mov_b32 v72, -1
  v_mov_b32 v73, -1
  v_mov_b32 v74, -1
  v_mov_b32 v75, -1
  v_cmp_gt_u32 vcc, 0x90000, v68
  s_mov_b32 s56, 0x90000
  s_nop 0
  v_cndmask_b32 v70, v69, v68, vcc
  buffer_store_dwordx4 v[72:75], v70, s[4:7], s56 offen sc1
  v_cmp_gt_u32 vcc, 0x10000, v68
  s_mov_b32 s56, 0x110000
  s_nop 0
  v_cndmask_b32 v70, v69, v68, vcc
  buffer_store_dwordx4 v[72:75], v70, s[4:7], s56 offen sc1
  s_nop 1
  v_mov_b32 v72, -1
  v_mov_b32 v73, -1
  v_mov_b32 v74, -1
  v_mov_b32 v75, -1
  v_cmp_gt_u32 vcc, 0xa0000, v68
  s_mov_b32 s56, 0x200000
  s_nop 0
  v_cndmask_b32 v70, v69, v68, vcc
  buffer_store_dwordx4 v[72:75], v70, s[4:7], s56 offen sc1
  v_cmp_gt_u32 vcc, 0x20000, v68
  s_mov_b32 s56, 0x280000
  s_nop 0
  v_cndmask_b32 v70, v69, v68, vcc
  buffer_store_dwordx4 v[72:75], v70, s[4:7], s56 offen sc1
  s_waitcnt vmcnt(0)
  s_barrier
  s_cmp_lg_u32 s50, 0
  s_cbranch_scc1 Lar_198
  s_cmp_eq_u32 s100, 0
  s_cselect_b32 s56, 0, 128
  v_mov_b32 v68, 1
  s_mov_b64 exec, 1
  buffer_atomic_add v68, off, s[20:23], s56 sc1
  s_mov_b64 exec, -1
Lar_198:
  s_branch Lwa_202
Lwa_199:
  v_lshlrev_b32 v69, 2, v0
  buffer_load_dword v68, v69, s[20:23], 0 offen sc1
  s_waitcnt vmcnt(0)
Lwa_203:
  s_cmp_eq_u32 s100, 0
  s_cbranch_scc1 Lwa_201
  s_mov_b32 s56, 0
  v_readlane_b32 s57, v68, 8
  s_add_u32 s56, s56, s57
  v_readlane_b32 s57, v68, 9
  s_add_u32 s56, s56, s57
  v_readlane_b32 s57, v68, 10
  s_add_u32 s56, s56, s57
  v_readlane_b32 s57, v68, 11
  s_add_u32 s56, s56, s57
  v_readlane_b32 s57, v68, 12
  s_add_u32 s56, s56, s57
  v_readlane_b32 s57, v68, 13
  s_add_u32 s56, s56, s57
  v_readlane_b32 s57, v68, 14
  s_add_u32 s56, s56, s57
  v_readlane_b32 s57, v68, 15
  s_add_u32 s56, s56, s57
  v_readlane_b32 s57, v68, 16
  s_add_u32 s56, s56, s57
  v_readlane_b32 s57, v68, 40
  s_add_u32 s56, s56, s57
  v_readlane_b32 s57, v68, 41
  s_add_u32 s56, s56, s57
  v_readlane_b32 s57, v68, 42
  s_add_u32 s56, s56, s57
  v_readlane_b32 s57, v68, 43
  s_add_u32 s56, s56, s57
  v_readlane_b32 s57, v68, 44
  s_add_u32 s56, s56, s57
  v_readlane_b32 s57, v68, 45
  s_add_u32 s56, s56, s57
  v_readlane_b32 s57, v68, 46
  s_add_u32 s56, s56, s57
  v_readlane_b32 s57, v68, 47
  s_add_u32 s56, s56, s57
  v_readlane_b32 s57, v68, 48
  s_add_u32 s56, s56, s57
  s_cmp_lt_u32 s56, 256
  s_cbranch_scc1 Lwa_202
  s_lshr_b32 s58, s100, 2
  v_readlane_b32 s56, v68, s58
  s_add_u32 s58, s58, 32
  v_readlane_b32 s57, v68, s58
  s_add_u32 s56, s56, s57
  s_cmp_eq_u32 s58, 48
  s_cselect_b32 s56, 0, s56
  s_cmp_lt_u32 s56, 256
  s_cbranch_scc1 L_restart
  v_readlane_b32 s56, v68, 32
  s_cmp_ge_u32 s56, 128
  s_cbranch_scc1 Lwa_200
  s_branch Lwa_202
Lwa_201:
  v_readlane_b32 s56, v68, 0
  s_cmp_ge_u32 s56, 256
  s_cbranch_scc1 Lwa_200
Lwa_202:
  s_sleep 127
  s_add_u32 s55, s55, 1
  s_bitcmp1_b32 s55, 21
  s_cbranch_scc1 L_abort
  s_branch Lwa_199
Lwa_200:
  s_lshl_b32 s56, s52, 10
  s_add_u32 s56, s56, 768
  v_mov_b32 v127, s56
Lwf_205:
  buffer_load_dword v126, v127, s[4:7], 0 offen sc1
  s_waitcnt vmcnt(0)
  v_cmp_gt_u32 vcc, 1, v126
  s_cbranch_vccz Lwf_206
  s_sleep 8
  s_add_u32 s55, s55, 1
  s_bitcmp1_b32 s55, 21
  s_cbranch_scc1 L_abort
  s_branch Lwf_205
Lwf_206:
  s_mov_b32 s8, s28
  s_mov_b32 s9, s29
  s_mov_b32 s10, 0x800000
  s_mov_b32 s11, 0x20000
  v_lshrrev_b32 v126, 3, v0
  v_lshlrev_b32 v2, 13, v126
  v_and_b32 v126, 2, v126
  v_xor_b32 v126, v126, v0
  v_and_b32 v126, 7, v126
  v_lshlrev_b32 v126, 4, v126
  v_xor_b32 v3, 64, v126
  v_add_u32 v3, v3, v2
  v_add_u32 v2, v126, v2
  v_lshrrev_b32 v126, 4, v0
  v_lshlrev_b32 v126, 3, v126
  v_bfe_u32 v127, v0, 2, 2
  v_add_u32 v126, v126, v127
  v_lshrrev_b32 v127, 5, v0
  v_lshlrev_b32 v127, 1, v127
  v_bfe_u32 v4, v0, 3, 1
  v_or_b32 v127, v127, v4
  v_lshlrev_b32 v126, 7, v126
  v_xor_b32 v127, s50, v127
  v_and_b32 v4, 3, v0
  v_lshl_add_u32 v126, v4, 3, v126
  v_lshl_add_u32 v126, v127, 5, v126
  v_xor_b32 v68, 0, v126
  v_add_u32 v72, 0x10000, v68
  v_xor_b32 v69, 32, v126
  v_add_u32 v73, 0x10000, v69
  v_xor_b32 v70, 64, v126
  v_add_u32 v74, 0x10000, v70
  v_xor_b32 v71, 96, v126
  v_add_u32 v75, 0x10000, v71
  s_lshl_b32 s60, s52, 8
  s_mul_i32 s56, s50, 2097152
  s_add_u32 s60, s60, s56
  s_lshl_b32 s56, s50, 15
  s_add_u32 s56, s56, 0
  s_sub_u32 s57, s60, 65536
  s_mov_b32 s58, 4
Ldma_207:
  s_mov_b32 m0, s56
  s_add_u32 s57, s57, 65536
  buffer_load_dwordx4 v2, s[8:11], s57 offen nt lds
  s_add_u32 s56, s56, 1024
  s_mov_b32 m0, s56
  s_add_u32 s57, s57, 65536
  buffer_load_dwordx4 v2, s[8:11], s57 offen nt lds
  s_add_u32 s56, s56, 1024
  s_mov_b32 m0, s56
  s_add_u32 s57, s57, 65536
  buffer_load_dwordx4 v3, s[8:11], s57 offen nt lds
  s_add_u32 s56, s56, 1024
  s_mov_b32 m0, s56
  s_add_u32 s57, s57, 65536
  buffer_load_dwordx4 v3, s[8:11], s57 offen nt lds
  s_add_u32 s56, s56, 1024
  s_sub_u32 s58, s58, 1
  s_cmp_lg_u32 s58, 0
  s_cbranch_scc1 Ldma_207
  s_lshl_b32 s60, s52, 8
  s_mul_i32 s56, s50, 2097152
  s_add_u32 s60, s60, s56
  s_add_u32 s60, s60, 1048576
  s_lshl_b32 s56, s50, 15
  s_add_u32 s56, s56, 16384
  s_sub_u32 s57, s60, 65536
  s_mov_b32 s58, 4
Ldma_208:
  s_mov_b32 m0, s56
  s_add_u32 s57, s57, 65536
  buffer_load_dwordx4 v2, s[8:11], s57 offen nt lds
  s_add_u32 s56, s56, 1024
  s_mov_b32 m0, s56
  s_add_u32 s57, s57, 65536
  buffer_load_dwordx4 v2, s[8:11], s57 offen nt lds
  s_add_u32 s56, s56, 1024
  s_mov_b32 m0, s56
  s_add_u32 s57, s57, 65536
  buffer_load_dwordx4 v3, s[8:11], s57 offen nt lds
  s_add_u32 s56, s56, 1024
  s_mov_b32 m0, s56
  s_add_u32 s57, s57, 65536
  buffer_load_dwordx4 v3, s[8:11], s57 offen nt lds
  s_add_u32 s56, s56, 1024
  s_sub_u32 s58, s58, 1
  s_cmp_lg_u32 s58, 0
  s_cbranch_scc1 Ldma_208
  s_waitcnt vmcnt(16)
  s_barrier
  ds_read_b64_tr_b16 a[0:1], v68 offset:0
  ds_read_b64_tr_b16 a[2:3], v68 offset:512
  ds_read_b64_tr_b16 a[4:5], v68 offset:4096
  ds_read_b64_tr_b16 a[6:7], v68 offset:4608
  ds_read_b64_tr_b16 a[8:9], v68 offset:8192
  ds_read_b64_tr_b16 a[10:11], v68 offset:8704
  ds_read_b64_tr_b16 a[12:13], v68 offset:12288
  ds_read_b64_tr_b16 a[14:15], v68 offset:12800
  ds_read_b64_tr_b16 a[32:33], v68 offset:32768
  ds_read_b64_tr_b16 a[34:35], v68 offset:33280
  ds_read_b64_tr_b16 a[36:37], v68 offset:36864
  ds_read_b64_tr_b16 a[38:39], v68 offset:37376
  ds_read_b64_tr_b16 a[40:41], v68 offset:40960
  ds_read_b64_tr_b16 a[42:43], v68 offset:41472
  ds_read_b64_tr_b16 a[44:45], v68 offset:45056
  ds_read_b64_tr_b16 a[46:47], v68 offset:45568
  ds_read_b64_tr_b16 a[64:65], v72 offset:0
  ds_read_b64_tr_b16 a[66:67], v72 offset:512
  ds_read_b64_tr_b16 a[68:69], v72 offset:4096
  ds_read_b64_tr_b16 a[70:71], v72 offset:4608
  ds_read_b64_tr_b16 a[72:73], v72 offset:8192
  ds_read_b64_tr_b16 a[74:75], v72 offset:8704
  ds_read_b64_tr_b16 a[76:77], v72 offset:12288
  ds_read_b64_tr_b16 a[78:79], v72 offset:12800
  ds_read_b64_tr_b16 a[96:97], v72 offset:32768
  ds_read_b64_tr_b16 a[98:99], v72 offset:33280
  ds_read_b64_tr_b16 a[100:101], v72 offset:36864
  ds_read_b64_tr_b16 a[102:103], v72 offset:37376
  ds_read_b64_tr_b16 a[104:105], v72 offset:40960
  ds_read_b64_tr_b16 a[106:107], v72 offset:41472
  ds_read_b64_tr_b16 a[108:109], v72 offset:45056
  ds_read_b64_tr_b16 a[110:111], v72 offset:45568
Lro_209:
  s_waitcnt lgkmcnt(0)
  s_barrier
  s_lshl_b32 s60, s52, 8
  s_add_u32 s60, s60, 128
  s_mul_i32 s56, s50, 2097152
  s_add_u32 s60, s60, s56
  s_lshl_b32 s56, s50, 15
  s_add_u32 s56, s56, 0
  s_sub_u32 s57, s60, 65536
  s_mov_b32 s58, 4
Ldma_210:
  s_mov_b32 m0, s56
  s_add_u32 s57, s57, 65536
  buffer_load_dwordx4 v2, s[8:11], s57 offen nt lds
  s_add_u32 s56, s56, 1024
  s_mov_b32 m0, s56
  s_add_u32 s57, s57, 65536
  buffer_load_dwordx4 v2, s[8:11], s57 offen nt lds
  s_add_u32 s56, s56, 1024
  s_mov_b32 m0, s56
  s_add_u32 s57, s57, 65536
  buffer_load_dwordx4 v3, s[8:11], s57 offen nt lds
  s_add_u32 s56, s56, 1024
  s_mov_b32 m0, s56
  s_add_u32 s57, s57, 65536
  buffer_load_dwordx4 v3, s[8:11], s57 offen nt lds
  s_add_u32 s56, s56, 1024
  s_sub_u32 s58, s58, 1
  s_cmp_lg_u32 s58, 0
  s_cbranch_scc1 Ldma_210
  s_waitcnt vmcnt(16)
  s_barrier
  ds_read_b64_tr_b16 a[16:17], v68 offset:16384
  ds_read_b64_tr_b16 a[18:19], v68 offset:16896
  ds_read_b64_tr_b16 a[20:21], v68 offset:20480
  ds_read_b64_tr_b16 a[22:23], v68 offset:20992
  ds_read_b64_tr_b16 a[24:25], v68 offset:24576
  ds_read_b64_tr_b16 a[26:27], v68 offset:25088
  ds_read_b64_tr_b16 a[28:29], v68 offset:28672
  ds_read_b64_tr_b16 a[30:31], v68 offset:29184
  ds_read_b64_tr_b16 a[48:49], v68 offset:49152
  ds_read_b64_tr_b16 a[50:51], v68 offset:49664
  ds_read_b64_tr_b16 a[52:53], v68 offset:53248
  ds_read_b64_tr_b16 a[54:55], v68 offset:53760
  ds_read_b64_tr_b16 a[56:57], v68 offset:57344
  ds_read_b64_tr_b16 a[58:59], v68 offset:57856
  ds_read_b64_tr_b16 a[60:61], v68 offset:61440
  ds_read_b64_tr_b16 a[62:63], v68 offset:61952
  ds_read_b64_tr_b16 a[80:81], v72 offset:16384
  ds_read_b64_tr_b16 a[82:83], v72 offset:16896
  ds_read_b64_tr_b16 a[84:85], v72 offset:20480
  ds_read_b64_tr_b16 a[86:87], v72 offset:20992
  ds_read_b64_tr_b16 a[88:89], v72 offset:24576
  ds_read_b64_tr_b16 a[90:91], v72 offset:25088
  ds_read_b64_tr_b16 a[92:93], v72 offset:28672
  ds_read_b64_tr_b16 a[94:95], v72 offset:29184
  ds_read_b64_tr_b16 a[112:113], v72 offset:49152
  ds_read_b64_tr_b16 a[114:115], v72 offset:49664
  ds_read_b64_tr_b16 a[116:117], v72 offset:53248
  ds_read_b64_tr_b16 a[118:119], v72 offset:53760
  ds_read_b64_tr_b16 a[120:121], v72 offset:57344
  ds_read_b64_tr_b16 a[122:123], v72 offset:57856
  ds_read_b64_tr_b16 a[124:125], v72 offset:61440
  ds_read_b64_tr_b16 a[126:127], v72 offset:61952
Lro_211:
  s_waitcnt lgkmcnt(0)
  s_barrier
  s_lshl_b32 s60, s52, 8
  s_add_u32 s60, s60, 128
  s_mul_i32 s56, s50, 2097152
  s_add_u32 s60, s60, s56
  s_add_u32 s60, s60, 1048576
  s_lshl_b32 s56, s50, 15
  s_add_u32 s56, s56, 16384
  s_sub_u32 s57, s60, 65536
  s_mov_b32 s58, 4
Ldma_212:
  s_mov_b32 m0, s56
  s_add_u32 s57, s57, 65536
  buffer_load_dwordx4 v2, s[8:11], s57 offen nt lds
  s_add_u32 s56, s56, 1024
  s_mov_b32 m0, s56
  s_add_u32 s57, s57, 65536
  buffer_load_dwordx4 v2, s[8:11], s57 offen nt lds
  s_add_u32 s56, s56, 1024
  s_mov_b32 m0, s56
  s_add_u32 s57, s57, 65536
  buffer_load_dwordx4 v3, s[8:11], s57 offen nt lds
  s_add_u32 s56, s56, 1024
  s_mov_b32 m0, s56
  s_add_u32 s57, s57, 65536
  buffer_load_dwordx4 v3, s[8:11], s57 offen nt lds
  s_add_u32 s56, s56, 1024
  s_sub_u32 s58, s58, 1
  s_cmp_lg_u32 s58, 0
  s_cbranch_scc1 Ldma_212
  s_waitcnt vmcnt(16)
  s_barrier
  ds_read_b64_tr_b16 a[128:129], v68 offset:0
  ds_read_b64_tr_b16 a[130:131], v68 offset:512
  ds_read_b64_tr_b16 a[132:133], v68 offset:4096
  ds_read_b64_tr_b16 a[134:135], v68 offset:4608
  ds_read_b64_tr_b16 a[136:137], v68 offset:8192
  ds_read_b64_tr_b16 a[138:139], v68 offset:8704
  ds_read_b64_tr_b16 a[140:141], v68 offset:12288
  ds_read_b64_tr_b16 a[142:143], v68 offset:12800
  ds_read_b64_tr_b16 a[160:161], v68 offset:32768
  ds_read_b64_tr_b16 a[162:163], v68 offset:33280
  ds_read_b64_tr_b16 a[164:165], v68 offset:36864
  ds_read_b64_tr_b16 a[166:167], v68 offset:37376
  ds_read_b64_tr_b16 a[168:169], v68 offset:40960
  ds_read_b64_tr_b16 a[170:171], v68 offset:41472
  ds_read_b64_tr_b16 a[172:173], v68 offset:45056
  ds_read_b64_tr_b16 a[174:175], v68 offset:45568
  ds_read_b64_tr_b16 a[192:193], v72 offset:0
  ds_read_b64_tr_b16 a[194:195], v72 offset:512
  ds_read_b64_tr_b16 a[196:197], v72 offset:4096
  ds_read_b64_tr_b16 a[198:199], v72 offset:4608
  ds_read_b64_tr_b16 a[200:201], v72 offset:8192
  ds_read_b64_tr_b16 a[202:203], v72 offset:8704
  ds_read_b64_tr_b16 a[204:205], v72 offset:12288
  ds_read_b64_tr_b16 a[206:207], v72 offset:12800
  ds_read_b64_tr_b16 a[224:225], v72 offset:32768
  ds_read_b64_tr_b16 a[226:227], v72 offset:33280
  ds_read_b64_tr_b16 a[228:229], v72 offset:36864
  ds_read_b64_tr_b16 a[230:231], v72 offset:37376
  ds_read_b64_tr_b16 a[232:233], v72 offset:40960
  ds_read_b64_tr_b16 a[234:235], v72 offset:41472
  ds_read_b64_tr_b16 a[236:237], v72 offset:45056
  ds_read_b64_tr_b16 a[238:239], v72 offset:45568
Lro_213:
  s_waitcnt lgkmcnt(0)
  s_barrier
  s_waitcnt vmcnt(0)
  s_barrier
  ds_read_b64_tr_b16 a[144:145], v68 offset:16384
  ds_read_b64_tr_b16 a[146:147], v68 offset:16896
  ds_read_b64_tr_b16 a[148:149], v68 offset:20480
  ds_read_b64_tr_b16 a[150:151], v68 offset:20992
  ds_read_b64_tr_b16 a[152:153], v68 offset:24576
  ds_read_b64_tr_b16 a[154:155], v68 offset:25088
  ds_read_b64_tr_b16 a[156:157], v68 offset:28672
  ds_read_b64_tr_b16 a[158:159], v68 offset:29184
  ds_read_b64_tr_b16 a[176:177], v68 offset:49152
  ds_read_b64_tr_b16 a[178:179], v68 offset:49664
  ds_read_b64_tr_b16 a[180:181], v68 offset:53248
  ds_read_b64_tr_b16 a[182:183], v68 offset:53760
  ds_read_b64_tr_b16 a[184:185], v68 offset:57344
  ds_read_b64_tr_b16 a[186:187], v68 offset:57856
  ds_read_b64_tr_b16 a[188:189], v68 offset:61440
  ds_read_b64_tr_b16 a[190:191], v68 offset:61952
  ds_read_b64_tr_b16 a[208:209], v72 offset:16384
  ds_read_b64_tr_b16 a[210:211], v72 offset:16896
  ds_read_b64_tr_b16 a[212:213], v72 offset:20480
  ds_read_b64_tr_b16 a[214:215], v72 offset:20992
  ds_read_b64_tr_b16 a[216:217], v72 offset:24576
  ds_read_b64_tr_b16 a[218:219], v72 offset:25088
  ds_read_b64_tr_b16 a[220:221], v72 offset:28672
  ds_read_b64_tr_b16 a[222:223], v72 offset:29184
  ds_read_b64_tr_b16 a[240:241], v72 offset:49152
  ds_read_b64_tr_b16 a[242:243], v72 offset:49664
  ds_read_b64_tr_b16 a[244:245], v72 offset:53248
  ds_read_b64_tr_b16 a[246:247], v72 offset:53760
  ds_read_b64_tr_b16 a[248:249], v72 offset:57344
  ds_read_b64_tr_b16 a[250:251], v72 offset:57856
  ds_read_b64_tr_b16 a[252:253], v72 offset:61440
  ds_read_b64_tr_b16 a[254:255], v72 offset:61952
Lro_214:
  s_waitcnt lgkmcnt(0)
  s_barrier
  s_mov_b32 s66, 0x3e0293ee
  s_mov_b32 s68, -1
  s_mov_b32 s69, 0
  s_lshl_b32 s56, s50, 10
  s_add_u32 s56, s56, 139264
  v_add_u32 v128, s56, v1
  s_and_b32 s57, s50, 1
  s_lshl_b32 s56, s57, 12
  s_add_u32 s56, s56, 131072
  v_add_u32 v129, s56, v1
  v_add_u32 v130, 147456, v1
  s_lshr_b32 s56, s50, 1
  s_lshl_b32 s56, s56, 10
  v_lshl_add_u32 v134, v0, 3, s56
  s_lshl_b32 s56, s56, 2
  s_add_u32 s56, s56, 155648
  v_add_u32 v131, s56, v1
  v_lshrrev_b32 v126, 5, v0
  v_lshlrev_b32 v126, 8, v126
  v_and_b32 v127, 7, v0
  v_lshl_add_u32 v126, v127, 5, v126
  v_and_b32 v127, 16, v0
  v_add_u32 v133, v126, v127
  s_and_b32 s56, s52, 15
  s_lshl_b32 s56, s56, 3
  s_lshr_b32 s64, s52, 4
  s_add_u32 s56, s56, s64
  s_lshl_b32 s56, s56, 7
  v_mov_b32 v132, s56
  s_lshl_b32 s57, s57, 4
  v_and_b32 v126, 15, v0
  v_add_u32 v126, s57, v126
  v_lshrrev_b32 v127, 4, v0
  v_lshlrev_b32 v127, 2, v127
  v_sub_u32 v126, v126, v127
  v_mov_b32 v127, -1
  s_mov_b32 s37, 0xd028965f
  v_cmp_gt_i32 vcc, 0, v126
  s_nop 1
  v_cndmask_b32 v136, 0, v127, vcc
  v_cmp_gt_i32 vcc, 1, v126
  s_nop 1
  v_cndmask_b32 v137, 0, v127, vcc
  v_cmp_gt_i32 vcc, 2, v126
  s_nop 1
  v_cndmask_b32 v138, 0, v127, vcc
  v_cmp_gt_i32 vcc, 3, v126
  s_nop 1
  v_cndmask_b32 v139, 0, v127, vcc
  v_cmp_gt_i32 vcc, 16, v126
  s_nop 1
  v_cndmask_b32 v140, 0, v127, vcc
  v_cmp_gt_i32 vcc, 17, v126
  s_nop 1
  v_cndmask_b32 v141, 0, v127, vcc
  v_cmp_gt_i32 vcc, 18, v126
  s_nop 1
  v_cndmask_b32 v142, 0, v127, vcc
  v_cmp_gt_i32 vcc, 19, v126
  s_nop 1
  v_cndmask_b32 v143, 0, v127, vcc
  s_mov_b32 s61, 0
  s_mov_b32 s62, 64
  s_and_b32 s73, s50, 1
  s_lshl_b32 s73, s73, 5
  s_add_u32 s73, s73, s52
  s_lshl_b32 s73, s73, 1
  s_lshr_b32 s56, s50, 1
  s_add_u32 s73, s73, s56
  s_lshl_b32 s73, s73, 11
  s_add_u32 s73, s73, 0x5400000
  v_mov_b32 v236, 0x3f803f80
  v_mov_b32 v237, 0x3f803f80
  v_mov_b32 v238, 0x3f803f80
  v_mov_b32 v239, 0x3f803f80
  v_cndmask_b32 v240, 0, v236, s[68:69]
  v_cndmask_b32 v241, 0, v236, s[68:69]
  s_mov_b32 s74, -2
  s_cmp_eq_u32 s50, 3
  s_cselect_b32 s56, 0, 0x80000000
  v_mov_b32 v135, 0x80000000
  v_writelane_b32 v135, s56, 0
  v_mov_b32 v248, 0x80000000
  s_lshl_b32 s71, s2, 7
  s_lshl_b32 s56, s50, 3
  s_add_u32 s56, s56, 0
  s_and_b32 s57, s56, 15
  v_xor_b32 v126, s57, v0
  s_lshl_b32 s56, s56, 11
  v_lshl_add_u32 v8, v126, 4, s56
  s_lshl_b32 s56, s50, 3
  s_add_u32 s56, s56, 1
  s_and_b32 s57, s56, 15
  v_xor_b32 v126, s57, v0
  s_lshl_b32 s56, s56, 11
  v_lshl_add_u32 v9, v126, 4, s56
  s_lshl_b32 s56, s50, 3
  s_add_u32 s56, s56, 2
  s_and_b32 s57, s56, 15
  v_xor_b32 v126, s57, v0
  s_lshl_b32 s56, s56, 11
  v_lshl_add_u32 v10, v126, 4, s56
  s_lshl_b32 s56, s50, 3
  s_add_u32 s56, s56, 3
  s_and_b32 s57, s56, 15
  v_xor_b32 v126, s57, v0
  s_lshl_b32 s56, s56, 11
  v_lshl_add_u32 v11, v126, 4, s56
  s_lshl_b32 s56, s50, 3
  s_add_u32 s56, s56, 4
  s_and_b32 s57, s56, 15
  v_xor_b32 v126, s57, v0
  s_lshl_b32 s56, s56, 11
  v_lshl_add_u32 v12, v126, 4, s56
  s_lshl_b32 s56, s50, 3
  s_add_u32 s56, s56, 5
  s_and_b32 s57, s56, 15
  v_xor_b32 v126, s57, v0
  s_lshl_b32 s56, s56, 11
  v_lshl_add_u32 v13, v126, 4, s56
  s_lshl_b32 s56, s50, 3
  s_add_u32 s56, s56, 6
  s_and_b32 s57, s56, 15
  v_xor_b32 v126, s57, v0
  s_lshl_b32 s56, s56, 11
  v_lshl_add_u32 v14, v126, 4, s56
  s_lshl_b32 s56, s50, 3
  s_add_u32 s56, s56, 7
  s_and_b32 s57, s56, 15
  v_xor_b32 v126, s57, v0
  s_lshl_b32 s56, s56, 11
  v_lshl_add_u32 v15, v126, 4, s56
  v_lshrrev_b32 v126, 4, v0
  v_add_u32 v126, 0, v126
  v_and_b32 v127, 15, v0
  v_xor_b32 v126, v126, v127
  v_lshlrev_b32 v126, 4, v126
  v_lshl_add_u32 v16, v127, 11, v126
  v_lshrrev_b32 v126, 4, v0
  v_add_u32 v126, 4, v126
  v_and_b32 v127, 15, v0
  v_xor_b32 v126, v126, v127
  v_lshlrev_b32 v126, 4, v126
  v_lshl_add_u32 v17, v127, 11, v126
  v_lshrrev_b32 v126, 4, v0
  v_add_u32 v126, 8, v126
  v_and_b32 v127, 15, v0
  v_xor_b32 v126, v126, v127
  v_lshlrev_b32 v126, 4, v126
  v_lshl_add_u32 v18, v127, 11, v126
  v_lshrrev_b32 v126, 4, v0
  v_add_u32 v126, 12, v126
  v_and_b32 v127, 15, v0
  v_xor_b32 v126, v126, v127
  v_lshlrev_b32 v126, 4, v126
  v_lshl_add_u32 v19, v127, 11, v126
  s_mov_b32 s56, s52
  s_lshl_b32 s56, s56, 2
  s_add_u32 s56, s56, s50
  s_mul_i32 s56, s56, 512
  v_lshl_add_u32 v5, v0, 6, s56
  v_cmp_gt_u32 vcc, 8, v0
  v_mov_b32 v7, 0x80000000
  s_nop 0
  v_cndmask_b32 v5, v7, v5, vcc
  s_add_u32 s70, s61, 0
  s_sub_u32 s56, s62, 1
  s_min_u32 s70, s70, s56
  s_lshl_b32 s70, s70, 16
  buffer_load_dword v6, v5, s[12:15], s70 offen
  s_add_u32 s70, s61, 1
  s_sub_u32 s56, s62, 1
  s_min_u32 s70, s70, s56
  s_lshl_b32 s70, s70, 16
  buffer_load_dword v6, v5, s[12:15], s70 offen
  s_add_u32 s70, s61, 2
  s_sub_u32 s56, s62, 1
  s_min_u32 s70, s70, s56
  s_lshl_b32 s70, s70, 16
  buffer_load_dword v6, v5, s[12:15], s70 offen
  s_lshl_b32 s65, s50, 14
  s_add_u32 s63, s61, 0
  s_sub_u32 s56, s62, 1
  s_min_u32 s63, s63, s56
  s_lshl_b32 s63, s63, 16
  s_add_u32 m0, s65, 0
  s_nop 0
  buffer_load_dwordx4 v8, s[12:15], s63 offen lds
  buffer_load_dwordx4 v8, s[12:15], s63 offen offset:1024 lds
  s_add_u32 m0, s65, 2048
  s_nop 0
  buffer_load_dwordx4 v9, s[12:15], s63 offen lds
  buffer_load_dwordx4 v9, s[12:15], s63 offen offset:1024 lds
  s_add_u32 m0, s65, 4096
  s_nop 0
  buffer_load_dwordx4 v10, s[12:15], s63 offen lds
  buffer_load_dwordx4 v10, s[12:15], s63 offen offset:1024 lds
  s_add_u32 m0, s65, 6144
  s_nop 0
  buffer_load_dwordx4 v11, s[12:15], s63 offen lds
  buffer_load_dwordx4 v11, s[12:15], s63 offen offset:1024 lds
  s_add_u32 m0, s65, 8192
  s_nop 0
  buffer_load_dwordx4 v12, s[12:15], s63 offen lds
  buffer_load_dwordx4 v12, s[12:15], s63 offen offset:1024 lds
  s_add_u32 m0, s65, 10240
  s_nop 0
  buffer_load_dwordx4 v13, s[12:15], s63 offen lds
  buffer_load_dwordx4 v13, s[12:15], s63 offen offset:1024 lds
  s_add_u32 m0, s65, 12288
  s_nop 0
  buffer_load_dwordx4 v14, s[12:15], s63 offen lds
  buffer_load_dwordx4 v14, s[12:15], s63 offen offset:1024 lds
  s_add_u32 m0, s65, 14336
  s_nop 0
  buffer_load_dwordx4 v15, s[12:15], s63 offen lds
  buffer_load_dwordx4 v15, s[12:15], s63 offen offset:1024 lds
  s_waitcnt vmcnt(0)
L_qa_loop:
  s_waitcnt vmcnt(2)
  s_barrier
  ds_read_b128 v[36:39], v16 offset:0
  ds_read_b128 v[40:43], v16 offset:32768
  ds_read_b128 v[44:47], v17 offset:0
  ds_read_b128 v[48:51], v17 offset:32768
  ds_read_b128 v[52:55], v18 offset:0
  ds_read_b128 v[56:59], v18 offset:32768
  s_xor_b32 s65, s65, 0x10000
  s_add_u32 s63, s61, 1
  s_sub_u32 s56, s62, 1
  s_min_u32 s63, s63, s56
  s_lshl_b32 s63, s63, 16
  s_add_u32 s70, s61, 3
  s_sub_u32 s56, s62, 1
  s_min_u32 s70, s70, s56
  s_lshl_b32 s70, s70, 16
  s_waitcnt lgkmcnt(4)
  v_mfma_f32_16x16x32_bf16 v[20:23], a[0:3], v[36:39], 0
  ds_read_b128 v[60:63], v19 offset:0
  s_add_u32 s64, s74, 1
  s_max_i32 s64, s64, 0
  s_lshl_b32 s75, s64, 11
  v_mfma_f32_16x16x32_bf16 v[24:27], a[128:131], v[36:39], 0
  ds_read_b128 v[64:67], v19 offset:32768
  s_add_u32 m0, s65, 0
  v_mfma_f32_16x16x32_bf16 v[28:31], a[0:3], v[40:43], 0
  buffer_load_dwordx4 v8, s[12:15], s63 offen lds
  v_mfma_f32_16x16x32_bf16 v[32:35], a[128:131], v[40:43], 0
  s_waitcnt lgkmcnt(4)
  ds_read_b128 v[144:147], v129 offset:0
  ds_read_b128 v[160:163], v130 offset:0
  v_mfma_f32_16x16x32_bf16 v[20:23], a[4:7], v[44:47], v[20:23]
  ds_read_b128 v[36:39], v16 offset:256
  s_add_u32 s75, s75, s67
  s_add_u32 s76, s75, 0x1120000
  s_add_u32 s75, s75, 0x1100000
  v_mfma_f32_16x16x32_bf16 v[24:27], a[132:135], v[44:47], v[24:27]
  ds_read_b128 v[40:43], v16 offset:33024
  v_mfma_f32_16x16x32_bf16 v[28:31], a[4:7], v[48:51], v[28:31]
  buffer_load_dwordx4 v8, s[12:15], s63 offen offset:1024 lds
  v_mfma_f32_16x16x32_bf16 v[32:35], a[132:135], v[48:51], v[32:35]
  s_waitcnt lgkmcnt(6)
  ds_read_b128 v[176:179], v130 offset:4096
  ds_read_b128 v[148:151], v129 offset:1024
  v_mfma_f32_16x16x32_bf16 v[20:23], a[8:11], v[52:55], v[20:23]
  ds_read_b128 v[44:47], v17 offset:256
  s_lshl_b32 s77, s64, 2
  s_add_u32 s77, s77, s50
  s_lshl_b32 s77, s77, 11
  v_mfma_f32_16x16x32_bf16 v[24:27], a[136:139], v[52:55], v[24:27]
  ds_read_b128 v[48:51], v17 offset:33024
  s_add_u32 m0, s65, 2048
  v_mfma_f32_16x16x32_bf16 v[28:31], a[8:11], v[56:59], v[28:31]
  buffer_load_dwordx4 v9, s[12:15], s63 offen lds
  v_mfma_f32_16x16x32_bf16 v[32:35], a[136:139], v[56:59], v[32:35]
  s_waitcnt lgkmcnt(8)
  ds_read_b128 v[164:167], v130 offset:1024
  ds_read_b128 v[180:183], v130 offset:5120
  v_mfma_f32_16x16x32_bf16 v[20:23], a[12:15], v[60:63], v[20:23]
  ds_read_b128 v[52:55], v18 offset:256
  s_add_u32 s77, s77, s67
  s_add_u32 s53, s77, 0x1080000
  s_add_u32 s77, s77, 0x1000000
  v_mfma_f32_16x16x32_bf16 v[24:27], a[140:143], v[60:63], v[24:27]
  ds_read_b128 v[56:59], v18 offset:33024
  v_mfma_f32_16x16x32_bf16 v[28:31], a[12:15], v[64:67], v[28:31]
  buffer_load_dwordx4 v9, s[12:15], s63 offen offset:1024 lds
  v_mfma_f32_16x16x32_bf16 v[32:35], a[140:143], v[64:67], v[32:35]
  s_waitcnt lgkmcnt(8)
  ds_read_b128 v[152:155], v129 offset:2048
  ds_read_b128 v[168:171], v130 offset:2048
  v_mfma_f32_16x16x32_bf16 v[20:23], a[16:19], v[36:39], v[20:23]
  ds_read_b128 v[60:63], v19 offset:256
  s_max_i32 s3, s74, 0
  s_lshl_b32 s3, s3, 18
  s_add_u32 s3, s3, s73
  v_mfma_f32_16x16x32_bf16 v[24:27], a[144:147], v[36:39], v[24:27]
  ds_read_b128 v[64:67], v19 offset:33024
  s_add_u32 m0, s65, 4096
  v_mfma_f32_16x16x32_bf16 v[28:31], a[16:19], v[40:43], v[28:31]
  buffer_load_dwordx4 v10, s[12:15], s63 offen lds
  v_mfma_f32_16x16x32_bf16 v[32:35], a[144:147], v[40:43], v[32:35]
  s_waitcnt lgkmcnt(8)
  ds_read_b128 v[184:187], v130 offset:6144
  ds_read_b128 v[156:159], v129 offset:3072
  v_mfma_f32_16x16x32_bf16 v[20:23], a[20:23], v[44:47], v[20:23]
  ds_read_b128 v[36:39], v16 offset:512
  v_mfma_f32_16x16x32_bf16 v[24:27], a[148:151], v[44:47], v[24:27]
  ds_read_b128 v[40:43], v16 offset:33280
  v_mfma_f32_16x16x32_bf16 v[28:31], a[20:23], v[48:51], v[28:31]
  buffer_load_dwordx4 v10, s[12:15], s63 offen offset:1024 lds
  v_mfma_f32_16x16x32_bf16 v[32:35], a[148:151], v[48:51], v[32:35]
  s_waitcnt lgkmcnt(8)
  ds_read_b128 v[172:175], v130 offset:3072
  ds_read_b128 v[188:191], v130 offset:7168
  v_mfma_f32_16x16x32_bf16 v[20:23], a[24:27], v[52:55], v[20:23]
  ds_read_b128 v[44:47], v17 offset:512
  v_mfma_f32_16x16x32_bf16 v[24:27], a[152:155], v[52:55], v[24:27]
  ds_read_b128 v[48:51], v17 offset:33280
  s_add_u32 m0, s65, 6144
  v_mfma_f32_16x16x32_bf16 v[28:31], a[24:27], v[56:59], v[28:31]
  buffer_load_dwordx4 v11, s[12:15], s63 offen lds
  v_mfma_f32_16x16x32_bf16 v[32:35], a[152:155], v[56:59], v[32:35]
  s_waitcnt lgkmcnt(8)
  ds_read_b128 v[192:195], v131 offset:0
  ds_read_b128 v[196:199], v131 offset:1024
  v_mfma_f32_16x16x32_bf16 v[20:23], a[28:31], v[60:63], v[20:23]
  ds_read_b128 v[52:55], v18 offset:512
  v_mfma_f32_16x16x32_bf16 v[24:27], a[156:159], v[60:63], v[24:27]
  ds_read_b128 v[56:59], v18 offset:33280
  v_mfma_f32_16x16x32_bf16 v[28:31], a[28:31], v[64:67], v[28:31]
  buffer_load_dwordx4 v11, s[12:15], s63 offen offset:1024 lds
  buffer_load_dword v127, v132, s[4:7], 0 offen sc1
  v_mfma_f32_16x16x32_bf16 v[32:35], a[156:159], v[64:67], v[32:35]
  s_waitcnt lgkmcnt(8)
  ds_read_b128 v[200:203], v131 offset:2048
  ds_read_b128 v[204:207], v131 offset:3072
  v_mfma_f32_16x16x32_bf16 v[20:23], a[32:35], v[36:39], v[20:23]
  ds_read_b128 v[60:63], v19 offset:512
  v_mfma_f32_16x16x32_bf16 v[24:27], a[160:163], v[36:39], v[24:27]
  ds_read_b128 v[64:67], v19 offset:33280
  s_add_u32 m0, s65, 8192
  v_mfma_f32_16x16x32_bf16 v[28:31], a[32:35], v[40:43], v[28:31]
  buffer_load_dwordx4 v12, s[12:15], s63 offen lds
  v_mfma_f32_16x16x32_bf16 v[32:35], a[160:163], v[40:43], v[32:35]
  s_waitcnt lgkmcnt(8)
  v_mfma_f32_16x16x32_bf16 v[20:23], a[36:39], v[44:47], v[20:23]
  ds_read_b128 v[36:39], v16 offset:768
  v_mfma_f32_16x16x32_bf16 v[68:71], v[160:163], v[144:147], 0
  v_mfma_f32_16x16x32_bf16 v[72:75], v[176:179], v[144:147], 0
  v_mfma_f32_16x16x32_bf16 v[68:71], v[164:167], v[148:151], v[68:71]
  v_mfma_f32_16x16x32_bf16 v[72:75], v[180:183], v[148:151], v[72:75]
  v_mfma_f32_16x16x32_bf16 v[68:71], v[168:171], v[152:155], v[68:71]
  v_mfma_f32_16x16x32_bf16 v[72:75], v[184:187], v[152:155], v[72:75]
  v_mfma_f32_16x16x32_bf16 v[68:71], v[172:175], v[156:159], v[68:71]
  v_mfma_f32_16x16x32_bf16 v[72:75], v[188:191], v[156:159], v[72:75]
  v_mfma_f32_16x16x32_bf16 v[76:79], v[208:211], v[144:147], 0
  v_cndmask_b32 v228, 0, v224, s[68:69]
  v_cndmask_b32 v230, v224, 0, s[68:69]
  v_mfma_f32_16x16x32_bf16 v[76:79], v[212:215], v[148:151], v[76:79]
  v_cndmask_b32 v229, 0, v225, s[68:69]
  v_cndmask_b32 v231, v225, 0, s[68:69]
  v_mfma_f32_16x16x32_bf16 v[76:79], v[216:219], v[152:155], v[76:79]
  v_cndmask_b32 v232, 0, v226, s[68:69]
  v_cndmask_b32 v234, v226, 0, s[68:69]
  v_mfma_f32_16x16x32_bf16 v[76:79], v[220:223], v[156:159], v[76:79]
  v_bfi_b32 v68, v136, s37, v68
  v_bfi_b32 v69, v137, s37, v69
  v_mfma_f32_16x16x32_bf16 v[24:27], a[164:167], v[44:47], v[24:27]
  ds_read_b128 v[40:43], v16 offset:33536
  v_bfi_b32 v70, v138, s37, v70
  v_mfma_f32_16x16x32_bf16 v[28:31], a[36:39], v[48:51], v[28:31]
  buffer_load_dwordx4 v12, s[12:15], s63 offen offset:1024 lds
  v_bfi_b32 v71, v139, s37, v71
  v_mfma_f32_16x16x32_bf16 v[32:35], a[164:167], v[48:51], v[32:35]
  s_waitcnt lgkmcnt(6)
  v_bfi_b32 v72, v140, s37, v72
  v_bfi_b32 v73, v141, s37, v73
  v_mfma_f32_16x16x32_bf16 v[20:23], a[40:43], v[52:55], v[20:23]
  ds_read_b128 v[44:47], v17 offset:768
  v_bfi_b32 v74, v142, s37, v74
  v_mfma_f32_16x16x32_bf16 v[24:27], a[168:171], v[52:55], v[24:27]
  ds_read_b128 v[48:51], v17 offset:33536
  s_add_u32 m0, s65, 10240
  v_mfma_f32_16x16x32_bf16 v[28:31], a[40:43], v[56:59], v[28:31]
  buffer_load_dwordx4 v13, s[12:15], s63 offen lds
  v_bfi_b32 v75, v143, s37, v75
  v_mfma_f32_16x16x32_bf16 v[32:35], a[168:171], v[56:59], v[32:35]
  s_waitcnt lgkmcnt(4)
  v_max3_f32 v80, v68, v69, v70
  v_max3_f32 v80, v80, v71, v72
  v_mfma_f32_16x16x32_bf16 v[20:23], a[44:47], v[60:63], v[20:23]
  ds_read_b128 v[52:55], v18 offset:768
  v_max3_f32 v80, v80, v73, v74
  v_mfma_f32_16x16x32_bf16 v[24:27], a[172:175], v[60:63], v[24:27]
  ds_read_b128 v[56:59], v18 offset:33536
  v_max_f32 v82, v80, v75
  v_mfma_f32_16x16x32_bf16 v[28:31], a[44:47], v[64:67], v[28:31]
  buffer_load_dwordx4 v13, s[12:15], s63 offen offset:1024 lds
  v_max_f32 v80, v80, v75
  v_mfma_f32_16x16x32_bf16 v[32:35], a[172:175], v[64:67], v[32:35]
  s_waitcnt lgkmcnt(4)
  v_cndmask_b32 v233, 0, v227, s[68:69]
  v_cndmask_b32 v235, v227, 0, s[68:69]
  v_mfma_f32_16x16x32_bf16 v[20:23], a[48:51], v[36:39], v[20:23]
  ds_read_b128 v[60:63], v19 offset:768
  v_permlane32_swap_b32 v80, v82
  v_mfma_f32_16x16x32_bf16 v[24:27], a[176:179], v[36:39], v[24:27]
  ds_read_b128 v[64:67], v19 offset:33536
  s_add_u32 m0, s65, 12288
  v_mfma_f32_16x16x32_bf16 v[28:31], a[48:51], v[40:43], v[28:31]
  buffer_load_dwordx4 v14, s[12:15], s63 offen lds
  v_max3_f32 v80, v80, v82, v76
  v_mfma_f32_16x16x32_bf16 v[32:35], a[176:179], v[40:43], v[32:35]
  s_waitcnt lgkmcnt(4)
  v_max_f32 v80, v80, v77
  v_max3_f32 v82, v80, v78, v79
  v_mfma_f32_16x16x32_bf16 v[20:23], a[52:55], v[44:47], v[20:23]
  ds_read_b128 v[36:39], v16 offset:1024
  v_max3_f32 v80, v80, v78, v79
  v_mfma_f32_16x16x32_bf16 v[24:27], a[180:183], v[44:47], v[24:27]
  ds_read_b128 v[40:43], v16 offset:33792
  v_mul_f32 v68, s66, v68
  v_mfma_f32_16x16x32_bf16 v[28:31], a[52:55], v[48:51], v[28:31]
  buffer_load_dwordx4 v14, s[12:15], s63 offen offset:1024 lds
  v_mul_f32 v69, s66, v69
  v_mfma_f32_16x16x32_bf16 v[32:35], a[180:183], v[48:51], v[32:35]
  s_waitcnt lgkmcnt(4)
  v_mul_f32 v70, s66, v70
  v_mul_f32 v71, s66, v71
  v_mfma_f32_16x16x32_bf16 v[20:23], a[56:59], v[52:55], v[20:23]
  ds_read_b128 v[44:47], v17 offset:1024
  v_mul_f32 v72, s66, v72
  v_mfma_f32_16x16x32_bf16 v[24:27], a[184:187], v[52:55], v[24:27]
  ds_read_b128 v[48:51], v17 offset:33792
  s_add_u32 m0, s65, 14336
  v_mfma_f32_16x16x32_bf16 v[28:31], a[56:59], v[56:59], v[28:31]
  buffer_load_dwordx4 v15, s[12:15], s63 offen lds
  v_mul_f32 v73, s66, v73
  v_mfma_f32_16x16x32_bf16 v[32:35], a[184:187], v[56:59], v[32:35]
  s_waitcnt lgkmcnt(4)
  v_mul_f32 v74, s66, v74
  v_mul_f32 v75, s66, v75
  v_mfma_f32_16x16x32_bf16 v[20:23], a[60:63], v[60:63], v[20:23]
  ds_read_b128 v[52:55], v18 offset:1024
  v_mul_f32 v76, s66, v76
  v_mfma_f32_16x16x32_bf16 v[24:27], a[188:191], v[60:63], v[24:27]
  ds_read_b128 v[56:59], v18 offset:33792
  v_mul_f32 v77, s66, v77
  v_mfma_f32_16x16x32_bf16 v[28:31], a[60:63], v[64:67], v[28:31]
  buffer_load_dwordx4 v15, s[12:15], s63 offen offset:1024 lds
  v_mul_f32 v78, s66, v78
  v_mfma_f32_16x16x32_bf16 v[32:35], a[188:191], v[64:67], v[32:35]
  s_waitcnt lgkmcnt(4)
  v_mul_f32 v79, s66, v79
  v_mfma_f32_16x16x32_bf16 v[20:23], a[64:67], v[36:39], v[20:23]
  ds_read_b128 v[60:63], v19 offset:1024
  v_permlane16_swap_b32 v80, v82
  v_mfma_f32_16x16x32_bf16 v[24:27], a[192:195], v[36:39], v[24:27]
  ds_read_b128 v[64:67], v19 offset:33792
  v_max_f32 v80, v80, v82
  v_mfma_f32_16x16x32_bf16 v[28:31], a[64:67], v[40:43], v[28:31]
  buffer_load_dword v6, v5, s[12:15], s70 offen
  v_mul_f32 v80, s66, v80
  v_mfma_f32_16x16x32_bf16 v[32:35], a[192:195], v[40:43], v[32:35]
  s_waitcnt lgkmcnt(4)
  v_sub_f32 v68, v68, v80
  v_sub_f32 v69, v69, v80
  v_mfma_f32_16x16x32_bf16 v[20:23], a[68:71], v[44:47], v[20:23]
  ds_read_b128 v[36:39], v16 offset:1280
  v_sub_f32 v70, v70, v80
  v_mfma_f32_16x16x32_bf16 v[24:27], a[196:199], v[44:47], v[24:27]
  ds_read_b128 v[40:43], v16 offset:34048
  v_sub_f32 v71, v71, v80
  v_mfma_f32_16x16x32_bf16 v[28:31], a[68:71], v[48:51], v[28:31]
  v_sub_f32 v72, v72, v80
  v_sub_f32 v73, v73, v80
  v_mfma_f32_16x16x32_bf16 v[32:35], a[196:199], v[48:51], v[32:35]
  s_waitcnt lgkmcnt(4)
  v_sub_f32 v74, v74, v80
  v_sub_f32 v75, v75, v80
  v_mfma_f32_16x16x32_bf16 v[20:23], a[72:75], v[52:55], v[20:23]
  ds_read_b128 v[44:47], v17 offset:1280
  v_sub_f32 v76, v76, v80
  v_mfma_f32_16x16x32_bf16 v[24:27], a[200:203], v[52:55], v[24:27]
  ds_read_b128 v[48:51], v17 offset:34048
  v_sub_f32 v77, v77, v80
  v_mfma_f32_16x16x32_bf16 v[28:31], a[72:75], v[56:59], v[28:31]
  s_waitcnt vmcnt(9)
  s_barrier
  v_readfirstlane_b32 s72, v127
  v_mfma_f32_16x16x32_bf16 v[32:35], a[200:203], v[56:59], v[32:35]
  s_waitcnt lgkmcnt(4)
  s_max_i32 s64, s74, 0
  v_mov_b32 v126, s64
  v_mfma_f32_16x16x32_bf16 v[20:23], a[76:79], v[60:63], v[20:23]
  ds_read_b128 v[52:55], v18 offset:1280
  s_cmp_lt_u32 s72, s61
  s_cbranch_scc1 Lqp_215
Lqp_216:
  v_mfma_f32_16x16x32_bf16 v[24:27], a[204:207], v[60:63], v[24:27]
  ds_read_b128 v[56:59], v18 offset:34048
  v_sub_f32 v78, v78, v80
  v_mfma_f32_16x16x32_bf16 v[28:31], a[76:79], v[64:67], v[28:31]
  buffer_load_dwordx4 v[208:211], v133, s[4:7], s75 offen offset:0 sc1
  v_sub_f32 v79, v79, v80
  v_mfma_f32_16x16x32_bf16 v[32:35], a[204:207], v[64:67], v[32:35]
  s_waitcnt lgkmcnt(4)
  buffer_load_dwordx4 v[212:215], v133, s[4:7], s75 offen offset:512 sc1
  v_exp_f32 v68, v68
  v_mfma_f32_16x16x32_bf16 v[20:23], a[80:83], v[36:39], v[20:23]
  ds_read_b128 v[60:63], v19 offset:1280
  v_exp_f32 v69, v69
  v_mfma_f32_16x16x32_bf16 v[24:27], a[208:211], v[36:39], v[24:27]
  ds_read_b128 v[64:67], v19 offset:34048
  v_exp_f32 v70, v70
  v_mfma_f32_16x16x32_bf16 v[28:31], a[80:83], v[40:43], v[28:31]
  buffer_load_dwordx4 v[216:219], v133, s[4:7], s75 offen offset:1024 sc1
  v_exp_f32 v71, v71
  v_mfma_f32_16x16x32_bf16 v[32:35], a[208:211], v[40:43], v[32:35]
  s_waitcnt lgkmcnt(4)
  buffer_load_dwordx4 v[220:223], v133, s[4:7], s75 offen offset:1536 sc1
  v_exp_f32 v72, v72
  v_mfma_f32_16x16x32_bf16 v[20:23], a[84:87], v[44:47], v[20:23]
  ds_read_b128 v[36:39], v16 offset:1536
  v_exp_f32 v73, v73
  v_mfma_f32_16x16x32_bf16 v[24:27], a[212:215], v[44:47], v[24:27]
  ds_read_b128 v[40:43], v16 offset:34304
  v_exp_f32 v74, v74
  v_mfma_f32_16x16x32_bf16 v[28:31], a[84:87], v[48:51], v[28:31]
  buffer_load_dwordx2 v[224:225], v134, s[4:7], s76 offen offset:0 sc1
  v_exp_f32 v75, v75
  v_mfma_f32_16x16x32_bf16 v[32:35], a[212:215], v[48:51], v[32:35]
  s_waitcnt lgkmcnt(4)
  buffer_load_dwordx2 v[226:227], v134, s[4:7], s76 offen offset:512 sc1
  v_cvt_pk_bf16_f32 v100, v68, v69
  v_mfma_f32_16x16x32_bf16 v[20:23], a[88:91], v[52:55], v[20:23]
  ds_read_b128 v[44:47], v17 offset:1536
  v_cvt_pk_bf16_f32 v101, v70, v71
  v_mfma_f32_16x16x32_bf16 v[24:27], a[216:219], v[52:55], v[24:27]
  ds_read_b128 v[48:51], v17 offset:34304
  v_cvt_pk_bf16_f32 v102, v72, v73
  v_mfma_f32_16x16x32_bf16 v[28:31], a[88:91], v[56:59], v[28:31]
  s_lshl_b32 s56, s50, 11
  s_add_u32 m0, s56, 147456
  s_nop 0
  buffer_load_dwordx4 v1, s[4:7], s77 offen sc1 lds
  v_mfma_f32_16x16x32_bf16 v[32:35], a[216:219], v[56:59], v[32:35]
  s_waitcnt lgkmcnt(4)
  buffer_load_dwordx4 v1, s[4:7], s77 offen offset:1024 sc1 lds
  v_cvt_pk_bf16_f32 v103, v74, v75
  v_mfma_f32_16x16x32_bf16 v[20:23], a[92:95], v[60:63], v[20:23]
  ds_read_b128 v[52:55], v18 offset:1536
  v_exp_f32 v76, v76
  v_mfma_f32_16x16x32_bf16 v[24:27], a[220:223], v[60:63], v[24:27]
  ds_read_b128 v[56:59], v18 offset:34304
  v_exp_f32 v77, v77
  v_mfma_f32_16x16x32_bf16 v[244:247], v[236:239], v[100:103], 0
  v_exp_f32 v78, v78
  v_mfma_f32_16x16x32_bf16 v[84:87], v[192:195], v[100:103], 0
  v_exp_f32 v79, v79
  v_mfma_f32_16x16x32_bf16 v[88:91], v[196:199], v[100:103], 0
  v_cvt_pk_bf16_f32 v104, v76, v77
  v_cvt_pk_bf16_f32 v105, v78, v79
  v_mfma_f32_16x16x32_bf16 v[92:95], v[200:203], v[100:103], 0
  v_mfma_f32_16x16x32_bf16 v[96:99], v[204:207], v[100:103], 0
  v_mfma_f32_16x16x16_bf16 v[244:247], v[240:241], v[104:105], v[244:247]
  v_mfma_f32_16x16x16_bf16 v[84:87], v[228:229], v[104:105], v[84:87]
  v_mfma_f32_16x16x16_bf16 v[88:91], v[230:231], v[104:105], v[88:91]
  v_mfma_f32_16x16x16_bf16 v[92:95], v[232:233], v[104:105], v[92:95]
  v_mfma_f32_16x16x16_bf16 v[96:99], v[234:235], v[104:105], v[96:99]
  v_mfma_f32_16x16x32_bf16 v[28:31], a[92:95], v[64:67], v[28:31]
  s_lshl_b32 s56, s50, 11
  s_add_u32 m0, s56, 155648
  s_nop 0
  buffer_load_dwordx4 v1, s[4:7], s53 offen sc1 lds
  v_mfma_f32_16x16x32_bf16 v[32:35], a[220:223], v[64:67], v[32:35]
  s_waitcnt lgkmcnt(4)
  buffer_load_dwordx4 v1, s[4:7], s53 offen offset:1024 sc1 lds
  v_mfma_f32_16x16x32_bf16 v[20:23], a[96:99], v[36:39], v[20:23]
  ds_read_b128 v[60:63], v19 offset:1536
  v_rcp_f32 v244, v244
  v_mfma_f32_16x16x32_bf16 v[24:27], a[224:227], v[36:39], v[24:27]
  ds_read_b128 v[64:67], v19 offset:34304
  v_mul_f32 v84, v84, v244
  v_mfma_f32_16x16x32_bf16 v[28:31], a[96:99], v[40:43], v[28:31]
  buffer_store_dword v126, v135, s[4:7], s71 offen sc1
  v_mul_f32 v85, v85, v244
  v_mfma_f32_16x16x32_bf16 v[32:35], a[224:227], v[40:43], v[32:35]
  s_waitcnt lgkmcnt(4)
  v_mul_f32 v86, v86, v244
  v_mul_f32 v87, v87, v244
  v_mfma_f32_16x16x32_bf16 v[20:23], a[100:103], v[44:47], v[20:23]
  ds_read_b128 v[36:39], v16 offset:1792
  v_mul_f32 v88, v88, v244
  v_mfma_f32_16x16x32_bf16 v[24:27], a[228:231], v[44:47], v[24:27]
  ds_read_b128 v[40:43], v16 offset:34560
  v_mul_f32 v89, v89, v244
  v_mfma_f32_16x16x32_bf16 v[28:31], a[100:103], v[48:51], v[28:31]
  v_mul_f32 v90, v90, v244
  v_mul_f32 v91, v91, v244
  v_mfma_f32_16x16x32_bf16 v[32:35], a[228:231], v[48:51], v[32:35]
  s_waitcnt lgkmcnt(4)
  v_cvt_pk_bf16_f32 v100, v84, v85
  v_cvt_pk_bf16_f32 v101, v86, v87
  v_mfma_f32_16x16x32_bf16 v[20:23], a[104:107], v[52:55], v[20:23]
  ds_read_b128 v[44:47], v17 offset:1792
  v_cvt_pk_bf16_f32 v102, v88, v89
  v_mfma_f32_16x16x32_bf16 v[24:27], a[232:235], v[52:55], v[24:27]
  ds_read_b128 v[48:51], v17 offset:34560
  v_cvt_pk_bf16_f32 v103, v90, v91
  v_mfma_f32_16x16x32_bf16 v[28:31], a[104:107], v[56:59], v[28:31]
  v_mul_f32 v92, v92, v244
  v_mul_f32 v93, v93, v244
  v_mfma_f32_16x16x32_bf16 v[32:35], a[232:235], v[56:59], v[32:35]
  s_waitcnt lgkmcnt(4)
  v_mul_f32 v94, v94, v244
  v_mul_f32 v95, v95, v244
  v_mfma_f32_16x16x32_bf16 v[20:23], a[108:111], v[60:63], v[20:23]
  ds_read_b128 v[52:55], v18 offset:1792
  v_mul_f32 v96, v96, v244
  v_mfma_f32_16x16x32_bf16 v[24:27], a[236:239], v[60:63], v[24:27]
  ds_read_b128 v[56:59], v18 offset:34560
  v_mul_f32 v97, v97, v244
  v_mfma_f32_16x16x32_bf16 v[28:31], a[108:111], v[64:67], v[28:31]
  v_mul_f32 v98, v98, v244
  v_mul_f32 v99, v99, v244
  v_mfma_f32_16x16x32_bf16 v[32:35], a[236:239], v[64:67], v[32:35]
  s_waitcnt lgkmcnt(4)
  v_cvt_pk_bf16_f32 v104, v92, v93
  v_cvt_pk_bf16_f32 v105, v94, v95
  v_mfma_f32_16x16x32_bf16 v[20:23], a[112:115], v[36:39], v[20:23]
  ds_read_b128 v[60:63], v19 offset:1792
  v_cvt_pk_bf16_f32 v106, v96, v97
  v_mfma_f32_16x16x32_bf16 v[24:27], a[240:243], v[36:39], v[24:27]
  ds_read_b128 v[64:67], v19 offset:34560
  v_cvt_pk_bf16_f32 v107, v98, v99
  v_mfma_f32_16x16x32_bf16 v[28:31], a[112:115], v[40:43], v[28:31]
  s_add_u32 s74, s74, 1
  s_cmp_ge_i32 s74, 0
  s_cselect_b32 s56, 0, 0x80000000
  v_mfma_f32_16x16x32_bf16 v[32:35], a[240:243], v[40:43], v[32:35]
  s_waitcnt lgkmcnt(4)
  v_xor_b32 v128, 8192, v128
  v_xor_b32 v129, 8192, v129
  v_mfma_f32_16x16x32_bf16 v[20:23], a[116:119], v[44:47], v[20:23]
  v_xor_b32 v16, 0x10000, v16
  v_mfma_f32_16x16x32_bf16 v[24:27], a[244:247], v[44:47], v[24:27]
  buffer_store_dwordx4 v[100:103], v248, s[4:7], s3 offen offset:0 sc1
  v_mfma_f32_16x16x32_bf16 v[28:31], a[116:119], v[48:51], v[28:31]
  buffer_store_dwordx4 v[104:107], v248, s[4:7], s3 offen offset:1024 sc1
  v_mfma_f32_16x16x32_bf16 v[32:35], a[244:247], v[48:51], v[32:35]
  s_waitcnt lgkmcnt(2)
  v_mfma_f32_16x16x32_bf16 v[20:23], a[120:123], v[52:55], v[20:23]
  v_xor_b32 v17, 0x10000, v17
  v_mfma_f32_16x16x32_bf16 v[24:27], a[248:251], v[52:55], v[24:27]
  v_mfma_f32_16x16x32_bf16 v[28:31], a[120:123], v[56:59], v[28:31]
  v_mfma_f32_16x16x32_bf16 v[32:35], a[248:251], v[56:59], v[32:35]
  s_waitcnt lgkmcnt(0)
  v_mfma_f32_16x16x32_bf16 v[20:23], a[124:127], v[60:63], v[20:23]
  v_xor_b32 v18, 0x10000, v18
  v_mfma_f32_16x16x32_bf16 v[24:27], a[252:255], v[60:63], v[24:27]
  v_xor_b32 v19, 0x10000, v19
  v_mfma_f32_16x16x32_bf16 v[28:31], a[124:127], v[64:67], v[28:31]
  v_mfma_f32_16x16x32_bf16 v[32:35], a[252:255], v[64:67], v[32:35]
  v_mov_b32 v0, v0
  v_mov_b32 v0, v0
  v_mov_b32 v0, v0
  v_mov_b32 v0, v0
  v_mov_b32 v0, v0
  v_cvt_pk_bf16_f32 v108, v20, v24
  v_cvt_pk_bf16_f32 v109, v21, v25
  v_cvt_pk_bf16_f32 v110, v22, v26
  v_cvt_pk_bf16_f32 v111, v23, v27
  v_cvt_pk_bf16_f32 v112, v28, v32
  v_cvt_pk_bf16_f32 v113, v29, v33
  v_cvt_pk_bf16_f32 v114, v30, v34
  v_cvt_pk_bf16_f32 v115, v31, v35
  ds_write_b128 v128, v[108:111] offset:0
  ds_write_b128 v128, v[112:115] offset:4096
  v_or_b32 v248, s56, v1
  s_waitcnt lgkmcnt(0)
  s_add_u32 s61, s61, 1
  s_cmp_lt_u32 s61, s62
  s_cbranch_scc1 L_qa_loop
  s_waitcnt vmcnt(2)
  s_barrier
  ds_read_b128 v[144:147], v129 offset:0
  ds_read_b128 v[160:163], v130 offset:0
  ds_read_b128 v[176:179], v130 offset:4096
  ds_read_b128 v[148:151], v129 offset:1024
  ds_read_b128 v[164:167], v130 offset:1024
  ds_read_b128 v[180:183], v130 offset:5120
  ds_read_b128 v[152:155], v129 offset:2048
  ds_read_b128 v[168:171], v130 offset:2048
  ds_read_b128 v[184:187], v130 offset:6144
  ds_read_b128 v[156:159], v129 offset:3072
  ds_read_b128 v[172:175], v130 offset:3072
  ds_read_b128 v[188:191], v130 offset:7168
  ds_read_b128 v[192:195], v131 offset:0
  ds_read_b128 v[196:199], v131 offset:1024
  ds_read_b128 v[200:203], v131 offset:2048
  ds_read_b128 v[204:207], v131 offset:3072
  s_max_i32 s3, s74, 0
  s_lshl_b32 s3, s3, 18
  s_add_u32 s3, s3, s73
  s_add_u32 s64, s74, 1
  s_max_i32 s64, s64, 0
  s_lshl_b32 s75, s64, 11
  s_add_u32 s75, s75, s67
  s_add_u32 s76, s75, 0x1120000
  s_add_u32 s75, s75, 0x1100000
  s_lshl_b32 s77, s64, 2
  s_add_u32 s77, s77, s50
  s_lshl_b32 s77, s77, 11
  s_add_u32 s77, s77, s67
  s_add_u32 s53, s77, 0x1080000
  s_add_u32 s77, s77, 0x1000000
  s_waitcnt vmcnt(0) lgkmcnt(0)
  s_barrier
  s_lshl_b32 s56, s50, 11
  s_add_u32 m0, s56, 147456
  s_nop 0
  buffer_load_dwordx4 v1, s[4:7], s77 offen sc1 lds
  buffer_load_dwordx4 v1, s[4:7], s77 offen offset:1024 sc1 lds
  s_lshl_b32 s56, s50, 11
  s_add_u32 m0, s56, 155648
  s_nop 0
  buffer_load_dwordx4 v1, s[4:7], s53 offen sc1 lds
  buffer_load_dwordx4 v1, s[4:7], s53 offen offset:1024 sc1 lds
  s_cmp_lg_u32 s50, 3
  s_cbranch_scc1 Lsg_217
  v_mov_b32 v126, 62
  s_lshl_b32 s59, s2, 7
  s_mov_b64 exec, 1
  buffer_store_dword v126, off, s[4:7], s59 sc1
  s_mov_b64 exec, -1
Lsg_217:
  v_mfma_f32_16x16x32_bf16 v[68:71], v[160:163], v[144:147], 0
  v_mfma_f32_16x16x32_bf16 v[72:75], v[176:179], v[144:147], 0
  v_mfma_f32_16x16x32_bf16 v[68:71], v[164:167], v[148:151], v[68:71]
  v_mfma_f32_16x16x32_bf16 v[72:75], v[180:183], v[148:151], v[72:75]
  v_mfma_f32_16x16x32_bf16 v[68:71], v[168:171], v[152:155], v[68:71]
  v_mfma_f32_16x16x32_bf16 v[72:75], v[184:187], v[152:155], v[72:75]
  v_mfma_f32_16x16x32_bf16 v[68:71], v[172:175], v[156:159], v[68:71]
  v_mfma_f32_16x16x32_bf16 v[72:75], v[188:191], v[156:159], v[72:75]
  v_mfma_f32_16x16x32_bf16 v[76:79], v[208:211], v[144:147], 0
  v_cndmask_b32 v228, 0, v224, s[68:69]
  v_cndmask_b32 v230, v224, 0, s[68:69]
  v_mfma_f32_16x16x32_bf16 v[76:79], v[212:215], v[148:151], v[76:79]
  v_cndmask_b32 v229, 0, v225, s[68:69]
  v_cndmask_b32 v231, v225, 0, s[68:69]
  v_mfma_f32_16x16x32_bf16 v[76:79], v[216:219], v[152:155], v[76:79]
  v_cndmask_b32 v232, 0, v226, s[68:69]
  v_cndmask_b32 v234, v226, 0, s[68:69]
  v_mfma_f32_16x16x32_bf16 v[76:79], v[220:223], v[156:159], v[76:79]
  v_bfi_b32 v68, v136, s37, v68
  v_bfi_b32 v69, v137, s37, v69
  v_bfi_b32 v70, v138, s37, v70
  v_bfi_b32 v71, v139, s37, v71
  v_bfi_b32 v72, v140, s37, v72
  v_bfi_b32 v73, v141, s37, v73
  v_bfi_b32 v74, v142, s37, v74
  v_bfi_b32 v75, v143, s37, v75
  v_max3_f32 v80, v68, v69, v70
  v_max3_f32 v80, v80, v71, v72
  v_max3_f32 v80, v80, v73, v74
  v_max_f32 v82, v80, v75
  v_max_f32 v80, v80, v75
  v_cndmask_b32 v233, 0, v227, s[68:69]
  v_cndmask_b32 v235, v227, 0, s[68:69]
  v_permlane32_swap_b32 v80, v82
  v_max3_f32 v80, v80, v82, v76
  v_max_f32 v80, v80, v77
  v_max3_f32 v82, v80, v78, v79
  v_max3_f32 v80, v80, v78, v79
  v_pk_mul_f32 v[68:69], v[68:69], s[66:67] op_sel_hi:[1,0]
  v_pk_mul_f32 v[70:71], v[70:71], s[66:67] op_sel_hi:[1,0]
  v_pk_mul_f32 v[72:73], v[72:73], s[66:67] op_sel_hi:[1,0]
  v_pk_mul_f32 v[74:75], v[74:75], s[66:67] op_sel_hi:[1,0]
  v_pk_mul_f32 v[76:77], v[76:77], s[66:67] op_sel_hi:[1,0]
  v_pk_mul_f32 v[78:79], v[78:79], s[66:67] op_sel_hi:[1,0]
  v_permlane16_swap_b32 v80, v82
  v_max_f32 v80, v80, v82
  v_mul_f32 v80, s66, v80
  v_pk_add_f32 v[68:69], v[68:69], v[80:81] op_sel_hi:[1,0] neg_lo:[0,1] neg_hi:[0,1]
  v_pk_add_f32 v[70:71], v[70:71], v[80:81] op_sel_hi:[1,0] neg_lo:[0,1] neg_hi:[0,1]
  v_pk_add_f32 v[72:73], v[72:73], v[80:81] op_sel_hi:[1,0] neg_lo:[0,1] neg_hi:[0,1]
  v_pk_add_f32 v[74:75], v[74:75], v[80:81] op_sel_hi:[1,0] neg_lo:[0,1] neg_hi:[0,1]
  v_pk_add_f32 v[76:77], v[76:77], v[80:81] op_sel_hi:[1,0] neg_lo:[0,1] neg_hi:[0,1]
  v_pk_add_f32 v[78:79], v[78:79], v[80:81] op_sel_hi:[1,0] neg_lo:[0,1] neg_hi:[0,1]
  v_exp_f32 v68, v68
  v_exp_f32 v69, v69
  v_exp_f32 v70, v70
  v_exp_f32 v71, v71
  v_exp_f32 v72, v72
  v_exp_f32 v73, v73
  v_exp_f32 v74, v74
  v_exp_f32 v75, v75
  v_cvt_pk_bf16_f32 v100, v68, v69
  v_cvt_pk_bf16_f32 v101, v70, v71
  v_cvt_pk_bf16_f32 v102, v72, v73
  v_cvt_pk_bf16_f32 v103, v74, v75
  v_exp_f32 v76, v76
  v_exp_f32 v77, v77
  v_mfma_f32_16x16x32_bf16 v[244:247], v[236:239], v[100:103], 0
  v_exp_f32 v78, v78
  v_mfma_f32_16x16x32_bf16 v[84:87], v[192:195], v[100:103], 0
  v_exp_f32 v79, v79
  v_mfma_f32_16x16x32_bf16 v[88:91], v[196:199], v[100:103], 0
  v_cvt_pk_bf16_f32 v104, v76, v77
  v_cvt_pk_bf16_f32 v105, v78, v79
  v_mfma_f32_16x16x32_bf16 v[92:95], v[200:203], v[100:103], 0
  v_mfma_f32_16x16x32_bf16 v[96:99], v[204:207], v[100:103], 0
  v_mfma_f32_16x16x16_bf16 v[244:247], v[240:241], v[104:105], v[244:247]
  v_mfma_f32_16x16x16_bf16 v[84:87], v[228:229], v[104:105], v[84:87]
  v_mfma_f32_16x16x16_bf16 v[88:91], v[230:231], v[104:105], v[88:91]
  v_mfma_f32_16x16x16_bf16 v[92:95], v[232:233], v[104:105], v[92:95]
  v_mfma_f32_16x16x16_bf16 v[96:99], v[234:235], v[104:105], v[96:99]
  v_mov_b32 v0, v0
  v_mov_b32 v0, v0
  v_mov_b32 v0, v0
  v_mov_b32 v0, v0
  v_rcp_f32 v244, v244
  s_nop 0
  v_pk_mul_f32 v[84:85], v[84:85], v[244:245] op_sel_hi:[1,0]
  v_pk_mul_f32 v[86:87], v[86:87], v[244:245] op_sel_hi:[1,0]
  v_pk_mul_f32 v[88:89], v[88:89], v[244:245] op_sel_hi:[1,0]
  v_pk_mul_f32 v[90:91], v[90:91], v[244:245] op_sel_hi:[1,0]
  v_cvt_pk_bf16_f32 v100, v84, v85
  v_cvt_pk_bf16_f32 v101, v86, v87
  v_cvt_pk_bf16_f32 v102, v88, v89
  v_cvt_pk_bf16_f32 v103, v90, v91
  v_pk_mul_f32 v[92:93], v[92:93], v[244:245] op_sel_hi:[1,0]
  v_pk_mul_f32 v[94:95], v[94:95], v[244:245] op_sel_hi:[1,0]
  v_pk_mul_f32 v[96:97], v[96:97], v[244:245] op_sel_hi:[1,0]
  v_pk_mul_f32 v[98:99], v[98:99], v[244:245] op_sel_hi:[1,0]
  v_cvt_pk_bf16_f32 v104, v92, v93
  v_cvt_pk_bf16_f32 v105, v94, v95
  v_cvt_pk_bf16_f32 v106, v96, v97
  v_cvt_pk_bf16_f32 v107, v98, v99
  buffer_store_dwordx4 v[100:103], v248, s[4:7], s3 offen offset:0 sc1
  buffer_store_dwordx4 v[104:107], v248, s[4:7], s3 offen offset:1024 sc1
  v_xor_b32 v129, 8192, v129
  s_add_u32 s74, s74, 1
  s_waitcnt vmcnt(2)
  s_barrier
  ds_read_b128 v[144:147], v129 offset:0
  ds_read_b128 v[160:163], v130 offset:0
  ds_read_b128 v[176:179], v130 offset:4096
  ds_read_b128 v[148:151], v129 offset:1024
  ds_read_b128 v[164:167], v130 offset:1024
  ds_read_b128 v[180:183], v130 offset:5120
  ds_read_b128 v[152:155], v129 offset:2048
  ds_read_b128 v[168:171], v130 offset:2048
  ds_read_b128 v[184:187], v130 offset:6144
  ds_read_b128 v[156:159], v129 offset:3072
  ds_read_b128 v[172:175], v130 offset:3072
  ds_read_b128 v[188:191], v130 offset:7168
  ds_read_b128 v[192:195], v131 offset:0
  ds_read_b128 v[196:199], v131 offset:1024
  ds_read_b128 v[200:203], v131 offset:2048
  ds_read_b128 v[204:207], v131 offset:3072
  s_max_i32 s3, s74, 0
  s_lshl_b32 s3, s3, 18
  s_add_u32 s3, s3, s73
  s_waitcnt lgkmcnt(0)
  v_mfma_f32_16x16x32_bf16 v[68:71], v[160:163], v[144:147], 0
  v_mfma_f32_16x16x32_bf16 v[72:75], v[176:179], v[144:147], 0
  v_mfma_f32_16x16x32_bf16 v[68:71], v[164:167], v[148:151], v[68:71]
  v_mfma_f32_16x16x32_bf16 v[72:75], v[180:183], v[148:151], v[72:75]
  v_mfma_f32_16x16x32_bf16 v[68:71], v[168:171], v[152:155], v[68:71]
  v_mfma_f32_16x16x32_bf16 v[72:75], v[184:187], v[152:155], v[72:75]
  v_mfma_f32_16x16x32_bf16 v[68:71], v[172:175], v[156:159], v[68:71]
  v_mfma_f32_16x16x32_bf16 v[72:75], v[188:191], v[156:159], v[72:75]
  buffer_load_dwordx4 v[208:211], v133, s[4:7], s75 offen offset:0 sc1
  buffer_load_dwordx4 v[212:215], v133, s[4:7], s75 offen offset:512 sc1
  buffer_load_dwordx4 v[216:219], v133, s[4:7], s75 offen offset:1024 sc1
  buffer_load_dwordx4 v[220:223], v133, s[4:7], s75 offen offset:1536 sc1
  buffer_load_dwordx2 v[224:225], v134, s[4:7], s76 offen offset:0 sc1
  buffer_load_dwordx2 v[226:227], v134, s[4:7], s76 offen offset:512 sc1
  s_waitcnt vmcnt(6)
  s_barrier
  v_mov_b32 v127, 63
  buffer_store_dword v127, v135, s[4:7], s71 offen sc1
  s_waitcnt vmcnt(1)
Lqd_218:
  v_max3_u32 v126, v208, v209, v210
  v_max3_u32 v126, v126, v211, v212
  v_max3_u32 v126, v126, v213, v214
  v_max3_u32 v126, v126, v215, v216
  v_max3_u32 v126, v126, v217, v218
  v_max3_u32 v126, v126, v219, v220
  v_max3_u32 v126, v126, v221, v222
  v_max3_u32 v126, v126, v223, v224
  v_max3_u32 v126, v126, v225, v226
  v_max_u32 v126, v126, v227
  v_cmp_eq_u32 vcc, -1, v126
  s_cbranch_vccz Lqd_219
  s_add_u32 s55, s55, 1
  s_bitcmp1_b32 s55, 21
  s_cbranch_scc1 L_abort
  buffer_load_dwordx4 v[208:211], v133, s[4:7], s75 offen offset:0 sc1
  buffer_load_dwordx4 v[212:215], v133, s[4:7], s75 offen offset:512 sc1
  buffer_load_dwordx4 v[216:219], v133, s[4:7], s75 offen offset:1024 sc1
  buffer_load_dwordx4 v[220:223], v133, s[4:7], s75 offen offset:1536 sc1
  buffer_load_dwordx2 v[224:225], v134, s[4:7], s76 offen offset:0 sc1
  buffer_load_dwordx2 v[226:227], v134, s[4:7], s76 offen offset:512 sc1
  s_waitcnt vmcnt(0)
  s_branch Lqd_218
Lqd_219:
  v_mfma_f32_16x16x32_bf16 v[76:79], v[208:211], v[144:147], 0
  v_cndmask_b32 v228, 0, v224, s[68:69]
  v_cndmask_b32 v230, v224, 0, s[68:69]
  v_mfma_f32_16x16x32_bf16 v[76:79], v[212:215], v[148:151], v[76:79]
  v_cndmask_b32 v229, 0, v225, s[68:69]
  v_cndmask_b32 v231, v225, 0, s[68:69]
  v_mfma_f32_16x16x32_bf16 v[76:79], v[216:219], v[152:155], v[76:79]
  v_cndmask_b32 v232, 0, v226, s[68:69]
  v_cndmask_b32 v234, v226, 0, s[68:69]
  v_mfma_f32_16x16x32_bf16 v[76:79], v[220:223], v[156:159], v[76:79]
  v_bfi_b32 v68, v136, s37, v68
  v_bfi_b32 v69, v137, s37, v69
  v_bfi_b32 v70, v138, s37, v70
  v_bfi_b32 v71, v139, s37, v71
  v_bfi_b32 v72, v140, s37, v72
  v_bfi_b32 v73, v141, s37, v73
  v_bfi_b32 v74, v142, s37, v74
  v_bfi_b32 v75, v143, s37, v75
  v_max3_f32 v80, v68, v69, v70
  v_max3_f32 v80, v80, v71, v72
  v_max3_f32 v80, v80, v73, v74
  v_max_f32 v82, v80, v75
  v_max_f32 v80, v80, v75
  v_cndmask_b32 v233, 0, v227, s[68:69]
  v_cndmask_b32 v235, v227, 0, s[68:69]
  v_permlane32_swap_b32 v80, v82
  v_max3_f32 v80, v80, v82, v76
  v_max_f32 v80, v80, v77
  v_max3_f32 v82, v80, v78, v79
  v_max3_f32 v80, v80, v78, v79
  v_pk_mul_f32 v[68:69], v[68:69], s[66:67] op_sel_hi:[1,0]
  v_pk_mul_f32 v[70:71], v[70:71], s[66:67] op_sel_hi:[1,0]
  v_pk_mul_f32 v[72:73], v[72:73], s[66:67] op_sel_hi:[1,0]
  v_pk_mul_f32 v[74:75], v[74:75], s[66:67] op_sel_hi:[1,0]
  v_pk_mul_f32 v[76:77], v[76:77], s[66:67] op_sel_hi:[1,0]
  v_pk_mul_f32 v[78:79], v[78:79], s[66:67] op_sel_hi:[1,0]
  v_permlane16_swap_b32 v80, v82
  v_max_f32 v80, v80, v82
  v_mul_f32 v80, s66, v80
  v_pk_add_f32 v[68:69], v[68:69], v[80:81] op_sel_hi:[1,0] neg_lo:[0,1] neg_hi:[0,1]
  v_pk_add_f32 v[70:71], v[70:71], v[80:81] op_sel_hi:[1,0] neg_lo:[0,1] neg_hi:[0,1]
  v_pk_add_f32 v[72:73], v[72:73], v[80:81] op_sel_hi:[1,0] neg_lo:[0,1] neg_hi:[0,1]
  v_pk_add_f32 v[74:75], v[74:75], v[80:81] op_sel_hi:[1,0] neg_lo:[0,1] neg_hi:[0,1]
  v_pk_add_f32 v[76:77], v[76:77], v[80:81] op_sel_hi:[1,0] neg_lo:[0,1] neg_hi:[0,1]
  v_pk_add_f32 v[78:79], v[78:79], v[80:81] op_sel_hi:[1,0] neg_lo:[0,1] neg_hi:[0,1]
  v_exp_f32 v68, v68
  v_exp_f32 v69, v69
  v_exp_f32 v70, v70
  v_exp_f32 v71, v71
  v_exp_f32 v72, v72
  v_exp_f32 v73, v73
  v_exp_f32 v74, v74
  v_exp_f32 v75, v75
  v_cvt_pk_bf16_f32 v100, v68, v69
  v_cvt_pk_bf16_f32 v101, v70, v71
  v_cvt_pk_bf16_f32 v102, v72, v73
  v_cvt_pk_bf16_f32 v103, v74, v75
  v_exp_f32 v76, v76
  v_exp_f32 v77, v77
  v_mfma_f32_16x16x32_bf16 v[244:247], v[236:239], v[100:103], 0
  v_exp_f32 v78, v78
  v_mfma_f32_16x16x32_bf16 v[84:87], v[192:195], v[100:103], 0
  v_exp_f32 v79, v79
  v_mfma_f32_16x16x32_bf16 v[88:91], v[196:199], v[100:103], 0
  v_cvt_pk_bf16_f32 v104, v76, v77
  v_cvt_pk_bf16_f32 v105, v78, v79
  v_mfma_f32_16x16x32_bf16 v[92:95], v[200:203], v[100:103], 0
  v_mfma_f32_16x16x32_bf16 v[96:99], v[204:207], v[100:103], 0
  v_mfma_f32_16x16x16_bf16 v[244:247], v[240:241], v[104:105], v[244:247]
  v_mfma_f32_16x16x16_bf16 v[84:87], v[228:229], v[104:105], v[84:87]
  v_mfma_f32_16x16x16_bf16 v[88:91], v[230:231], v[104:105], v[88:91]
  v_mfma_f32_16x16x16_bf16 v[92:95], v[232:233], v[104:105], v[92:95]
  v_mfma_f32_16x16x16_bf16 v[96:99], v[234:235], v[104:105], v[96:99]
  v_mov_b32 v0, v0
  v_mov_b32 v0, v0
  v_mov_b32 v0, v0
  v_mov_b32 v0, v0
  v_rcp_f32 v244, v244
  s_nop 0
  v_pk_mul_f32 v[84:85], v[84:85], v[244:245] op_sel_hi:[1,0]
  v_pk_mul_f32 v[86:87], v[86:87], v[244:245] op_sel_hi:[1,0]
  v_pk_mul_f32 v[88:89], v[88:89], v[244:245] op_sel_hi:[1,0]
  v_pk_mul_f32 v[90:91], v[90:91], v[244:245] op_sel_hi:[1,0]
  v_cvt_pk_bf16_f32 v100, v84, v85
  v_cvt_pk_bf16_f32 v101, v86, v87
  v_cvt_pk_bf16_f32 v102, v88, v89
  v_cvt_pk_bf16_f32 v103, v90, v91
  v_pk_mul_f32 v[92:93], v[92:93], v[244:245] op_sel_hi:[1,0]
  v_pk_mul_f32 v[94:95], v[94:95], v[244:245] op_sel_hi:[1,0]
  v_pk_mul_f32 v[96:97], v[96:97], v[244:245] op_sel_hi:[1,0]
  v_pk_mul_f32 v[98:99], v[98:99], v[244:245] op_sel_hi:[1,0]
  v_cvt_pk_bf16_f32 v104, v92, v93
  v_cvt_pk_bf16_f32 v105, v94, v95
  v_cvt_pk_bf16_f32 v106, v96, v97
  v_cvt_pk_bf16_f32 v107, v98, v99
  buffer_store_dwordx4 v[100:103], v248, s[4:7], s3 offen offset:0 sc1
  buffer_store_dwordx4 v[104:107], v248, s[4:7], s3 offen offset:1024 sc1
  v_xor_b32 v129, 8192, v129
  s_add_u32 s74, s74, 1
  s_waitcnt vmcnt(0)
  s_barrier
  s_cmp_lg_u32 s50, 3
  s_cbranch_scc1 Lsg_220
  v_mov_b32 v126, 64
  s_lshl_b32 s59, s2, 7
  s_mov_b64 exec, 1
  buffer_store_dword v126, off, s[4:7], s59 sc1
  s_mov_b64 exec, -1
Lsg_220:
  s_branch L_end
Lqp_215:
Lqp_221:
  buffer_load_dword v127, v132, s[4:7], 0 offen sc1
  s_waitcnt vmcnt(0)
  v_readfirstlane_b32 s72, v127
  s_cmp_ge_u32 s72, s61
  s_cbranch_scc1 Lqp_216
  s_sleep 1
  s_add_u32 s55, s55, 1
  s_bitcmp1_b32 s55, 21
  s_cbranch_scc1 L_abort
  s_branch Lqp_221
L_b:
  v_lshlrev_b32 v1, 4, v0
  s_mul_i32 s67, s52, 0x202000
  s_mov_b32 s12, s38
  s_mov_b32 s13, s39
  s_mov_b32 s14, 0x400000
  s_mov_b32 s15, 0x20000
  s_mov_b32 s66, 0x3fb8aa3b
  s_mov_b32 s68, 0x358637bd
  s_cmp_eq_u32 s50, 0
  s_cselect_b32 s8, s34, s8
  s_cselect_b32 s9, s35, s9
  s_cmp_eq_u32 s50, 1
  s_cselect_b32 s8, s28, s8
  s_cselect_b32 s9, s29, s9
  s_cmp_eq_u32 s50, 2
  s_cselect_b32 s8, s30, s8
  s_cselect_b32 s9, s31, s9
  s_cmp_eq_u32 s50, 3
  s_cselect_b32 s8, s32, s8
  s_cselect_b32 s9, s33, s9
  s_sub_u32 s56, s51, 2
  s_lshl_b32 s56, s56, 5
  s_add_u32 s56, s56, s52
  s_lshl_b32 s56, s56, 16
  v_lshlrev_b32 v127, 10, v0
  buffer_load_dword v6, v127, s[8:11], s56 offen offset:384
  s_sub_u32 s56, s51, 2
  s_lshl_b32 s56, s56, 5
  s_add_u32 s56, s56, s52
  s_lshl_b32 s56, s56, 2
  s_add_u32 s56, s56, s50
  s_lshl_b32 s56, s56, 10
  v_lshl_add_u32 v68, v0, 4, s56
  v_mov_b32 v69, 0x80000000
  v_mov_b32 v72, 0
  v_mov_b32 v73, 0
  v_mov_b32 v74, 0
  v_mov_b32 v75, 0
  v_cmp_gt_u32 vcc, 0x9000, v68
  s_mov_b32 s56, 0x0
  s_nop 0
  v_cndmask_b32 v70, v69, v68, vcc
  buffer_store_dwordx4 v[72:75], v70, s[4:7], s56 offen sc1
  s_nop 1
  v_mov_b32 v72, -1
  v_mov_b32 v73, -1
  v_mov_b32 v74, -1
  v_mov_b32 v75, -1
  v_cmp_gt_u32 vcc, 0x90000, v68
  s_mov_b32 s56, 0x90000
  s_nop 0
  v_cndmask_b32 v70, v69, v68, vcc
  buffer_store_dwordx4 v[72:75], v70, s[4:7], s56 offen sc1
  v_cmp_gt_u32 vcc, 0x10000, v68
  s_mov_b32 s56, 0x110000
  s_nop 0
  v_cndmask_b32 v70, v69, v68, vcc
  buffer_store_dwordx4 v[72:75], v70, s[4:7], s56 offen sc1
  s_nop 1
  v_mov_b32 v72, -1
  v_mov_b32 v73, -1
  v_mov_b32 v74, -1
  v_mov_b32 v75, -1
  v_cmp_gt_u32 vcc, 0xa0000, v68
  s_mov_b32 s56, 0x200000
  s_nop 0
  v_cndmask_b32 v70, v69, v68, vcc
  buffer_store_dwordx4 v[72:75], v70, s[4:7], s56 offen sc1
  v_cmp_gt_u32 vcc, 0x20000, v68
  s_mov_b32 s56, 0x280000
  s_nop 0
  v_cndmask_b32 v70, v69, v68, vcc
  buffer_store_dwordx4 v[72:75], v70, s[4:7], s56 offen sc1
  s_waitcnt vmcnt(0)
  s_barrier
  s_cmp_lg_u32 s50, 0
  s_cbranch_scc1 Lar_222
  s_cmp_eq_u32 s100, 0
  s_cselect_b32 s56, 0, 128
  v_mov_b32 v68, 1
  s_mov_b64 exec, 1
  buffer_atomic_add v68, off, s[20:23], s56 sc1
  s_mov_b64 exec, -1
Lar_222:
  s_mov_b32 s8, s40
  s_mov_b32 s9, s41
  s_mov_b32 s10, 0x600000
  s_mov_b32 s11, 0x20000
  v_lshrrev_b32 v126, 3, v0
  v_mul_u32_u24 v2, 6144, v126
  v_and_b32 v126, 2, v126
  v_xor_b32 v126, v126, v0
  v_and_b32 v126, 7, v126
  v_lshlrev_b32 v126, 4, v126
  v_xor_b32 v3, 64, v126
  v_add_u32 v3, v3, v2
  v_add_u32 v2, v126, v2
  v_lshrrev_b32 v126, 4, v0
  v_lshlrev_b32 v126, 3, v126
  v_bfe_u32 v127, v0, 2, 2
  v_add_u32 v126, v126, v127
  v_lshrrev_b32 v127, 5, v0
  v_lshlrev_b32 v127, 1, v127
  v_bfe_u32 v4, v0, 3, 1
  v_or_b32 v127, v127, v4
  v_lshlrev_b32 v126, 7, v126
  v_xor_b32 v127, s50, v127
  v_and_b32 v4, 3, v0
  v_lshl_add_u32 v126, v4, 3, v126
  v_lshl_add_u32 v126, v127, 5, v126
  v_xor_b32 v68, 0, v126
  v_add_u32 v72, 0x10000, v68
  v_xor_b32 v69, 32, v126
  v_add_u32 v73, 0x10000, v69
  v_xor_b32 v70, 64, v126
  v_add_u32 v74, 0x10000, v70
  v_xor_b32 v71, 96, v126
  v_add_u32 v75, 0x10000, v71
  s_and_b32 s60, s52, 15
  s_lshl_b32 s60, s60, 7
  s_add_u32 s60, s60, 2048
  s_mul_i32 s56, s50, 1572864
  s_add_u32 s60, s60, s56
  s_lshl_b32 s56, s50, 15
  s_add_u32 s56, s56, 0
  s_sub_u32 s57, s60, 49152
  s_mov_b32 s58, 4
Ldma_223:
  s_mov_b32 m0, s56
  s_add_u32 s57, s57, 49152
  buffer_load_dwordx4 v2, s[8:11], s57 offen nt lds
  s_add_u32 s56, s56, 1024
  s_mov_b32 m0, s56
  s_add_u32 s57, s57, 49152
  buffer_load_dwordx4 v2, s[8:11], s57 offen nt lds
  s_add_u32 s56, s56, 1024
  s_mov_b32 m0, s56
  s_add_u32 s57, s57, 49152
  buffer_load_dwordx4 v3, s[8:11], s57 offen nt lds
  s_add_u32 s56, s56, 1024
  s_mov_b32 m0, s56
  s_add_u32 s57, s57, 49152
  buffer_load_dwordx4 v3, s[8:11], s57 offen nt lds
  s_add_u32 s56, s56, 1024
  s_sub_u32 s58, s58, 1
  s_cmp_lg_u32 s58, 0
  s_cbranch_scc1 Ldma_223
  s_and_b32 s60, s52, 15
  s_lshl_b32 s60, s60, 7
  s_add_u32 s60, s60, 2048
  s_mul_i32 s56, s50, 1572864
  s_add_u32 s60, s60, s56
  s_add_u32 s60, s60, 786432
  s_lshl_b32 s56, s50, 15
  s_add_u32 s56, s56, 16384
  s_sub_u32 s57, s60, 49152
  s_mov_b32 s58, 4
Ldma_224:
  s_mov_b32 m0, s56
  s_add_u32 s57, s57, 49152
  buffer_load_dwordx4 v2, s[8:11], s57 offen nt lds
  s_add_u32 s56, s56, 1024
  s_mov_b32 m0, s56
  s_add_u32 s57, s57, 49152
  buffer_load_dwordx4 v2, s[8:11], s57 offen nt lds
  s_add_u32 s56, s56, 1024
  s_mov_b32 m0, s56
  s_add_u32 s57, s57, 49152
  buffer_load_dwordx4 v3, s[8:11], s57 offen nt lds
  s_add_u32 s56, s56, 1024
  s_mov_b32 m0, s56
  s_add_u32 s57, s57, 49152
  buffer_load_dwordx4 v3, s[8:11], s57 offen nt lds
  s_add_u32 s56, s56, 1024
  s_sub_u32 s58, s58, 1
  s_cmp_lg_u32 s58, 0
  s_cbranch_scc1 Ldma_224
  s_waitcnt vmcnt(16)
  s_barrier
  ds_read_b64_tr_b16 a[0:1], v68 offset:0
  ds_read_b64_tr_b16 a[2:3], v68 offset:512
  ds_read_b64_tr_b16 a[4:5], v68 offset:4096
  ds_read_b64_tr_b16 a[6:7], v68 offset:4608
  ds_read_b64_tr_b16 a[8:9], v68 offset:8192
  ds_read_b64_tr_b16 a[10:11], v68 offset:8704
  ds_read_b64_tr_b16 a[12:13], v68 offset:12288
  ds_read_b64_tr_b16 a[14:15], v68 offset:12800
  ds_read_b64_tr_b16 a[32:33], v68 offset:32768
  ds_read_b64_tr_b16 a[34:35], v68 offset:33280
  ds_read_b64_tr_b16 a[36:37], v68 offset:36864
  ds_read_b64_tr_b16 a[38:39], v68 offset:37376
  ds_read_b64_tr_b16 a[40:41], v68 offset:40960
  ds_read_b64_tr_b16 a[42:43], v68 offset:41472
  ds_read_b64_tr_b16 a[44:45], v68 offset:45056
  ds_read_b64_tr_b16 a[46:47], v68 offset:45568
  ds_read_b64_tr_b16 a[64:65], v72 offset:0
  ds_read_b64_tr_b16 a[66:67], v72 offset:512
  ds_read_b64_tr_b16 a[68:69], v72 offset:4096
  ds_read_b64_tr_b16 a[70:71], v72 offset:4608
  ds_read_b64_tr_b16 a[72:73], v72 offset:8192
  ds_read_b64_tr_b16 a[74:75], v72 offset:8704
  ds_read_b64_tr_b16 a[76:77], v72 offset:12288
  ds_read_b64_tr_b16 a[78:79], v72 offset:12800
  ds_read_b64_tr_b16 a[96:97], v72 offset:32768
  ds_read_b64_tr_b16 a[98:99], v72 offset:33280
  ds_read_b64_tr_b16 a[100:101], v72 offset:36864
  ds_read_b64_tr_b16 a[102:103], v72 offset:37376
  ds_read_b64_tr_b16 a[104:105], v72 offset:40960
  ds_read_b64_tr_b16 a[106:107], v72 offset:41472
  ds_read_b64_tr_b16 a[108:109], v72 offset:45056
  ds_read_b64_tr_b16 a[110:111], v72 offset:45568
Lro_225:
  s_waitcnt lgkmcnt(0)
  s_barrier
  s_and_b32 s60, s52, 15
  s_lshl_b32 s60, s60, 7
  s_add_u32 s60, s60, 4096
  s_mul_i32 s56, s50, 1572864
  s_add_u32 s60, s60, s56
  s_lshl_b32 s56, s50, 15
  s_add_u32 s56, s56, 0
  s_sub_u32 s57, s60, 49152
  s_mov_b32 s58, 4
Ldma_226:
  s_mov_b32 m0, s56
  s_add_u32 s57, s57, 49152
  buffer_load_dwordx4 v2, s[8:11], s57 offen nt lds
  s_add_u32 s56, s56, 1024
  s_mov_b32 m0, s56
  s_add_u32 s57, s57, 49152
  buffer_load_dwordx4 v2, s[8:11], s57 offen nt lds
  s_add_u32 s56, s56, 1024
  s_mov_b32 m0, s56
  s_add_u32 s57, s57, 49152
  buffer_load_dwordx4 v3, s[8:11], s57 offen nt lds
  s_add_u32 s56, s56, 1024
  s_mov_b32 m0, s56
  s_add_u32 s57, s57, 49152
  buffer_load_dwordx4 v3, s[8:11], s57 offen nt lds
  s_add_u32 s56, s56, 1024
  s_sub_u32 s58, s58, 1
  s_cmp_lg_u32 s58, 0
  s_cbranch_scc1 Ldma_226
  s_waitcnt vmcnt(16)
  s_barrier
  ds_read_b64_tr_b16 a[16:17], v68 offset:16384
  ds_read_b64_tr_b16 a[18:19], v68 offset:16896
  ds_read_b64_tr_b16 a[20:21], v68 offset:20480
  ds_read_b64_tr_b16 a[22:23], v68 offset:20992
  ds_read_b64_tr_b16 a[24:25], v68 offset:24576
  ds_read_b64_tr_b16 a[26:27], v68 offset:25088
  ds_read_b64_tr_b16 a[28:29], v68 offset:28672
  ds_read_b64_tr_b16 a[30:31], v68 offset:29184
  ds_read_b64_tr_b16 a[48:49], v68 offset:49152
  ds_read_b64_tr_b16 a[50:51], v68 offset:49664
  ds_read_b64_tr_b16 a[52:53], v68 offset:53248
  ds_read_b64_tr_b16 a[54:55], v68 offset:53760
  ds_read_b64_tr_b16 a[56:57], v68 offset:57344
  ds_read_b64_tr_b16 a[58:59], v68 offset:57856
  ds_read_b64_tr_b16 a[60:61], v68 offset:61440
  ds_read_b64_tr_b16 a[62:63], v68 offset:61952
  ds_read_b64_tr_b16 a[80:81], v72 offset:16384
  ds_read_b64_tr_b16 a[82:83], v72 offset:16896
  ds_read_b64_tr_b16 a[84:85], v72 offset:20480
  ds_read_b64_tr_b16 a[86:87], v72 offset:20992
  ds_read_b64_tr_b16 a[88:89], v72 offset:24576
  ds_read_b64_tr_b16 a[90:91], v72 offset:25088
  ds_read_b64_tr_b16 a[92:93], v72 offset:28672
  ds_read_b64_tr_b16 a[94:95], v72 offset:29184
  ds_read_b64_tr_b16 a[112:113], v72 offset:49152
  ds_read_b64_tr_b16 a[114:115], v72 offset:49664
  ds_read_b64_tr_b16 a[116:117], v72 offset:53248
  ds_read_b64_tr_b16 a[118:119], v72 offset:53760
  ds_read_b64_tr_b16 a[120:121], v72 offset:57344
  ds_read_b64_tr_b16 a[122:123], v72 offset:57856
  ds_read_b64_tr_b16 a[124:125], v72 offset:61440
  ds_read_b64_tr_b16 a[126:127], v72 offset:61952
Lro_227:
  s_waitcnt lgkmcnt(0)
  s_barrier
  s_and_b32 s60, s52, 15
  s_lshl_b32 s60, s60, 7
  s_add_u32 s60, s60, 4096
  s_mul_i32 s56, s50, 1572864
  s_add_u32 s60, s60, s56
  s_add_u32 s60, s60, 786432
  s_lshl_b32 s56, s50, 15
  s_add_u32 s56, s56, 16384
  s_sub_u32 s57, s60, 49152
  s_mov_b32 s58, 4
Ldma_228:
  s_mov_b32 m0, s56
  s_add_u32 s57, s57, 49152
  buffer_load_dwordx4 v2, s[8:11], s57 offen nt lds
  s_add_u32 s56, s56, 1024
  s_mov_b32 m0, s56
  s_add_u32 s57, s57, 49152
  buffer_load_dwordx4 v2, s[8:11], s57 offen nt lds
  s_add_u32 s56, s56, 1024
  s_mov_b32 m0, s56
  s_add_u32 s57, s57, 49152
  buffer_load_dwordx4 v3, s[8:11], s57 offen nt lds
  s_add_u32 s56, s56, 1024
  s_mov_b32 m0, s56
  s_add_u32 s57, s57, 49152
  buffer_load_dwordx4 v3, s[8:11], s57 offen nt lds
  s_add_u32 s56, s56, 1024
  s_sub_u32 s58, s58, 1
  s_cmp_lg_u32 s58, 0
  s_cbranch_scc1 Ldma_228
  s_waitcnt vmcnt(16)
  s_barrier
  ds_read_b64_tr_b16 a[128:129], v68 offset:0
  ds_read_b64_tr_b16 a[130:131], v68 offset:512
  ds_read_b64_tr_b16 a[132:133], v68 offset:4096
  ds_read_b64_tr_b16 a[134:135], v68 offset:4608
  ds_read_b64_tr_b16 a[136:137], v68 offset:8192
  ds_read_b64_tr_b16 a[138:139], v68 offset:8704
  ds_read_b64_tr_b16 a[140:141], v68 offset:12288
  ds_read_b64_tr_b16 a[142:143], v68 offset:12800
  ds_read_b64_tr_b16 a[160:161], v68 offset:32768
  ds_read_b64_tr_b16 a[162:163], v68 offset:33280
  ds_read_b64_tr_b16 a[164:165], v68 offset:36864
  ds_read_b64_tr_b16 a[166:167], v68 offset:37376
  ds_read_b64_tr_b16 a[168:169], v68 offset:40960
  ds_read_b64_tr_b16 a[170:171], v68 offset:41472
  ds_read_b64_tr_b16 a[172:173], v68 offset:45056
  ds_read_b64_tr_b16 a[174:175], v68 offset:45568
  ds_read_b64_tr_b16 a[192:193], v72 offset:0
  ds_read_b64_tr_b16 a[194:195], v72 offset:512
  ds_read_b64_tr_b16 a[196:197], v72 offset:4096
  ds_read_b64_tr_b16 a[198:199], v72 offset:4608
  ds_read_b64_tr_b16 a[200:201], v72 offset:8192
  ds_read_b64_tr_b16 a[202:203], v72 offset:8704
  ds_read_b64_tr_b16 a[204:205], v72 offset:12288
  ds_read_b64_tr_b16 a[206:207], v72 offset:12800
  ds_read_b64_tr_b16 a[224:225], v72 offset:32768
  ds_read_b64_tr_b16 a[226:227], v72 offset:33280
  ds_read_b64_tr_b16 a[228:229], v72 offset:36864
  ds_read_b64_tr_b16 a[230:231], v72 offset:37376
  ds_read_b64_tr_b16 a[232:233], v72 offset:40960
  ds_read_b64_tr_b16 a[234:235], v72 offset:41472
  ds_read_b64_tr_b16 a[236:237], v72 offset:45056
  ds_read_b64_tr_b16 a[238:239], v72 offset:45568
Lro_229:
  s_waitcnt lgkmcnt(0)
  s_barrier
  s_waitcnt vmcnt(0)
  s_barrier
  ds_read_b64_tr_b16 a[144:145], v68 offset:16384
  ds_read_b64_tr_b16 a[146:147], v68 offset:16896
  ds_read_b64_tr_b16 a[148:149], v68 offset:20480
  ds_read_b64_tr_b16 a[150:151], v68 offset:20992
  ds_read_b64_tr_b16 a[152:153], v68 offset:24576
  ds_read_b64_tr_b16 a[154:155], v68 offset:25088
  ds_read_b64_tr_b16 a[156:157], v68 offset:28672
  ds_read_b64_tr_b16 a[158:159], v68 offset:29184
  ds_read_b64_tr_b16 a[176:177], v68 offset:49152
  ds_read_b64_tr_b16 a[178:179], v68 offset:49664
  ds_read_b64_tr_b16 a[180:181], v68 offset:53248
  ds_read_b64_tr_b16 a[182:183], v68 offset:53760
  ds_read_b64_tr_b16 a[184:185], v68 offset:57344
  ds_read_b64_tr_b16 a[186:187], v68 offset:57856
  ds_read_b64_tr_b16 a[188:189], v68 offset:61440
  ds_read_b64_tr_b16 a[190:191], v68 offset:61952
  ds_read_b64_tr_b16 a[208:209], v72 offset:16384
  ds_read_b64_tr_b16 a[210:211], v72 offset:16896
  ds_read_b64_tr_b16 a[212:213], v72 offset:20480
  ds_read_b64_tr_b16 a[214:215], v72 offset:20992
  ds_read_b64_tr_b16 a[216:217], v72 offset:24576
  ds_read_b64_tr_b16 a[218:219], v72 offset:25088
  ds_read_b64_tr_b16 a[220:221], v72 offset:28672
  ds_read_b64_tr_b16 a[222:223], v72 offset:29184
  ds_read_b64_tr_b16 a[240:241], v72 offset:49152
  ds_read_b64_tr_b16 a[242:243], v72 offset:49664
  ds_read_b64_tr_b16 a[244:245], v72 offset:53248
  ds_read_b64_tr_b16 a[246:247], v72 offset:53760
  ds_read_b64_tr_b16 a[248:249], v72 offset:57344
  ds_read_b64_tr_b16 a[250:251], v72 offset:57856
  ds_read_b64_tr_b16 a[252:253], v72 offset:61440
  ds_read_b64_tr_b16 a[254:255], v72 offset:61952
Lro_230:
  s_waitcnt lgkmcnt(0)
  s_barrier
Lwa_231:
  v_lshlrev_b32 v69, 2, v0
  buffer_load_dword v68, v69, s[20:23], 0 offen sc1
  s_waitcnt vmcnt(0)
Lwa_235:
  s_cmp_eq_u32 s100, 0
  s_cbranch_scc1 Lwa_233
  s_mov_b32 s56, 0
  v_readlane_b32 s57, v68, 8
  s_add_u32 s56, s56, s57
  v_readlane_b32 s57, v68, 9
  s_add_u32 s56, s56, s57
  v_readlane_b32 s57, v68, 10
  s_add_u32 s56, s56, s57
  v_readlane_b32 s57, v68, 11
  s_add_u32 s56, s56, s57
  v_readlane_b32 s57, v68, 12
  s_add_u32 s56, s56, s57
  v_readlane_b32 s57, v68, 13
  s_add_u32 s56, s56, s57
  v_readlane_b32 s57, v68, 14
  s_add_u32 s56, s56, s57
  v_readlane_b32 s57, v68, 15
  s_add_u32 s56, s56, s57
  v_readlane_b32 s57, v68, 16
  s_add_u32 s56, s56, s57
  v_readlane_b32 s57, v68, 40
  s_add_u32 s56, s56, s57
  v_readlane_b32 s57, v68, 41
  s_add_u32 s56, s56, s57
  v_readlane_b32 s57, v68, 42
  s_add_u32 s56, s56, s57
  v_readlane_b32 s57, v68, 43
  s_add_u32 s56, s56, s57
  v_readlane_b32 s57, v68, 44
  s_add_u32 s56, s56, s57
  v_readlane_b32 s57, v68, 45
  s_add_u32 s56, s56, s57
  v_readlane_b32 s57, v68, 46
  s_add_u32 s56, s56, s57
  v_readlane_b32 s57, v68, 47
  s_add_u32 s56, s56, s57
  v_readlane_b32 s57, v68, 48
  s_add_u32 s56, s56, s57
  s_cmp_lt_u32 s56, 256
  s_cbranch_scc1 Lwa_234
  s_lshr_b32 s58, s100, 2
  v_readlane_b32 s56, v68, s58
  s_add_u32 s58, s58, 32
  v_readlane_b32 s57, v68, s58
  s_add_u32 s56, s56, s57
  s_cmp_eq_u32 s58, 48
  s_cselect_b32 s56, 0, s56
  s_cmp_lt_u32 s56, 256
  s_cbranch_scc1 L_restart
  v_readlane_b32 s56, v68, 32
  s_cmp_ge_u32 s56, 128
  s_cbranch_scc1 Lwa_232
  s_branch Lwa_234
Lwa_233:
  v_readlane_b32 s56, v68, 0
  s_cmp_ge_u32 s56, 256
  s_cbranch_scc1 Lwa_232
Lwa_234:
  s_sleep 8
  s_add_u32 s55, s55, 1
  s_bitcmp1_b32 s55, 21
  s_cbranch_scc1 L_abort
  s_branch Lwa_231
Lwa_232:
  v_mov_b32 v128, 0
  v_mov_b32 v129, 0
  v_mov_b32 v130, 0
  v_mov_b32 v131, 0
  v_mov_b32 v132, 0
  v_mov_b32 v133, 0
  v_mov_b32 v134, 0
  v_mov_b32 v135, 0
  v_mov_b32 v136, 0
  v_mov_b32 v137, 0
  v_mov_b32 v138, 0
  v_mov_b32 v139, 0
  v_mov_b32 v152, 0x3f803f80
  v_mov_b32 v153, 0x3f803f80
  v_mov_b32 v154, 0x3f803f80
  v_mov_b32 v155, 0x3f803f80
  s_lshl_b32 s56, s50, 10
  s_add_u32 s56, s56, 131072
  v_add_u32 v156, s56, v1
  v_xor_b32 v157, 1024, v156
  s_lshr_b32 s61, s52, 4
  s_lshl_b32 s61, s61, 5
  s_add_u32 s62, s61, 32
  s_lshl_b32 s56, s50, 3
  s_add_u32 s56, s56, 0
  s_and_b32 s57, s56, 15
  v_xor_b32 v126, s57, v0
  s_lshl_b32 s56, s56, 11
  v_lshl_add_u32 v8, v126, 4, s56
  s_lshl_b32 s56, s50, 3
  s_add_u32 s56, s56, 1
  s_and_b32 s57, s56, 15
  v_xor_b32 v126, s57, v0
  s_lshl_b32 s56, s56, 11
  v_lshl_add_u32 v9, v126, 4, s56
  s_lshl_b32 s56, s50, 3
  s_add_u32 s56, s56, 2
  s_and_b32 s57, s56, 15
  v_xor_b32 v126, s57, v0
  s_lshl_b32 s56, s56, 11
  v_lshl_add_u32 v10, v126, 4, s56
  s_lshl_b32 s56, s50, 3
  s_add_u32 s56, s56, 3
  s_and_b32 s57, s56, 15
  v_xor_b32 v126, s57, v0
  s_lshl_b32 s56, s56, 11
  v_lshl_add_u32 v11, v126, 4, s56
  s_lshl_b32 s56, s50, 3
  s_add_u32 s56, s56, 4
  s_and_b32 s57, s56, 15
  v_xor_b32 v126, s57, v0
  s_lshl_b32 s56, s56, 11
  v_lshl_add_u32 v12, v126, 4, s56
  s_lshl_b32 s56, s50, 3
  s_add_u32 s56, s56, 5
  s_and_b32 s57, s56, 15
  v_xor_b32 v126, s57, v0
  s_lshl_b32 s56, s56, 11
  v_lshl_add_u32 v13, v126, 4, s56
  s_lshl_b32 s56, s50, 3
  s_add_u32 s56, s56, 6
  s_and_b32 s57, s56, 15
  v_xor_b32 v126, s57, v0
  s_lshl_b32 s56, s56, 11
  v_lshl_add_u32 v14, v126, 4, s56
  s_lshl_b32 s56, s50, 3
  s_add_u32 s56, s56, 7
  s_and_b32 s57, s56, 15
  v_xor_b32 v126, s57, v0
  s_lshl_b32 s56, s56, 11
  v_lshl_add_u32 v15, v126, 4, s56
  v_lshrrev_b32 v126, 4, v0
  v_add_u32 v126, 0, v126
  v_and_b32 v127, 15, v0
  v_xor_b32 v126, v126, v127
  v_lshlrev_b32 v126, 4, v126
  v_lshl_add_u32 v16, v127, 11, v126
  v_lshrrev_b32 v126, 4, v0
  v_add_u32 v126, 4, v126
  v_and_b32 v127, 15, v0
  v_xor_b32 v126, v126, v127
  v_lshlrev_b32 v126, 4, v126
  v_lshl_add_u32 v17, v127, 11, v126
  v_lshrrev_b32 v126, 4, v0
  v_add_u32 v126, 8, v126
  v_and_b32 v127, 15, v0
  v_xor_b32 v126, v126, v127
  v_lshlrev_b32 v126, 4, v126
  v_lshl_add_u32 v18, v127, 11, v126
  v_lshrrev_b32 v126, 4, v0
  v_add_u32 v126, 12, v126
  v_and_b32 v127, 15, v0
  v_xor_b32 v126, v126, v127
  v_lshlrev_b32 v126, 4, v126
  v_lshl_add_u32 v19, v127, 11, v126
  s_and_b32 s56, s52, 15
  s_lshl_b32 s56, s56, 2
  s_add_u32 s56, s56, s50
  s_mul_i32 s56, s56, 1024
  v_lshl_add_u32 v5, v0, 6, s56
  v_cmp_gt_u32 vcc, 16, v0
  v_mov_b32 v7, 0x80000000
  s_nop 0
  v_cndmask_b32 v5, v7, v5, vcc
  s_add_u32 s70, s61, 0
  s_sub_u32 s56, s62, 1
  s_min_u32 s70, s70, s56
  s_lshl_b32 s70, s70, 16
  buffer_load_dword v6, v5, s[12:15], s70 offen
  s_add_u32 s70, s61, 1
  s_sub_u32 s56, s62, 1
  s_min_u32 s70, s70, s56
  s_lshl_b32 s70, s70, 16
  buffer_load_dword v6, v5, s[12:15], s70 offen
  s_add_u32 s70, s61, 2
  s_sub_u32 s56, s62, 1
  s_min_u32 s70, s70, s56
  s_lshl_b32 s70, s70, 16
  buffer_load_dword v6, v5, s[12:15], s70 offen
  s_lshl_b32 s65, s50, 14
  s_add_u32 s63, s61, 0
  s_sub_u32 s56, s62, 1
  s_min_u32 s63, s63, s56
  s_lshl_b32 s63, s63, 16
  s_add_u32 m0, s65, 0
  s_nop 0
  buffer_load_dwordx4 v8, s[12:15], s63 offen lds
  buffer_load_dwordx4 v8, s[12:15], s63 offen offset:1024 lds
  s_add_u32 m0, s65, 2048
  s_nop 0
  buffer_load_dwordx4 v9, s[12:15], s63 offen lds
  buffer_load_dwordx4 v9, s[12:15], s63 offen offset:1024 lds
  s_add_u32 m0, s65, 4096
  s_nop 0
  buffer_load_dwordx4 v10, s[12:15], s63 offen lds
  buffer_load_dwordx4 v10, s[12:15], s63 offen offset:1024 lds
  s_add_u32 m0, s65, 6144
  s_nop 0
  buffer_load_dwordx4 v11, s[12:15], s63 offen lds
  buffer_load_dwordx4 v11, s[12:15], s63 offen offset:1024 lds
  s_add_u32 m0, s65, 8192
  s_nop 0
  buffer_load_dwordx4 v12, s[12:15], s63 offen lds
  buffer_load_dwordx4 v12, s[12:15], s63 offen offset:1024 lds
  s_add_u32 m0, s65, 10240
  s_nop 0
  buffer_load_dwordx4 v13, s[12:15], s63 offen lds
  buffer_load_dwordx4 v13, s[12:15], s63 offen offset:1024 lds
  s_add_u32 m0, s65, 12288
  s_nop 0
  buffer_load_dwordx4 v14, s[12:15], s63 offen lds
  buffer_load_dwordx4 v14, s[12:15], s63 offen offset:1024 lds
  s_add_u32 m0, s65, 14336
  s_nop 0
  buffer_load_dwordx4 v15, s[12:15], s63 offen lds
  buffer_load_dwordx4 v15, s[12:15], s63 offen offset:1024 lds
  s_waitcnt vmcnt(0)
L_b1:
  s_waitcnt vmcnt(1)
  s_barrier
  ds_read_b128 v[36:39], v16 offset:0
  ds_read_b128 v[40:43], v16 offset:32768
  ds_read_b128 v[44:47], v17 offset:0
  ds_read_b128 v[48:51], v17 offset:32768
  ds_read_b128 v[52:55], v18 offset:0
  ds_read_b128 v[56:59], v18 offset:32768
  s_xor_b32 s65, s65, 0x10000
  s_add_u32 s63, s61, 1
  s_sub_u32 s56, s62, 1
  s_min_u32 s63, s63, s56
  s_lshl_b32 s63, s63, 16
  s_add_u32 s70, s61, 3
  s_sub_u32 s56, s62, 1
  s_min_u32 s70, s70, s56
  s_lshl_b32 s70, s70, 16
  s_waitcnt lgkmcnt(4)
  v_mfma_f32_16x16x32_bf16 v[20:23], v[36:39], a[0:3], 0
  ds_read_b128 v[60:63], v19 offset:0
  v_mfma_f32_16x16x32_bf16 v[24:27], v[36:39], a[128:131], 0
  ds_read_b128 v[64:67], v19 offset:32768
  s_add_u32 m0, s65, 0
  v_mfma_f32_16x16x32_bf16 v[28:31], v[40:43], a[0:3], 0
  buffer_load_dwordx4 v8, s[12:15], s63 offen lds
  v_mfma_f32_16x16x32_bf16 v[32:35], v[40:43], a[128:131], 0
  s_waitcnt lgkmcnt(4)
  v_mfma_f32_16x16x32_bf16 v[20:23], v[44:47], a[4:7], v[20:23]
  ds_read_b128 v[36:39], v16 offset:256
  v_mfma_f32_16x16x32_bf16 v[24:27], v[44:47], a[132:135], v[24:27]
  ds_read_b128 v[40:43], v16 offset:33024
  v_mfma_f32_16x16x32_bf16 v[28:31], v[48:51], a[4:7], v[28:31]
  buffer_load_dwordx4 v8, s[12:15], s63 offen offset:1024 lds
  v_mfma_f32_16x16x32_bf16 v[32:35], v[48:51], a[132:135], v[32:35]
  s_waitcnt lgkmcnt(4)
  v_mfma_f32_16x16x32_bf16 v[20:23], v[52:55], a[8:11], v[20:23]
  ds_read_b128 v[44:47], v17 offset:256
  v_mfma_f32_16x16x32_bf16 v[24:27], v[52:55], a[136:139], v[24:27]
  ds_read_b128 v[48:51], v17 offset:33024
  s_add_u32 m0, s65, 2048
  v_mfma_f32_16x16x32_bf16 v[28:31], v[56:59], a[8:11], v[28:31]
  buffer_load_dwordx4 v9, s[12:15], s63 offen lds
  v_mfma_f32_16x16x32_bf16 v[32:35], v[56:59], a[136:139], v[32:35]
  s_waitcnt lgkmcnt(4)
  v_mfma_f32_16x16x32_bf16 v[20:23], v[60:63], a[12:15], v[20:23]
  ds_read_b128 v[52:55], v18 offset:256
  v_mfma_f32_16x16x32_bf16 v[24:27], v[60:63], a[140:143], v[24:27]
  ds_read_b128 v[56:59], v18 offset:33024
  v_mfma_f32_16x16x32_bf16 v[28:31], v[64:67], a[12:15], v[28:31]
  buffer_load_dwordx4 v9, s[12:15], s63 offen offset:1024 lds
  v_mfma_f32_16x16x32_bf16 v[32:35], v[64:67], a[140:143], v[32:35]
  s_waitcnt lgkmcnt(4)
  v_mfma_f32_16x16x32_bf16 v[20:23], v[36:39], a[16:19], v[20:23]
  ds_read_b128 v[60:63], v19 offset:256
  v_mfma_f32_16x16x32_bf16 v[24:27], v[36:39], a[144:147], v[24:27]
  ds_read_b128 v[64:67], v19 offset:33024
  s_add_u32 m0, s65, 4096
  v_mfma_f32_16x16x32_bf16 v[28:31], v[40:43], a[16:19], v[28:31]
  buffer_load_dwordx4 v10, s[12:15], s63 offen lds
  v_mfma_f32_16x16x32_bf16 v[32:35], v[40:43], a[144:147], v[32:35]
  s_waitcnt lgkmcnt(4)
  v_mfma_f32_16x16x32_bf16 v[20:23], v[44:47], a[20:23], v[20:23]
  ds_read_b128 v[36:39], v16 offset:512
  v_mfma_f32_16x16x32_bf16 v[24:27], v[44:47], a[148:151], v[24:27]
  ds_read_b128 v[40:43], v16 offset:33280
  v_mfma_f32_16x16x32_bf16 v[28:31], v[48:51], a[20:23], v[28:31]
  buffer_load_dwordx4 v10, s[12:15], s63 offen offset:1024 lds
  v_mfma_f32_16x16x32_bf16 v[32:35], v[48:51], a[148:151], v[32:35]
  s_waitcnt lgkmcnt(4)
  v_mfma_f32_16x16x32_bf16 v[20:23], v[52:55], a[24:27], v[20:23]
  ds_read_b128 v[44:47], v17 offset:512
  v_mfma_f32_16x16x32_bf16 v[24:27], v[52:55], a[152:155], v[24:27]
  ds_read_b128 v[48:51], v17 offset:33280
  s_add_u32 m0, s65, 6144
  v_mfma_f32_16x16x32_bf16 v[28:31], v[56:59], a[24:27], v[28:31]
  buffer_load_dwordx4 v11, s[12:15], s63 offen lds
  v_mfma_f32_16x16x32_bf16 v[32:35], v[56:59], a[152:155], v[32:35]
  s_waitcnt lgkmcnt(4)
  v_mfma_f32_16x16x32_bf16 v[20:23], v[60:63], a[28:31], v[20:23]
  ds_read_b128 v[52:55], v18 offset:512
  v_mfma_f32_16x16x32_bf16 v[24:27], v[60:63], a[156:159], v[24:27]
  ds_read_b128 v[56:59], v18 offset:33280
  v_mfma_f32_16x16x32_bf16 v[28:31], v[64:67], a[28:31], v[28:31]
  buffer_load_dwordx4 v11, s[12:15], s63 offen offset:1024 lds
  v_mfma_f32_16x16x32_bf16 v[32:35], v[64:67], a[156:159], v[32:35]
  s_waitcnt lgkmcnt(4)
  v_mfma_f32_16x16x32_bf16 v[20:23], v[36:39], a[32:35], v[20:23]
  ds_read_b128 v[60:63], v19 offset:512
  v_mfma_f32_16x16x32_bf16 v[24:27], v[36:39], a[160:163], v[24:27]
  ds_read_b128 v[64:67], v19 offset:33280
  s_add_u32 m0, s65, 8192
  v_mfma_f32_16x16x32_bf16 v[28:31], v[40:43], a[32:35], v[28:31]
  buffer_load_dwordx4 v12, s[12:15], s63 offen lds
  v_mfma_f32_16x16x32_bf16 v[32:35], v[40:43], a[160:163], v[32:35]
  s_waitcnt lgkmcnt(4)
  v_mfma_f32_16x16x32_bf16 v[20:23], v[44:47], a[36:39], v[20:23]
  ds_read_b128 v[36:39], v16 offset:768
  v_mfma_f32_16x16x32_bf16 v[24:27], v[44:47], a[164:167], v[24:27]
  ds_read_b128 v[40:43], v16 offset:33536
  v_mfma_f32_16x16x32_bf16 v[28:31], v[48:51], a[36:39], v[28:31]
  buffer_load_dwordx4 v12, s[12:15], s63 offen offset:1024 lds
  v_mfma_f32_16x16x32_bf16 v[32:35], v[48:51], a[164:167], v[32:35]
  s_waitcnt lgkmcnt(4)
  v_mfma_f32_16x16x32_bf16 v[20:23], v[52:55], a[40:43], v[20:23]
  ds_read_b128 v[44:47], v17 offset:768
  v_mfma_f32_16x16x32_bf16 v[24:27], v[52:55], a[168:171], v[24:27]
  ds_read_b128 v[48:51], v17 offset:33536
  s_add_u32 m0, s65, 10240
  v_mfma_f32_16x16x32_bf16 v[28:31], v[56:59], a[40:43], v[28:31]
  buffer_load_dwordx4 v13, s[12:15], s63 offen lds
  v_mfma_f32_16x16x32_bf16 v[32:35], v[56:59], a[168:171], v[32:35]
  s_waitcnt lgkmcnt(4)
  v_mfma_f32_16x16x32_bf16 v[20:23], v[60:63], a[44:47], v[20:23]
  ds_read_b128 v[52:55], v18 offset:768
  v_mfma_f32_16x16x32_bf16 v[24:27], v[60:63], a[172:175], v[24:27]
  ds_read_b128 v[56:59], v18 offset:33536
  v_mfma_f32_16x16x32_bf16 v[28:31], v[64:67], a[44:47], v[28:31]
  buffer_load_dwordx4 v13, s[12:15], s63 offen offset:1024 lds
  v_mfma_f32_16x16x32_bf16 v[32:35], v[64:67], a[172:175], v[32:35]
  s_waitcnt lgkmcnt(4)
  v_mfma_f32_16x16x32_bf16 v[20:23], v[36:39], a[48:51], v[20:23]
  ds_read_b128 v[60:63], v19 offset:768
  v_mfma_f32_16x16x32_bf16 v[24:27], v[36:39], a[176:179], v[24:27]
  ds_read_b128 v[64:67], v19 offset:33536
  s_add_u32 m0, s65, 12288
  v_mfma_f32_16x16x32_bf16 v[28:31], v[40:43], a[48:51], v[28:31]
  buffer_load_dwordx4 v14, s[12:15], s63 offen lds
  v_mfma_f32_16x16x32_bf16 v[32:35], v[40:43], a[176:179], v[32:35]
  s_waitcnt lgkmcnt(4)
  v_mfma_f32_16x16x32_bf16 v[20:23], v[44:47], a[52:55], v[20:23]
  ds_read_b128 v[36:39], v16 offset:1024
  v_mfma_f32_16x16x32_bf16 v[24:27], v[44:47], a[180:183], v[24:27]
  ds_read_b128 v[40:43], v16 offset:33792
  v_mfma_f32_16x16x32_bf16 v[28:31], v[48:51], a[52:55], v[28:31]
  buffer_load_dwordx4 v14, s[12:15], s63 offen offset:1024 lds
  v_mfma_f32_16x16x32_bf16 v[32:35], v[48:51], a[180:183], v[32:35]
  s_waitcnt lgkmcnt(4)
  v_mfma_f32_16x16x32_bf16 v[20:23], v[52:55], a[56:59], v[20:23]
  ds_read_b128 v[44:47], v17 offset:1024
  v_mfma_f32_16x16x32_bf16 v[24:27], v[52:55], a[184:187], v[24:27]
  ds_read_b128 v[48:51], v17 offset:33792
  s_add_u32 m0, s65, 14336
  v_mfma_f32_16x16x32_bf16 v[28:31], v[56:59], a[56:59], v[28:31]
  buffer_load_dwordx4 v15, s[12:15], s63 offen lds
  v_mfma_f32_16x16x32_bf16 v[32:35], v[56:59], a[184:187], v[32:35]
  s_waitcnt lgkmcnt(4)
  v_mfma_f32_16x16x32_bf16 v[20:23], v[60:63], a[60:63], v[20:23]
  ds_read_b128 v[52:55], v18 offset:1024
  v_mfma_f32_16x16x32_bf16 v[24:27], v[60:63], a[188:191], v[24:27]
  ds_read_b128 v[56:59], v18 offset:33792
  v_mfma_f32_16x16x32_bf16 v[28:31], v[64:67], a[60:63], v[28:31]
  buffer_load_dwordx4 v15, s[12:15], s63 offen offset:1024 lds
  v_mfma_f32_16x16x32_bf16 v[32:35], v[64:67], a[188:191], v[32:35]
  s_waitcnt lgkmcnt(4)
  v_mfma_f32_16x16x32_bf16 v[20:23], v[36:39], a[64:67], v[20:23]
  ds_read_b128 v[60:63], v19 offset:1024
  v_mfma_f32_16x16x32_bf16 v[24:27], v[36:39], a[192:195], v[24:27]
  ds_read_b128 v[64:67], v19 offset:33792
  v_mfma_f32_16x16x32_bf16 v[28:31], v[40:43], a[64:67], v[28:31]
  buffer_load_dword v6, v5, s[12:15], s70 offen
  v_mfma_f32_16x16x32_bf16 v[32:35], v[40:43], a[192:195], v[32:35]
  s_waitcnt lgkmcnt(4)
  v_mfma_f32_16x16x32_bf16 v[20:23], v[44:47], a[68:71], v[20:23]
  ds_read_b128 v[36:39], v16 offset:1280
  v_mfma_f32_16x16x32_bf16 v[24:27], v[44:47], a[196:199], v[24:27]
  ds_read_b128 v[40:43], v16 offset:34048
  v_mfma_f32_16x16x32_bf16 v[28:31], v[48:51], a[68:71], v[28:31]
  v_mfma_f32_16x16x32_bf16 v[32:35], v[48:51], a[196:199], v[32:35]
  s_waitcnt lgkmcnt(4)
  v_mfma_f32_16x16x32_bf16 v[20:23], v[52:55], a[72:75], v[20:23]
  ds_read_b128 v[44:47], v17 offset:1280
  v_mfma_f32_16x16x32_bf16 v[24:27], v[52:55], a[200:203], v[24:27]
  ds_read_b128 v[48:51], v17 offset:34048
  v_mfma_f32_16x16x32_bf16 v[28:31], v[56:59], a[72:75], v[28:31]
  v_mfma_f32_16x16x32_bf16 v[32:35], v[56:59], a[200:203], v[32:35]
  s_waitcnt lgkmcnt(4)
  v_mfma_f32_16x16x32_bf16 v[20:23], v[60:63], a[76:79], v[20:23]
  ds_read_b128 v[52:55], v18 offset:1280
  v_mfma_f32_16x16x32_bf16 v[24:27], v[60:63], a[204:207], v[24:27]
  ds_read_b128 v[56:59], v18 offset:34048
  v_mfma_f32_16x16x32_bf16 v[28:31], v[64:67], a[76:79], v[28:31]
  v_mfma_f32_16x16x32_bf16 v[32:35], v[64:67], a[204:207], v[32:35]
  s_waitcnt lgkmcnt(4)
  v_mfma_f32_16x16x32_bf16 v[20:23], v[36:39], a[80:83], v[20:23]
  ds_read_b128 v[60:63], v19 offset:1280
  v_mfma_f32_16x16x32_bf16 v[24:27], v[36:39], a[208:211], v[24:27]
  ds_read_b128 v[64:67], v19 offset:34048
  v_mfma_f32_16x16x32_bf16 v[28:31], v[40:43], a[80:83], v[28:31]
  v_mfma_f32_16x16x32_bf16 v[32:35], v[40:43], a[208:211], v[32:35]
  s_waitcnt lgkmcnt(4)
  v_mfma_f32_16x16x32_bf16 v[20:23], v[44:47], a[84:87], v[20:23]
  ds_read_b128 v[36:39], v16 offset:1536
  v_mfma_f32_16x16x32_bf16 v[24:27], v[44:47], a[212:215], v[24:27]
  ds_read_b128 v[40:43], v16 offset:34304
  v_mfma_f32_16x16x32_bf16 v[28:31], v[48:51], a[84:87], v[28:31]
  v_mfma_f32_16x16x32_bf16 v[32:35], v[48:51], a[212:215], v[32:35]
  s_waitcnt lgkmcnt(4)
  v_mfma_f32_16x16x32_bf16 v[20:23], v[52:55], a[88:91], v[20:23]
  ds_read_b128 v[44:47], v17 offset:1536
  v_mfma_f32_16x16x32_bf16 v[24:27], v[52:55], a[216:219], v[24:27]
  ds_read_b128 v[48:51], v17 offset:34304
  v_mfma_f32_16x16x32_bf16 v[28:31], v[56:59], a[88:91], v[28:31]
  v_mfma_f32_16x16x32_bf16 v[32:35], v[56:59], a[216:219], v[32:35]
  s_waitcnt lgkmcnt(4)
  v_mfma_f32_16x16x32_bf16 v[20:23], v[60:63], a[92:95], v[20:23]
  ds_read_b128 v[52:55], v18 offset:1536
  v_mfma_f32_16x16x32_bf16 v[24:27], v[60:63], a[220:223], v[24:27]
  ds_read_b128 v[56:59], v18 offset:34304
  v_mfma_f32_16x16x32_bf16 v[28:31], v[64:67], a[92:95], v[28:31]
  v_mfma_f32_16x16x32_bf16 v[32:35], v[64:67], a[220:223], v[32:35]
  s_waitcnt lgkmcnt(4)
  v_mfma_f32_16x16x32_bf16 v[20:23], v[36:39], a[96:99], v[20:23]
  ds_read_b128 v[60:63], v19 offset:1536
  v_mfma_f32_16x16x32_bf16 v[24:27], v[36:39], a[224:227], v[24:27]
  ds_read_b128 v[64:67], v19 offset:34304
  v_mfma_f32_16x16x32_bf16 v[28:31], v[40:43], a[96:99], v[28:31]
  v_mfma_f32_16x16x32_bf16 v[32:35], v[40:43], a[224:227], v[32:35]
  s_waitcnt lgkmcnt(4)
  v_mfma_f32_16x16x32_bf16 v[20:23], v[44:47], a[100:103], v[20:23]
  ds_read_b128 v[36:39], v16 offset:1792
  v_mfma_f32_16x16x32_bf16 v[24:27], v[44:47], a[228:231], v[24:27]
  ds_read_b128 v[40:43], v16 offset:34560
  v_mfma_f32_16x16x32_bf16 v[28:31], v[48:51], a[100:103], v[28:31]
  v_mfma_f32_16x16x32_bf16 v[32:35], v[48:51], a[228:231], v[32:35]
  s_waitcnt lgkmcnt(4)
  v_mfma_f32_16x16x32_bf16 v[20:23], v[52:55], a[104:107], v[20:23]
  ds_read_b128 v[44:47], v17 offset:1792
  v_mfma_f32_16x16x32_bf16 v[24:27], v[52:55], a[232:235], v[24:27]
  ds_read_b128 v[48:51], v17 offset:34560
  v_mfma_f32_16x16x32_bf16 v[28:31], v[56:59], a[104:107], v[28:31]
  v_mfma_f32_16x16x32_bf16 v[32:35], v[56:59], a[232:235], v[32:35]
  s_waitcnt lgkmcnt(4)
  v_mfma_f32_16x16x32_bf16 v[20:23], v[60:63], a[108:111], v[20:23]
  ds_read_b128 v[52:55], v18 offset:1792
  v_mfma_f32_16x16x32_bf16 v[24:27], v[60:63], a[236:239], v[24:27]
  ds_read_b128 v[56:59], v18 offset:34560
  v_mfma_f32_16x16x32_bf16 v[28:31], v[64:67], a[108:111], v[28:31]
  v_mfma_f32_16x16x32_bf16 v[32:35], v[64:67], a[236:239], v[32:35]
  s_waitcnt lgkmcnt(4)
  v_mfma_f32_16x16x32_bf16 v[20:23], v[36:39], a[112:115], v[20:23]
  ds_read_b128 v[60:63], v19 offset:1792
  v_mfma_f32_16x16x32_bf16 v[24:27], v[36:39], a[240:243], v[24:27]
  ds_read_b128 v[64:67], v19 offset:34560
  v_mfma_f32_16x16x32_bf16 v[28:31], v[40:43], a[112:115], v[28:31]
  v_mfma_f32_16x16x32_bf16 v[32:35], v[40:43], a[240:243], v[32:35]
  s_waitcnt lgkmcnt(4)
  v_mfma_f32_16x16x32_bf16 v[20:23], v[44:47], a[116:119], v[20:23]
  v_xor_b32 v16, 0x10000, v16
  v_mfma_f32_16x16x32_bf16 v[24:27], v[44:47], a[244:247], v[24:27]
  v_mfma_f32_16x16x32_bf16 v[28:31], v[48:51], a[116:119], v[28:31]
  v_mfma_f32_16x16x32_bf16 v[32:35], v[48:51], a[244:247], v[32:35]
  s_waitcnt lgkmcnt(2)
  v_mfma_f32_16x16x32_bf16 v[20:23], v[52:55], a[120:123], v[20:23]
  v_xor_b32 v17, 0x10000, v17
  v_mfma_f32_16x16x32_bf16 v[24:27], v[52:55], a[248:251], v[24:27]
  v_mfma_f32_16x16x32_bf16 v[28:31], v[56:59], a[120:123], v[28:31]
  v_mfma_f32_16x16x32_bf16 v[32:35], v[56:59], a[248:251], v[32:35]
  s_waitcnt lgkmcnt(0)
  v_mfma_f32_16x16x32_bf16 v[20:23], v[60:63], a[124:127], v[20:23]
  v_xor_b32 v18, 0x10000, v18
  v_mfma_f32_16x16x32_bf16 v[24:27], v[60:63], a[252:255], v[24:27]
  v_xor_b32 v19, 0x10000, v19
  v_mfma_f32_16x16x32_bf16 v[28:31], v[64:67], a[124:127], v[28:31]
  v_mfma_f32_16x16x32_bf16 v[32:35], v[64:67], a[252:255], v[32:35]
  v_mov_b32 v0, v0
  v_mov_b32 v0, v0
  v_mov_b32 v0, v0
  v_mov_b32 v0, v0
  v_mov_b32 v0, v0
  v_cvt_pk_bf16_f32 v144, v24, v25
  v_cvt_pk_bf16_f32 v145, v26, v27
  s_nop 0
  v_cvt_pk_bf16_f32 v146, v32, v33
  v_cvt_pk_bf16_f32 v147, v34, v35
  ds_write_b128 v156, v[144:147]
  v_mul_f32 v68, s66, v20
  v_mul_f32 v69, s66, v21
  v_mul_f32 v70, s66, v22
  v_mul_f32 v71, s66, v23
  v_mul_f32 v72, s66, v28
  v_mul_f32 v73, s66, v29
  v_mul_f32 v74, s66, v30
  v_mul_f32 v75, s66, v31
  v_exp_f32 v68, v68
  v_exp_f32 v69, v69
  v_exp_f32 v70, v70
  v_exp_f32 v71, v71
  v_exp_f32 v72, v72
  v_exp_f32 v73, v73
  v_exp_f32 v74, v74
  v_exp_f32 v75, v75
  v_cmp_lt_f32 vcc, 0, v20
  v_add_f32 v20, 1.0, v20
  s_nop 0
  v_cndmask_b32 v20, v68, v20, vcc
  v_add_f32 v20, s68, v20
  v_cmp_lt_f32 vcc, 0, v21
  v_add_f32 v21, 1.0, v21
  s_nop 0
  v_cndmask_b32 v21, v69, v21, vcc
  v_add_f32 v21, s68, v21
  v_cmp_lt_f32 vcc, 0, v22
  v_add_f32 v22, 1.0, v22
  s_nop 0
  v_cndmask_b32 v22, v70, v22, vcc
  v_add_f32 v22, s68, v22
  v_cmp_lt_f32 vcc, 0, v23
  v_add_f32 v23, 1.0, v23
  s_nop 0
  v_cndmask_b32 v23, v71, v23, vcc
  v_add_f32 v23, s68, v23
  v_cmp_lt_f32 vcc, 0, v28
  v_add_f32 v28, 1.0, v28
  s_nop 0
  v_cndmask_b32 v28, v72, v28, vcc
  v_add_f32 v28, s68, v28
  v_cmp_lt_f32 vcc, 0, v29
  v_add_f32 v29, 1.0, v29
  s_nop 0
  v_cndmask_b32 v29, v73, v29, vcc
  v_add_f32 v29, s68, v29
  v_cmp_lt_f32 vcc, 0, v30
  v_add_f32 v30, 1.0, v30
  s_nop 0
  v_cndmask_b32 v30, v74, v30, vcc
  v_add_f32 v30, s68, v30
  v_cmp_lt_f32 vcc, 0, v31
  v_add_f32 v31, 1.0, v31
  s_nop 0
  v_cndmask_b32 v31, v75, v31, vcc
  v_add_f32 v31, s68, v31
  v_cvt_pk_bf16_f32 v140, v20, v21
  v_cvt_pk_bf16_f32 v141, v22, v23
  v_cvt_pk_bf16_f32 v142, v28, v29
  v_cvt_pk_bf16_f32 v143, v30, v31
  s_waitcnt lgkmcnt(0)
  s_barrier
  ds_read_b128 v[148:151], v157
  v_mfma_f32_16x16x32_bf16 v[128:131], v[140:143], v[144:147], v[128:131]
  v_mfma_f32_16x16x32_bf16 v[136:139], v[140:143], v[152:155], v[136:139]
  s_waitcnt lgkmcnt(0)
  v_mfma_f32_16x16x32_bf16 v[132:135], v[140:143], v[148:151], v[132:135]
  s_add_u32 s61, s61, 1
  s_cmp_lt_u32 s61, s62
  s_cbranch_scc1 L_b1
  s_lshl_b32 s64, s52, 1
  s_lshr_b32 s56, s50, 1
  s_add_u32 s64, s64, s56
  s_mul_i32 s64, s64, 6144
  s_and_b32 s56, s50, 1
  s_lshl_b32 s57, s56, 10
  s_add_u32 s64, s64, s57
  s_add_u32 s64, s64, 0x6400000
  s_lshl_b32 s56, s56, 11
  s_add_u32 s63, s64, s56
  buffer_store_dwordx4 v[128:131], v1, s[4:7], s63 offen sc1
  s_xor_b32 s56, s56, 2048
  s_add_u32 s63, s64, s56
  buffer_store_dwordx4 v[132:135], v1, s[4:7], s63 offen sc1
  s_add_u32 s63, s64, 4096
  buffer_store_dwordx4 v[136:139], v1, s[4:7], s63 offen sc1
  s_waitcnt vmcnt(0)
  s_barrier
  s_cmp_lg_u32 s50, 0
  s_cbranch_scc1 Lsg_237
  v_mov_b32 v126, 1
  s_lshl_b32 s59, s2, 7
  s_mov_b64 exec, 1
  buffer_store_dword v126, off, s[4:7], s59 sc1
  s_mov_b64 exec, -1
Lsg_237:
  s_mov_b32 s8, s40
  s_mov_b32 s9, s41
  s_mov_b32 s10, 0x600000
  s_mov_b32 s11, 0x20000
  v_lshrrev_b32 v126, 3, v0
  v_mul_u32_u24 v2, 6144, v126
  v_and_b32 v126, 2, v126
  v_xor_b32 v126, v126, v0
  v_and_b32 v126, 7, v126
  v_lshlrev_b32 v126, 4, v126
  v_xor_b32 v3, 64, v126
  v_add_u32 v3, v3, v2
  v_add_u32 v2, v126, v2
  v_lshrrev_b32 v126, 4, v0
  v_lshlrev_b32 v126, 3, v126
  v_bfe_u32 v127, v0, 2, 2
  v_add_u32 v126, v126, v127
  v_lshrrev_b32 v127, 5, v0
  v_lshlrev_b32 v127, 1, v127
  v_bfe_u32 v4, v0, 3, 1
  v_or_b32 v127, v127, v4
  v_lshlrev_b32 v126, 7, v126
  s_and_b32 s56, s50, 1
  s_lshl_b32 s56, s56, 1
  v_xor_b32 v127, s56, v127
  v_and_b32 v4, 3, v0
  v_lshl_add_u32 v126, v4, 3, v126
  v_lshl_add_u32 v126, v127, 5, v126
  v_xor_b32 v68, 0, v126
  v_add_u32 v72, 0x10000, v68
  v_xor_b32 v69, 32, v126
  v_add_u32 v73, 0x10000, v69
  v_xor_b32 v70, 64, v126
  v_add_u32 v74, 0x10000, v70
  v_xor_b32 v71, 96, v126
  v_add_u32 v75, 0x10000, v71
  s_and_b32 s60, s52, 7
  s_lshl_b32 s60, s60, 8
  s_mul_i32 s56, s50, 1572864
  s_add_u32 s60, s60, s56
  s_lshl_b32 s56, s50, 15
  s_add_u32 s56, s56, 0
  s_sub_u32 s57, s60, 49152
  s_mov_b32 s58, 4
Ldma_238:
  s_mov_b32 m0, s56
  s_add_u32 s57, s57, 49152
  buffer_load_dwordx4 v2, s[8:11], s57 offen nt lds
  s_add_u32 s56, s56, 1024
  s_mov_b32 m0, s56
  s_add_u32 s57, s57, 49152
  buffer_load_dwordx4 v2, s[8:11], s57 offen nt lds
  s_add_u32 s56, s56, 1024
  s_mov_b32 m0, s56
  s_add_u32 s57, s57, 49152
  buffer_load_dwordx4 v3, s[8:11], s57 offen nt lds
  s_add_u32 s56, s56, 1024
  s_mov_b32 m0, s56
  s_add_u32 s57, s57, 49152
  buffer_load_dwordx4 v3, s[8:11], s57 offen nt lds
  s_add_u32 s56, s56, 1024
  s_sub_u32 s58, s58, 1
  s_cmp_lg_u32 s58, 0
  s_cbranch_scc1 Ldma_238
  s_and_b32 s60, s52, 7
  s_lshl_b32 s60, s60, 8
  s_mul_i32 s56, s50, 1572864
  s_add_u32 s60, s60, s56
  s_add_u32 s60, s60, 786432
  s_lshl_b32 s56, s50, 15
  s_add_u32 s56, s56, 16384
  s_sub_u32 s57, s60, 49152
  s_mov_b32 s58, 4
Ldma_239:
  s_mov_b32 m0, s56
  s_add_u32 s57, s57, 49152
  buffer_load_dwordx4 v2, s[8:11], s57 offen nt lds
  s_add_u32 s56, s56, 1024
  s_mov_b32 m0, s56
  s_add_u32 s57, s57, 49152
  buffer_load_dwordx4 v2, s[8:11], s57 offen nt lds
  s_add_u32 s56, s56, 1024
  s_mov_b32 m0, s56
  s_add_u32 s57, s57, 49152
  buffer_load_dwordx4 v3, s[8:11], s57 offen nt lds
  s_add_u32 s56, s56, 1024
  s_mov_b32 m0, s56
  s_add_u32 s57, s57, 49152
  buffer_load_dwordx4 v3, s[8:11], s57 offen nt lds
  s_add_u32 s56, s56, 1024
  s_sub_u32 s58, s58, 1
  s_cmp_lg_u32 s58, 0
  s_cbranch_scc1 Ldma_239
  s_waitcnt vmcnt(16)
  s_barrier
  s_lshr_b32 s56, s50, 1
  s_cmp_lg_u32 s56, 0
  s_cbranch_scc1 Lro_240
  ds_read_b64_tr_b16 a[0:1], v68 offset:0
  ds_read_b64_tr_b16 a[2:3], v68 offset:512
  ds_read_b64_tr_b16 a[4:5], v68 offset:4096
  ds_read_b64_tr_b16 a[6:7], v68 offset:4608
  ds_read_b64_tr_b16 a[8:9], v68 offset:8192
  ds_read_b64_tr_b16 a[10:11], v68 offset:8704
  ds_read_b64_tr_b16 a[12:13], v68 offset:12288
  ds_read_b64_tr_b16 a[14:15], v68 offset:12800
  ds_read_b64_tr_b16 a[32:33], v68 offset:32768
  ds_read_b64_tr_b16 a[34:35], v68 offset:33280
  ds_read_b64_tr_b16 a[36:37], v68 offset:36864
  ds_read_b64_tr_b16 a[38:39], v68 offset:37376
  ds_read_b64_tr_b16 a[40:41], v68 offset:40960
  ds_read_b64_tr_b16 a[42:43], v68 offset:41472
  ds_read_b64_tr_b16 a[44:45], v68 offset:45056
  ds_read_b64_tr_b16 a[46:47], v68 offset:45568
  ds_read_b64_tr_b16 a[64:65], v72 offset:0
  ds_read_b64_tr_b16 a[66:67], v72 offset:512
  ds_read_b64_tr_b16 a[68:69], v72 offset:4096
  ds_read_b64_tr_b16 a[70:71], v72 offset:4608
  ds_read_b64_tr_b16 a[72:73], v72 offset:8192
  ds_read_b64_tr_b16 a[74:75], v72 offset:8704
  ds_read_b64_tr_b16 a[76:77], v72 offset:12288
  ds_read_b64_tr_b16 a[78:79], v72 offset:12800
  ds_read_b64_tr_b16 a[96:97], v72 offset:32768
  ds_read_b64_tr_b16 a[98:99], v72 offset:33280
  ds_read_b64_tr_b16 a[100:101], v72 offset:36864
  ds_read_b64_tr_b16 a[102:103], v72 offset:37376
  ds_read_b64_tr_b16 a[104:105], v72 offset:40960
  ds_read_b64_tr_b16 a[106:107], v72 offset:41472
  ds_read_b64_tr_b16 a[108:109], v72 offset:45056
  ds_read_b64_tr_b16 a[110:111], v72 offset:45568
  ds_read_b64_tr_b16 a[128:129], v69 offset:0
  ds_read_b64_tr_b16 a[130:131], v69 offset:512
  ds_read_b64_tr_b16 a[132:133], v69 offset:4096
  ds_read_b64_tr_b16 a[134:135], v69 offset:4608
  ds_read_b64_tr_b16 a[136:137], v69 offset:8192
  ds_read_b64_tr_b16 a[138:139], v69 offset:8704
  ds_read_b64_tr_b16 a[140:141], v69 offset:12288
  ds_read_b64_tr_b16 a[142:143], v69 offset:12800
  ds_read_b64_tr_b16 a[160:161], v69 offset:32768
  ds_read_b64_tr_b16 a[162:163], v69 offset:33280
  ds_read_b64_tr_b16 a[164:165], v69 offset:36864
  ds_read_b64_tr_b16 a[166:167], v69 offset:37376
  ds_read_b64_tr_b16 a[168:169], v69 offset:40960
  ds_read_b64_tr_b16 a[170:171], v69 offset:41472
  ds_read_b64_tr_b16 a[172:173], v69 offset:45056
  ds_read_b64_tr_b16 a[174:175], v69 offset:45568
  ds_read_b64_tr_b16 a[192:193], v73 offset:0
  ds_read_b64_tr_b16 a[194:195], v73 offset:512
  ds_read_b64_tr_b16 a[196:197], v73 offset:4096
  ds_read_b64_tr_b16 a[198:199], v73 offset:4608
  ds_read_b64_tr_b16 a[200:201], v73 offset:8192
  ds_read_b64_tr_b16 a[202:203], v73 offset:8704
  ds_read_b64_tr_b16 a[204:205], v73 offset:12288
  ds_read_b64_tr_b16 a[206:207], v73 offset:12800
  ds_read_b64_tr_b16 a[224:225], v73 offset:32768
  ds_read_b64_tr_b16 a[226:227], v73 offset:33280
  ds_read_b64_tr_b16 a[228:229], v73 offset:36864
  ds_read_b64_tr_b16 a[230:231], v73 offset:37376
  ds_read_b64_tr_b16 a[232:233], v73 offset:40960
  ds_read_b64_tr_b16 a[234:235], v73 offset:41472
  ds_read_b64_tr_b16 a[236:237], v73 offset:45056
  ds_read_b64_tr_b16 a[238:239], v73 offset:45568
Lro_240:
  s_waitcnt lgkmcnt(0)
  s_barrier
  s_and_b32 s60, s52, 7
  s_lshl_b32 s60, s60, 8
  s_add_u32 s60, s60, 128
  s_mul_i32 s56, s50, 1572864
  s_add_u32 s60, s60, s56
  s_lshl_b32 s56, s50, 15
  s_add_u32 s56, s56, 0
  s_sub_u32 s57, s60, 49152
  s_mov_b32 s58, 4
Ldma_241:
  s_mov_b32 m0, s56
  s_add_u32 s57, s57, 49152
  buffer_load_dwordx4 v2, s[8:11], s57 offen nt lds
  s_add_u32 s56, s56, 1024
  s_mov_b32 m0, s56
  s_add_u32 s57, s57, 49152
  buffer_load_dwordx4 v2, s[8:11], s57 offen nt lds
  s_add_u32 s56, s56, 1024
  s_mov_b32 m0, s56
  s_add_u32 s57, s57, 49152
  buffer_load_dwordx4 v3, s[8:11], s57 offen nt lds
  s_add_u32 s56, s56, 1024
  s_mov_b32 m0, s56
  s_add_u32 s57, s57, 49152
  buffer_load_dwordx4 v3, s[8:11], s57 offen nt lds
  s_add_u32 s56, s56, 1024
  s_sub_u32 s58, s58, 1
  s_cmp_lg_u32 s58, 0
  s_cbranch_scc1 Ldma_241
  s_waitcnt vmcnt(16)
  s_barrier
  s_lshr_b32 s56, s50, 1
  s_cmp_lg_u32 s56, 0
  s_cbranch_scc1 Lro_242
  ds_read_b64_tr_b16 a[16:17], v68 offset:16384
  ds_read_b64_tr_b16 a[18:19], v68 offset:16896
  ds_read_b64_tr_b16 a[20:21], v68 offset:20480
  ds_read_b64_tr_b16 a[22:23], v68 offset:20992
  ds_read_b64_tr_b16 a[24:25], v68 offset:24576
  ds_read_b64_tr_b16 a[26:27], v68 offset:25088
  ds_read_b64_tr_b16 a[28:29], v68 offset:28672
  ds_read_b64_tr_b16 a[30:31], v68 offset:29184
  ds_read_b64_tr_b16 a[48:49], v68 offset:49152
  ds_read_b64_tr_b16 a[50:51], v68 offset:49664
  ds_read_b64_tr_b16 a[52:53], v68 offset:53248
  ds_read_b64_tr_b16 a[54:55], v68 offset:53760
  ds_read_b64_tr_b16 a[56:57], v68 offset:57344
  ds_read_b64_tr_b16 a[58:59], v68 offset:57856
  ds_read_b64_tr_b16 a[60:61], v68 offset:61440
  ds_read_b64_tr_b16 a[62:63], v68 offset:61952
  ds_read_b64_tr_b16 a[80:81], v72 offset:16384
  ds_read_b64_tr_b16 a[82:83], v72 offset:16896
  ds_read_b64_tr_b16 a[84:85], v72 offset:20480
  ds_read_b64_tr_b16 a[86:87], v72 offset:20992
  ds_read_b64_tr_b16 a[88:89], v72 offset:24576
  ds_read_b64_tr_b16 a[90:91], v72 offset:25088
  ds_read_b64_tr_b16 a[92:93], v72 offset:28672
  ds_read_b64_tr_b16 a[94:95], v72 offset:29184
  ds_read_b64_tr_b16 a[112:113], v72 offset:49152
  ds_read_b64_tr_b16 a[114:115], v72 offset:49664
  ds_read_b64_tr_b16 a[116:117], v72 offset:53248
  ds_read_b64_tr_b16 a[118:119], v72 offset:53760
  ds_read_b64_tr_b16 a[120:121], v72 offset:57344
  ds_read_b64_tr_b16 a[122:123], v72 offset:57856
  ds_read_b64_tr_b16 a[124:125], v72 offset:61440
  ds_read_b64_tr_b16 a[126:127], v72 offset:61952
  ds_read_b64_tr_b16 a[144:145], v69 offset:16384
  ds_read_b64_tr_b16 a[146:147], v69 offset:16896
  ds_read_b64_tr_b16 a[148:149], v69 offset:20480
  ds_read_b64_tr_b16 a[150:151], v69 offset:20992
  ds_read_b64_tr_b16 a[152:153], v69 offset:24576
  ds_read_b64_tr_b16 a[154:155], v69 offset:25088
  ds_read_b64_tr_b16 a[156:157], v69 offset:28672
  ds_read_b64_tr_b16 a[158:159], v69 offset:29184
  ds_read_b64_tr_b16 a[176:177], v69 offset:49152
  ds_read_b64_tr_b16 a[178:179], v69 offset:49664
  ds_read_b64_tr_b16 a[180:181], v69 offset:53248
  ds_read_b64_tr_b16 a[182:183], v69 offset:53760
  ds_read_b64_tr_b16 a[184:185], v69 offset:57344
  ds_read_b64_tr_b16 a[186:187], v69 offset:57856
  ds_read_b64_tr_b16 a[188:189], v69 offset:61440
  ds_read_b64_tr_b16 a[190:191], v69 offset:61952
  ds_read_b64_tr_b16 a[208:209], v73 offset:16384
  ds_read_b64_tr_b16 a[210:211], v73 offset:16896
  ds_read_b64_tr_b16 a[212:213], v73 offset:20480
  ds_read_b64_tr_b16 a[214:215], v73 offset:20992
  ds_read_b64_tr_b16 a[216:217], v73 offset:24576
  ds_read_b64_tr_b16 a[218:219], v73 offset:25088
  ds_read_b64_tr_b16 a[220:221], v73 offset:28672
  ds_read_b64_tr_b16 a[222:223], v73 offset:29184
  ds_read_b64_tr_b16 a[240:241], v73 offset:49152
  ds_read_b64_tr_b16 a[242:243], v73 offset:49664
  ds_read_b64_tr_b16 a[244:245], v73 offset:53248
  ds_read_b64_tr_b16 a[246:247], v73 offset:53760
  ds_read_b64_tr_b16 a[248:249], v73 offset:57344
  ds_read_b64_tr_b16 a[250:251], v73 offset:57856
  ds_read_b64_tr_b16 a[252:253], v73 offset:61440
  ds_read_b64_tr_b16 a[254:255], v73 offset:61952
Lro_242:
  s_waitcnt lgkmcnt(0)
  s_barrier
  s_and_b32 s60, s52, 7
  s_lshl_b32 s60, s60, 8
  s_add_u32 s60, s60, 128
  s_mul_i32 s56, s50, 1572864
  s_add_u32 s60, s60, s56
  s_add_u32 s60, s60, 786432
  s_lshl_b32 s56, s50, 15
  s_add_u32 s56, s56, 16384
  s_sub_u32 s57, s60, 49152
  s_mov_b32 s58, 4
Ldma_243:
  s_mov_b32 m0, s56
  s_add_u32 s57, s57, 49152
  buffer_load_dwordx4 v2, s[8:11], s57 offen nt lds
  s_add_u32 s56, s56, 1024
  s_mov_b32 m0, s56
  s_add_u32 s57, s57, 49152
  buffer_load_dwordx4 v2, s[8:11], s57 offen nt lds
  s_add_u32 s56, s56, 1024
  s_mov_b32 m0, s56
  s_add_u32 s57, s57, 49152
  buffer_load_dwordx4 v3, s[8:11], s57 offen nt lds
  s_add_u32 s56, s56, 1024
  s_mov_b32 m0, s56
  s_add_u32 s57, s57, 49152
  buffer_load_dwordx4 v3, s[8:11], s57 offen nt lds
  s_add_u32 s56, s56, 1024
  s_sub_u32 s58, s58, 1
  s_cmp_lg_u32 s58, 0
  s_cbranch_scc1 Ldma_243
  s_waitcnt vmcnt(16)
  s_barrier
  s_lshr_b32 s56, s50, 1
  s_cmp_lg_u32 s56, 1
  s_cbranch_scc1 Lro_244
  ds_read_b64_tr_b16 a[0:1], v68 offset:0
  ds_read_b64_tr_b16 a[2:3], v68 offset:512
  ds_read_b64_tr_b16 a[4:5], v68 offset:4096
  ds_read_b64_tr_b16 a[6:7], v68 offset:4608
  ds_read_b64_tr_b16 a[8:9], v68 offset:8192
  ds_read_b64_tr_b16 a[10:11], v68 offset:8704
  ds_read_b64_tr_b16 a[12:13], v68 offset:12288
  ds_read_b64_tr_b16 a[14:15], v68 offset:12800
  ds_read_b64_tr_b16 a[32:33], v68 offset:32768
  ds_read_b64_tr_b16 a[34:35], v68 offset:33280
  ds_read_b64_tr_b16 a[36:37], v68 offset:36864
  ds_read_b64_tr_b16 a[38:39], v68 offset:37376
  ds_read_b64_tr_b16 a[40:41], v68 offset:40960
  ds_read_b64_tr_b16 a[42:43], v68 offset:41472
  ds_read_b64_tr_b16 a[44:45], v68 offset:45056
  ds_read_b64_tr_b16 a[46:47], v68 offset:45568
  ds_read_b64_tr_b16 a[64:65], v72 offset:0
  ds_read_b64_tr_b16 a[66:67], v72 offset:512
  ds_read_b64_tr_b16 a[68:69], v72 offset:4096
  ds_read_b64_tr_b16 a[70:71], v72 offset:4608
  ds_read_b64_tr_b16 a[72:73], v72 offset:8192
  ds_read_b64_tr_b16 a[74:75], v72 offset:8704
  ds_read_b64_tr_b16 a[76:77], v72 offset:12288
  ds_read_b64_tr_b16 a[78:79], v72 offset:12800
  ds_read_b64_tr_b16 a[96:97], v72 offset:32768
  ds_read_b64_tr_b16 a[98:99], v72 offset:33280
  ds_read_b64_tr_b16 a[100:101], v72 offset:36864
  ds_read_b64_tr_b16 a[102:103], v72 offset:37376
  ds_read_b64_tr_b16 a[104:105], v72 offset:40960
  ds_read_b64_tr_b16 a[106:107], v72 offset:41472
  ds_read_b64_tr_b16 a[108:109], v72 offset:45056
  ds_read_b64_tr_b16 a[110:111], v72 offset:45568
  ds_read_b64_tr_b16 a[128:129], v69 offset:0
  ds_read_b64_tr_b16 a[130:131], v69 offset:512
  ds_read_b64_tr_b16 a[132:133], v69 offset:4096
  ds_read_b64_tr_b16 a[134:135], v69 offset:4608
  ds_read_b64_tr_b16 a[136:137], v69 offset:8192
  ds_read_b64_tr_b16 a[138:139], v69 offset:8704
  ds_read_b64_tr_b16 a[140:141], v69 offset:12288
  ds_read_b64_tr_b16 a[142:143], v69 offset:12800
  ds_read_b64_tr_b16 a[160:161], v69 offset:32768
  ds_read_b64_tr_b16 a[162:163], v69 offset:33280
  ds_read_b64_tr_b16 a[164:165], v69 offset:36864
  ds_read_b64_tr_b16 a[166:167], v69 offset:37376
  ds_read_b64_tr_b16 a[168:169], v69 offset:40960
  ds_read_b64_tr_b16 a[170:171], v69 offset:41472
  ds_read_b64_tr_b16 a[172:173], v69 offset:45056
  ds_read_b64_tr_b16 a[174:175], v69 offset:45568
  ds_read_b64_tr_b16 a[192:193], v73 offset:0
  ds_read_b64_tr_b16 a[194:195], v73 offset:512
  ds_read_b64_tr_b16 a[196:197], v73 offset:4096
  ds_read_b64_tr_b16 a[198:199], v73 offset:4608
  ds_read_b64_tr_b16 a[200:201], v73 offset:8192
  ds_read_b64_tr_b16 a[202:203], v73 offset:8704
  ds_read_b64_tr_b16 a[204:205], v73 offset:12288
  ds_read_b64_tr_b16 a[206:207], v73 offset:12800
  ds_read_b64_tr_b16 a[224:225], v73 offset:32768
  ds_read_b64_tr_b16 a[226:227], v73 offset:33280
  ds_read_b64_tr_b16 a[228:229], v73 offset:36864
  ds_read_b64_tr_b16 a[230:231], v73 offset:37376
  ds_read_b64_tr_b16 a[232:233], v73 offset:40960
  ds_read_b64_tr_b16 a[234:235], v73 offset:41472
  ds_read_b64_tr_b16 a[236:237], v73 offset:45056
  ds_read_b64_tr_b16 a[238:239], v73 offset:45568
Lro_244:
  s_waitcnt lgkmcnt(0)
  s_barrier
  s_waitcnt vmcnt(0)
  s_barrier
  s_lshr_b32 s56, s50, 1
  s_cmp_lg_u32 s56, 1
  s_cbranch_scc1 Lro_245
  ds_read_b64_tr_b16 a[16:17], v68 offset:16384
  ds_read_b64_tr_b16 a[18:19], v68 offset:16896
  ds_read_b64_tr_b16 a[20:21], v68 offset:20480
  ds_read_b64_tr_b16 a[22:23], v68 offset:20992
  ds_read_b64_tr_b16 a[24:25], v68 offset:24576
  ds_read_b64_tr_b16 a[26:27], v68 offset:25088
  ds_read_b64_tr_b16 a[28:29], v68 offset:28672
  ds_read_b64_tr_b16 a[30:31], v68 offset:29184
  ds_read_b64_tr_b16 a[48:49], v68 offset:49152
  ds_read_b64_tr_b16 a[50:51], v68 offset:49664
  ds_read_b64_tr_b16 a[52:53], v68 offset:53248
  ds_read_b64_tr_b16 a[54:55], v68 offset:53760
  ds_read_b64_tr_b16 a[56:57], v68 offset:57344
  ds_read_b64_tr_b16 a[58:59], v68 offset:57856
  ds_read_b64_tr_b16 a[60:61], v68 offset:61440
  ds_read_b64_tr_b16 a[62:63], v68 offset:61952
  ds_read_b64_tr_b16 a[80:81], v72 offset:16384
  ds_read_b64_tr_b16 a[82:83], v72 offset:16896
  ds_read_b64_tr_b16 a[84:85], v72 offset:20480
  ds_read_b64_tr_b16 a[86:87], v72 offset:20992
  ds_read_b64_tr_b16 a[88:89], v72 offset:24576
  ds_read_b64_tr_b16 a[90:91], v72 offset:25088
  ds_read_b64_tr_b16 a[92:93], v72 offset:28672
  ds_read_b64_tr_b16 a[94:95], v72 offset:29184
  ds_read_b64_tr_b16 a[112:113], v72 offset:49152
  ds_read_b64_tr_b16 a[114:115], v72 offset:49664
  ds_read_b64_tr_b16 a[116:117], v72 offset:53248
  ds_read_b64_tr_b16 a[118:119], v72 offset:53760
  ds_read_b64_tr_b16 a[120:121], v72 offset:57344
  ds_read_b64_tr_b16 a[122:123], v72 offset:57856
  ds_read_b64_tr_b16 a[124:125], v72 offset:61440
  ds_read_b64_tr_b16 a[126:127], v72 offset:61952
  ds_read_b64_tr_b16 a[144:145], v69 offset:16384
  ds_read_b64_tr_b16 a[146:147], v69 offset:16896
  ds_read_b64_tr_b16 a[148:149], v69 offset:20480
  ds_read_b64_tr_b16 a[150:151], v69 offset:20992
  ds_read_b64_tr_b16 a[152:153], v69 offset:24576
  ds_read_b64_tr_b16 a[154:155], v69 offset:25088
  ds_read_b64_tr_b16 a[156:157], v69 offset:28672
  ds_read_b64_tr_b16 a[158:159], v69 offset:29184
  ds_read_b64_tr_b16 a[176:177], v69 offset:49152
  ds_read_b64_tr_b16 a[178:179], v69 offset:49664
  ds_read_b64_tr_b16 a[180:181], v69 offset:53248
  ds_read_b64_tr_b16 a[182:183], v69 offset:53760
  ds_read_b64_tr_b16 a[184:185], v69 offset:57344
  ds_read_b64_tr_b16 a[186:187], v69 offset:57856
  ds_read_b64_tr_b16 a[188:189], v69 offset:61440
  ds_read_b64_tr_b16 a[190:191], v69 offset:61952
  ds_read_b64_tr_b16 a[208:209], v73 offset:16384
  ds_read_b64_tr_b16 a[210:211], v73 offset:16896
  ds_read_b64_tr_b16 a[212:213], v73 offset:20480
  ds_read_b64_tr_b16 a[214:215], v73 offset:20992
  ds_read_b64_tr_b16 a[216:217], v73 offset:24576
  ds_read_b64_tr_b16 a[218:219], v73 offset:25088
  ds_read_b64_tr_b16 a[220:221], v73 offset:28672
  ds_read_b64_tr_b16 a[222:223], v73 offset:29184
  ds_read_b64_tr_b16 a[240:241], v73 offset:49152
  ds_read_b64_tr_b16 a[242:243], v73 offset:49664
  ds_read_b64_tr_b16 a[244:245], v73 offset:53248
  ds_read_b64_tr_b16 a[246:247], v73 offset:53760
  ds_read_b64_tr_b16 a[248:249], v73 offset:57344
  ds_read_b64_tr_b16 a[250:251], v73 offset:57856
  ds_read_b64_tr_b16 a[252:253], v73 offset:61440
  ds_read_b64_tr_b16 a[254:255], v73 offset:61952
Lro_245:
  s_waitcnt lgkmcnt(0)
  s_barrier
  s_and_b32 s60, s52, 7
  s_lshl_b32 s60, s60, 2
  s_add_u32 s60, s60, s50
  s_lshr_b32 s56, s60, 1
  s_lshl_b32 s56, s56, 10
  s_add_u32 s56, s56, 640
  v_and_b32 v126, 1, v0
  v_lshl_add_u32 v158, v126, 14, s56
Lwf_246:
  buffer_load_dword v126, v158, s[4:7], 0 offen sc1
  s_waitcnt vmcnt(0)
  v_cmp_gt_u32 vcc, 1, v126
  s_cbranch_vccz Lwf_247
  s_sleep 2
  s_add_u32 s55, s55, 1
  s_bitcmp1_b32 s55, 21
  s_cbranch_scc1 L_abort
  s_branch Lwf_246
Lwf_247:
  s_mul_i32 s63, s60, 6144
  s_add_u32 s63, s63, 0x6400000
  buffer_load_dwordx4 v[160:163], v1, s[4:7], s63 offen offset:0 sc1
  buffer_load_dwordx4 v[164:167], v1, s[4:7], s63 offen offset:1024 sc1
  buffer_load_dwordx4 v[168:171], v1, s[4:7], s63 offen offset:2048 sc1
  buffer_load_dwordx4 v[172:175], v1, s[4:7], s63 offen offset:3072 sc1
  s_add_u32 s63, s63, 4096
  buffer_load_dwordx4 v[176:179], v1, s[4:7], s63 offen offset:0 sc1
  buffer_load_dwordx4 v[180:183], v1, s[4:7], s63 offen offset:1024 sc1
  s_add_u32 s63, s63, 192512
  buffer_load_dwordx4 v[184:187], v1, s[4:7], s63 offen offset:0 sc1
  buffer_load_dwordx4 v[188:191], v1, s[4:7], s63 offen offset:1024 sc1
  buffer_load_dwordx4 v[192:195], v1, s[4:7], s63 offen offset:2048 sc1
  buffer_load_dwordx4 v[196:199], v1, s[4:7], s63 offen offset:3072 sc1
  s_add_u32 s63, s63, 4096
  buffer_load_dwordx4 v[200:203], v1, s[4:7], s63 offen offset:0 sc1
  buffer_load_dwordx4 v[204:207], v1, s[4:7], s63 offen offset:1024 sc1
  s_waitcnt vmcnt(0)
  v_add_f32 v160, v160, v184
  v_add_f32 v161, v161, v185
  v_add_f32 v162, v162, v186
  v_add_f32 v163, v163, v187
  v_add_f32 v164, v164, v188
  v_add_f32 v165, v165, v189
  v_add_f32 v166, v166, v190
  v_add_f32 v167, v167, v191
  v_add_f32 v168, v168, v192
  v_add_f32 v169, v169, v193
  v_add_f32 v170, v170, v194
  v_add_f32 v171, v171, v195
  v_add_f32 v172, v172, v196
  v_add_f32 v173, v173, v197
  v_add_f32 v174, v174, v198
  v_add_f32 v175, v175, v199
  v_add_f32 v176, v176, v200
  v_add_f32 v177, v177, v201
  v_add_f32 v178, v178, v202
  v_add_f32 v179, v179, v203
  v_add_f32 v180, v180, v204
  v_add_f32 v181, v181, v205
  v_add_f32 v182, v182, v206
  v_add_f32 v183, v183, v207
  v_cvt_pk_bf16_f32 v128, v160, v161
  v_cvt_pk_bf16_f32 v129, v162, v163
  v_cvt_pk_bf16_f32 v130, v164, v165
  v_cvt_pk_bf16_f32 v131, v166, v167
  v_cvt_pk_bf16_f32 v132, v168, v169
  v_cvt_pk_bf16_f32 v133, v170, v171
  v_cvt_pk_bf16_f32 v134, v172, v173
  v_cvt_pk_bf16_f32 v135, v174, v175
  v_cvt_pk_bf16_f32 v136, v176, v177
  v_cvt_pk_bf16_f32 v137, v178, v179
  v_cvt_pk_bf16_f32 v138, v180, v181
  v_cvt_pk_bf16_f32 v139, v182, v183
  s_lshr_b32 s61, s52, 3
  s_lshl_b32 s61, s61, 4
  s_add_u32 s62, s61, 16
  s_mov_b32 s71, 0
  s_lshl_b32 s56, s50, 3
  s_add_u32 s56, s56, 0
  s_and_b32 s57, s56, 15
  v_xor_b32 v126, s57, v0
  s_lshl_b32 s56, s56, 11
  v_lshl_add_u32 v8, v126, 4, s56
  s_lshl_b32 s56, s50, 3
  s_add_u32 s56, s56, 1
  s_and_b32 s57, s56, 15
  v_xor_b32 v126, s57, v0
  s_lshl_b32 s56, s56, 11
  v_lshl_add_u32 v9, v126, 4, s56
  s_lshl_b32 s56, s50, 3
  s_add_u32 s56, s56, 2
  s_and_b32 s57, s56, 15
  v_xor_b32 v126, s57, v0
  s_lshl_b32 s56, s56, 11
  v_lshl_add_u32 v10, v126, 4, s56
  s_lshl_b32 s56, s50, 3
  s_add_u32 s56, s56, 3
  s_and_b32 s57, s56, 15
  v_xor_b32 v126, s57, v0
  s_lshl_b32 s56, s56, 11
  v_lshl_add_u32 v11, v126, 4, s56
  s_lshl_b32 s56, s50, 3
  s_add_u32 s56, s56, 4
  s_and_b32 s57, s56, 15
  v_xor_b32 v126, s57, v0
  s_lshl_b32 s56, s56, 11
  v_lshl_add_u32 v12, v126, 4, s56
  s_lshl_b32 s56, s50, 3
  s_add_u32 s56, s56, 5
  s_and_b32 s57, s56, 15
  v_xor_b32 v126, s57, v0
  s_lshl_b32 s56, s56, 11
  v_lshl_add_u32 v13, v126, 4, s56
  s_lshl_b32 s56, s50, 3
  s_add_u32 s56, s56, 6
  s_and_b32 s57, s56, 15
  v_xor_b32 v126, s57, v0
  s_lshl_b32 s56, s56, 11
  v_lshl_add_u32 v14, v126, 4, s56
  s_lshl_b32 s56, s50, 3
  s_add_u32 s56, s56, 7
  s_and_b32 s57, s56, 15
  v_xor_b32 v126, s57, v0
  s_lshl_b32 s56, s56, 11
  v_lshl_add_u32 v15, v126, 4, s56
  v_lshrrev_b32 v126, 4, v0
  v_add_u32 v126, 0, v126
  v_and_b32 v127, 15, v0
  v_xor_b32 v126, v126, v127
  v_lshlrev_b32 v126, 4, v126
  v_lshl_add_u32 v16, v127, 11, v126
  v_lshrrev_b32 v126, 4, v0
  v_add_u32 v126, 4, v126
  v_and_b32 v127, 15, v0
  v_xor_b32 v126, v126, v127
  v_lshlrev_b32 v126, 4, v126
  v_lshl_add_u32 v17, v127, 11, v126
  v_lshrrev_b32 v126, 4, v0
  v_add_u32 v126, 8, v126
  v_and_b32 v127, 15, v0
  v_xor_b32 v126, v126, v127
  v_lshlrev_b32 v126, 4, v126
  v_lshl_add_u32 v18, v127, 11, v126
  v_lshrrev_b32 v126, 4, v0
  v_add_u32 v126, 12, v126
  v_and_b32 v127, 15, v0
  v_xor_b32 v126, v126, v127
  v_lshlrev_b32 v126, 4, v126
  v_lshl_add_u32 v19, v127, 11, v126
  s_and_b32 s56, s52, 7
  s_lshl_b32 s56, s56, 2
  s_add_u32 s56, s56, s50
  s_mul_i32 s56, s56, 2048
  v_lshl_add_u32 v5, v0, 6, s56
  v_cmp_gt_u32 vcc, 32, v0
  v_mov_b32 v7, 0x80000000
  s_nop 0
  v_cndmask_b32 v5, v7, v5, vcc
  s_add_u32 s70, s61, 0
  s_sub_u32 s56, s62, 1
  s_min_u32 s70, s70, s56
  s_lshl_b32 s70, s70, 16
  buffer_load_dword v6, v5, s[12:15], s70 offen
  s_add_u32 s70, s61, 1
  s_sub_u32 s56, s62, 1
  s_min_u32 s70, s70, s56
  s_lshl_b32 s70, s70, 16
  buffer_load_dword v6, v5, s[12:15], s70 offen
  s_add_u32 s70, s61, 2
  s_sub_u32 s56, s62, 1
  s_min_u32 s70, s70, s56
  s_lshl_b32 s70, s70, 16
  buffer_load_dword v6, v5, s[12:15], s70 offen
  s_lshl_b32 s65, s50, 14
  s_add_u32 s63, s61, 0
  s_sub_u32 s56, s62, 1
  s_min_u32 s63, s63, s56
  s_lshl_b32 s63, s63, 16
  s_add_u32 m0, s65, 0
  s_nop 0
  buffer_load_dwordx4 v8, s[12:15], s63 offen lds
  buffer_load_dwordx4 v8, s[12:15], s63 offen offset:1024 lds
  s_add_u32 m0, s65, 2048
  s_nop 0
  buffer_load_dwordx4 v9, s[12:15], s63 offen lds
  buffer_load_dwordx4 v9, s[12:15], s63 offen offset:1024 lds
  s_add_u32 m0, s65, 4096
  s_nop 0
  buffer_load_dwordx4 v10, s[12:15], s63 offen lds
  buffer_load_dwordx4 v10, s[12:15], s63 offen offset:1024 lds
  s_add_u32 m0, s65, 6144
  s_nop 0
  buffer_load_dwordx4 v11, s[12:15], s63 offen lds
  buffer_load_dwordx4 v11, s[12:15], s63 offen offset:1024 lds
  s_add_u32 m0, s65, 8192
  s_nop 0
  buffer_load_dwordx4 v12, s[12:15], s63 offen lds
  buffer_load_dwordx4 v12, s[12:15], s63 offen offset:1024 lds
  s_add_u32 m0, s65, 10240
  s_nop 0
  buffer_load_dwordx4 v13, s[12:15], s63 offen lds
  buffer_load_dwordx4 v13, s[12:15], s63 offen offset:1024 lds
  s_add_u32 m0, s65, 12288
  s_nop 0
  buffer_load_dwordx4 v14, s[12:15], s63 offen lds
  buffer_load_dwordx4 v14, s[12:15], s63 offen offset:1024 lds
  s_add_u32 m0, s65, 14336
  s_nop 0
  buffer_load_dwordx4 v15, s[12:15], s63 offen lds
  buffer_load_dwordx4 v15, s[12:15], s63 offen offset:1024 lds
  s_waitcnt vmcnt(0)
L_b2:
  s_waitcnt vmcnt(3)
  s_barrier
  ds_read_b128 v[36:39], v16 offset:0
  ds_read_b128 v[40:43], v16 offset:32768
  ds_read_b128 v[44:47], v17 offset:0
  ds_read_b128 v[48:51], v17 offset:32768
  ds_read_b128 v[52:55], v18 offset:0
  ds_read_b128 v[56:59], v18 offset:32768
  s_xor_b32 s65, s65, 0x10000
  s_add_u32 s63, s61, 1
  s_sub_u32 s56, s62, 1
  s_min_u32 s63, s63, s56
  s_lshl_b32 s63, s63, 16
  s_add_u32 s70, s61, 3
  s_sub_u32 s56, s62, 1
  s_min_u32 s70, s70, s56
  s_lshl_b32 s70, s70, 16
  s_waitcnt lgkmcnt(4)
  v_mfma_f32_16x16x32_bf16 v[20:23], a[0:3], v[36:39], 0
  ds_read_b128 v[60:63], v19 offset:0
  v_mfma_f32_16x16x32_bf16 v[24:27], a[128:131], v[36:39], 0
  ds_read_b128 v[64:67], v19 offset:32768
  s_add_u32 m0, s65, 0
  v_mfma_f32_16x16x32_bf16 v[28:31], a[0:3], v[40:43], 0
  buffer_load_dwordx4 v8, s[12:15], s63 offen lds
  v_mfma_f32_16x16x32_bf16 v[32:35], a[128:131], v[40:43], 0
  s_waitcnt lgkmcnt(4)
  v_mfma_f32_16x16x32_bf16 v[20:23], a[4:7], v[44:47], v[20:23]
  ds_read_b128 v[36:39], v16 offset:256
  v_mfma_f32_16x16x32_bf16 v[24:27], a[132:135], v[44:47], v[24:27]
  ds_read_b128 v[40:43], v16 offset:33024
  v_mfma_f32_16x16x32_bf16 v[28:31], a[4:7], v[48:51], v[28:31]
  buffer_load_dwordx4 v8, s[12:15], s63 offen offset:1024 lds
  v_mfma_f32_16x16x32_bf16 v[32:35], a[132:135], v[48:51], v[32:35]
  s_waitcnt lgkmcnt(4)
  v_mfma_f32_16x16x32_bf16 v[20:23], a[8:11], v[52:55], v[20:23]
  ds_read_b128 v[44:47], v17 offset:256
  v_mfma_f32_16x16x32_bf16 v[24:27], a[136:139], v[52:55], v[24:27]
  ds_read_b128 v[48:51], v17 offset:33024
  s_add_u32 m0, s65, 2048
  v_mfma_f32_16x16x32_bf16 v[28:31], a[8:11], v[56:59], v[28:31]
  buffer_load_dwordx4 v9, s[12:15], s63 offen lds
  v_mfma_f32_16x16x32_bf16 v[32:35], a[136:139], v[56:59], v[32:35]
  s_waitcnt lgkmcnt(4)
  v_mfma_f32_16x16x32_bf16 v[20:23], a[12:15], v[60:63], v[20:23]
  ds_read_b128 v[52:55], v18 offset:256
  v_mfma_f32_16x16x32_bf16 v[24:27], a[140:143], v[60:63], v[24:27]
  ds_read_b128 v[56:59], v18 offset:33024
  v_mfma_f32_16x16x32_bf16 v[28:31], a[12:15], v[64:67], v[28:31]
  buffer_load_dwordx4 v9, s[12:15], s63 offen offset:1024 lds
  v_mfma_f32_16x16x32_bf16 v[32:35], a[140:143], v[64:67], v[32:35]
  s_waitcnt lgkmcnt(4)
  v_mfma_f32_16x16x32_bf16 v[20:23], a[16:19], v[36:39], v[20:23]
  ds_read_b128 v[60:63], v19 offset:256
  v_mfma_f32_16x16x32_bf16 v[24:27], a[144:147], v[36:39], v[24:27]
  ds_read_b128 v[64:67], v19 offset:33024
  s_add_u32 m0, s65, 4096
  v_mfma_f32_16x16x32_bf16 v[28:31], a[16:19], v[40:43], v[28:31]
  buffer_load_dwordx4 v10, s[12:15], s63 offen lds
  v_mfma_f32_16x16x32_bf16 v[32:35], a[144:147], v[40:43], v[32:35]
  s_waitcnt lgkmcnt(4)
  v_mfma_f32_16x16x32_bf16 v[20:23], a[20:23], v[44:47], v[20:23]
  ds_read_b128 v[36:39], v16 offset:512
  v_mfma_f32_16x16x32_bf16 v[24:27], a[148:151], v[44:47], v[24:27]
  ds_read_b128 v[40:43], v16 offset:33280
  v_mfma_f32_16x16x32_bf16 v[28:31], a[20:23], v[48:51], v[28:31]
  buffer_load_dwordx4 v10, s[12:15], s63 offen offset:1024 lds
  v_mfma_f32_16x16x32_bf16 v[32:35], a[148:151], v[48:51], v[32:35]
  s_waitcnt lgkmcnt(4)
  v_mfma_f32_16x16x32_bf16 v[20:23], a[24:27], v[52:55], v[20:23]
  ds_read_b128 v[44:47], v17 offset:512
  v_mfma_f32_16x16x32_bf16 v[24:27], a[152:155], v[52:55], v[24:27]
  ds_read_b128 v[48:51], v17 offset:33280
  s_add_u32 m0, s65, 6144
  v_mfma_f32_16x16x32_bf16 v[28:31], a[24:27], v[56:59], v[28:31]
  buffer_load_dwordx4 v11, s[12:15], s63 offen lds
  v_mfma_f32_16x16x32_bf16 v[32:35], a[152:155], v[56:59], v[32:35]
  s_waitcnt lgkmcnt(4)
  v_mfma_f32_16x16x32_bf16 v[20:23], a[28:31], v[60:63], v[20:23]
  ds_read_b128 v[52:55], v18 offset:512
  v_mfma_f32_16x16x32_bf16 v[24:27], a[156:159], v[60:63], v[24:27]
  ds_read_b128 v[56:59], v18 offset:33280
  v_mfma_f32_16x16x32_bf16 v[28:31], a[28:31], v[64:67], v[28:31]
  buffer_load_dwordx4 v11, s[12:15], s63 offen offset:1024 lds
  v_mfma_f32_16x16x32_bf16 v[32:35], a[156:159], v[64:67], v[32:35]
  s_waitcnt lgkmcnt(4)
  v_mfma_f32_16x16x32_bf16 v[20:23], a[32:35], v[36:39], v[20:23]
  ds_read_b128 v[60:63], v19 offset:512
  v_mfma_f32_16x16x32_bf16 v[24:27], a[160:163], v[36:39], v[24:27]
  ds_read_b128 v[64:67], v19 offset:33280
  s_add_u32 m0, s65, 8192
  v_mfma_f32_16x16x32_bf16 v[28:31], a[32:35], v[40:43], v[28:31]
  buffer_load_dwordx4 v12, s[12:15], s63 offen lds
  v_mfma_f32_16x16x32_bf16 v[32:35], a[160:163], v[40:43], v[32:35]
  s_waitcnt lgkmcnt(4)
  v_mfma_f32_16x16x32_bf16 v[20:23], a[36:39], v[44:47], v[20:23]
  ds_read_b128 v[36:39], v16 offset:768
  v_mfma_f32_16x16x32_bf16 v[24:27], a[164:167], v[44:47], v[24:27]
  ds_read_b128 v[40:43], v16 offset:33536
  v_mfma_f32_16x16x32_bf16 v[28:31], a[36:39], v[48:51], v[28:31]
  buffer_load_dwordx4 v12, s[12:15], s63 offen offset:1024 lds
  v_mfma_f32_16x16x32_bf16 v[32:35], a[164:167], v[48:51], v[32:35]
  s_waitcnt lgkmcnt(4)
  v_mfma_f32_16x16x32_bf16 v[20:23], a[40:43], v[52:55], v[20:23]
  ds_read_b128 v[44:47], v17 offset:768
  v_mfma_f32_16x16x32_bf16 v[24:27], a[168:171], v[52:55], v[24:27]
  ds_read_b128 v[48:51], v17 offset:33536
  s_add_u32 m0, s65, 10240
  v_mfma_f32_16x16x32_bf16 v[28:31], a[40:43], v[56:59], v[28:31]
  buffer_load_dwordx4 v13, s[12:15], s63 offen lds
  v_mfma_f32_16x16x32_bf16 v[32:35], a[168:171], v[56:59], v[32:35]
  s_waitcnt lgkmcnt(4)
  v_mfma_f32_16x16x32_bf16 v[20:23], a[44:47], v[60:63], v[20:23]
  ds_read_b128 v[52:55], v18 offset:768
  v_mfma_f32_16x16x32_bf16 v[24:27], a[172:175], v[60:63], v[24:27]
  ds_read_b128 v[56:59], v18 offset:33536
  v_mfma_f32_16x16x32_bf16 v[28:31], a[44:47], v[64:67], v[28:31]
  buffer_load_dwordx4 v13, s[12:15], s63 offen offset:1024 lds
  v_mfma_f32_16x16x32_bf16 v[32:35], a[172:175], v[64:67], v[32:35]
  s_waitcnt lgkmcnt(4)
  v_mfma_f32_16x16x32_bf16 v[20:23], a[48:51], v[36:39], v[20:23]
  ds_read_b128 v[60:63], v19 offset:768
  v_mfma_f32_16x16x32_bf16 v[24:27], a[176:179], v[36:39], v[24:27]
  ds_read_b128 v[64:67], v19 offset:33536
  s_add_u32 m0, s65, 12288
  v_mfma_f32_16x16x32_bf16 v[28:31], a[48:51], v[40:43], v[28:31]
  buffer_load_dwordx4 v14, s[12:15], s63 offen lds
  v_mfma_f32_16x16x32_bf16 v[32:35], a[176:179], v[40:43], v[32:35]
  s_waitcnt lgkmcnt(4)
  v_mfma_f32_16x16x32_bf16 v[20:23], a[52:55], v[44:47], v[20:23]
  ds_read_b128 v[36:39], v16 offset:1024
  v_mfma_f32_16x16x32_bf16 v[24:27], a[180:183], v[44:47], v[24:27]
  ds_read_b128 v[40:43], v16 offset:33792
  v_mfma_f32_16x16x32_bf16 v[28:31], a[52:55], v[48:51], v[28:31]
  buffer_load_dwordx4 v14, s[12:15], s63 offen offset:1024 lds
  v_mfma_f32_16x16x32_bf16 v[32:35], a[180:183], v[48:51], v[32:35]
  s_waitcnt lgkmcnt(4)
  v_mfma_f32_16x16x32_bf16 v[20:23], a[56:59], v[52:55], v[20:23]
  ds_read_b128 v[44:47], v17 offset:1024
  v_mfma_f32_16x16x32_bf16 v[24:27], a[184:187], v[52:55], v[24:27]
  ds_read_b128 v[48:51], v17 offset:33792
  s_add_u32 m0, s65, 14336
  v_mfma_f32_16x16x32_bf16 v[28:31], a[56:59], v[56:59], v[28:31]
  buffer_load_dwordx4 v15, s[12:15], s63 offen lds
  v_mfma_f32_16x16x32_bf16 v[32:35], a[184:187], v[56:59], v[32:35]
  s_waitcnt lgkmcnt(4)
  v_mfma_f32_16x16x32_bf16 v[20:23], a[60:63], v[60:63], v[20:23]
  ds_read_b128 v[52:55], v18 offset:1024
  v_mfma_f32_16x16x32_bf16 v[24:27], a[188:191], v[60:63], v[24:27]
  ds_read_b128 v[56:59], v18 offset:33792
  v_mfma_f32_16x16x32_bf16 v[28:31], a[60:63], v[64:67], v[28:31]
  buffer_load_dwordx4 v15, s[12:15], s63 offen offset:1024 lds
  v_mfma_f32_16x16x32_bf16 v[32:35], a[188:191], v[64:67], v[32:35]
  s_waitcnt lgkmcnt(4)
  v_mfma_f32_16x16x32_bf16 v[20:23], a[64:67], v[36:39], v[20:23]
  ds_read_b128 v[60:63], v19 offset:1024
  v_mfma_f32_16x16x32_bf16 v[24:27], a[192:195], v[36:39], v[24:27]
  ds_read_b128 v[64:67], v19 offset:33792
  v_mfma_f32_16x16x32_bf16 v[28:31], a[64:67], v[40:43], v[28:31]
  buffer_load_dword v6, v5, s[12:15], s70 offen
  v_mfma_f32_16x16x32_bf16 v[32:35], a[192:195], v[40:43], v[32:35]
  s_waitcnt lgkmcnt(4)
  v_mfma_f32_16x16x32_bf16 v[20:23], a[68:71], v[44:47], v[20:23]
  ds_read_b128 v[36:39], v16 offset:1280
  v_mfma_f32_16x16x32_bf16 v[24:27], a[196:199], v[44:47], v[24:27]
  ds_read_b128 v[40:43], v16 offset:34048
  v_mfma_f32_16x16x32_bf16 v[28:31], a[68:71], v[48:51], v[28:31]
  buffer_store_dwordx4 v[68:71], v7, s[4:7], s71 offen sc1
  s_add_u32 s71, s71, 32768
  v_mfma_f32_16x16x32_bf16 v[32:35], a[196:199], v[48:51], v[32:35]
  s_waitcnt lgkmcnt(4)
  v_mfma_f32_16x16x32_bf16 v[20:23], a[72:75], v[52:55], v[20:23]
  ds_read_b128 v[44:47], v17 offset:1280
  v_mfma_f32_16x16x32_bf16 v[24:27], a[200:203], v[52:55], v[24:27]
  ds_read_b128 v[48:51], v17 offset:34048
  v_mfma_f32_16x16x32_bf16 v[28:31], a[72:75], v[56:59], v[28:31]
  buffer_store_dwordx4 v[72:75], v7, s[4:7], s71 offen sc1
  v_mfma_f32_16x16x32_bf16 v[32:35], a[200:203], v[56:59], v[32:35]
  s_waitcnt lgkmcnt(4)
  v_mfma_f32_16x16x32_bf16 v[20:23], a[76:79], v[60:63], v[20:23]
  ds_read_b128 v[52:55], v18 offset:1280
  v_mfma_f32_16x16x32_bf16 v[24:27], a[204:207], v[60:63], v[24:27]
  ds_read_b128 v[56:59], v18 offset:34048
  v_mfma_f32_16x16x32_bf16 v[28:31], a[76:79], v[64:67], v[28:31]
  v_mfma_f32_16x16x32_bf16 v[32:35], a[204:207], v[64:67], v[32:35]
  s_waitcnt lgkmcnt(4)
  v_mfma_f32_16x16x32_bf16 v[20:23], a[80:83], v[36:39], v[20:23]
  ds_read_b128 v[60:63], v19 offset:1280
  v_mfma_f32_16x16x32_bf16 v[24:27], a[208:211], v[36:39], v[24:27]
  ds_read_b128 v[64:67], v19 offset:34048
  v_mfma_f32_16x16x32_bf16 v[28:31], a[80:83], v[40:43], v[28:31]
  v_mfma_f32_16x16x32_bf16 v[32:35], a[208:211], v[40:43], v[32:35]
  s_waitcnt lgkmcnt(4)
  v_mfma_f32_16x16x32_bf16 v[20:23], a[84:87], v[44:47], v[20:23]
  ds_read_b128 v[36:39], v16 offset:1536
  v_mfma_f32_16x16x32_bf16 v[24:27], a[212:215], v[44:47], v[24:27]
  ds_read_b128 v[40:43], v16 offset:34304
  v_mfma_f32_16x16x32_bf16 v[28:31], a[84:87], v[48:51], v[28:31]
  v_mfma_f32_16x16x32_bf16 v[32:35], a[212:215], v[48:51], v[32:35]
  s_waitcnt lgkmcnt(4)
  v_mfma_f32_16x16x32_bf16 v[20:23], a[88:91], v[52:55], v[20:23]
  ds_read_b128 v[44:47], v17 offset:1536
  v_mfma_f32_16x16x32_bf16 v[24:27], a[216:219], v[52:55], v[24:27]
  ds_read_b128 v[48:51], v17 offset:34304
  v_mfma_f32_16x16x32_bf16 v[28:31], a[88:91], v[56:59], v[28:31]
  v_mfma_f32_16x16x32_bf16 v[32:35], a[216:219], v[56:59], v[32:35]
  s_waitcnt lgkmcnt(4)
  v_mfma_f32_16x16x32_bf16 v[20:23], a[92:95], v[60:63], v[20:23]
  ds_read_b128 v[52:55], v18 offset:1536
  v_mfma_f32_16x16x32_bf16 v[24:27], a[220:223], v[60:63], v[24:27]
  ds_read_b128 v[56:59], v18 offset:34304
  v_mfma_f32_16x16x32_bf16 v[28:31], a[92:95], v[64:67], v[28:31]
  v_mfma_f32_16x16x32_bf16 v[32:35], a[220:223], v[64:67], v[32:35]
  s_waitcnt lgkmcnt(4)
  v_mfma_f32_16x16x32_bf16 v[20:23], a[96:99], v[36:39], v[20:23]
  ds_read_b128 v[60:63], v19 offset:1536
  v_mfma_f32_16x16x32_bf16 v[24:27], a[224:227], v[36:39], v[24:27]
  ds_read_b128 v[64:67], v19 offset:34304
  v_mfma_f32_16x16x32_bf16 v[28:31], a[96:99], v[40:43], v[28:31]
  v_mfma_f32_16x16x32_bf16 v[32:35], a[224:227], v[40:43], v[32:35]
  s_waitcnt lgkmcnt(4)
  v_mfma_f32_16x16x32_bf16 v[20:23], a[100:103], v[44:47], v[20:23]
  ds_read_b128 v[36:39], v16 offset:1792
  v_mfma_f32_16x16x32_bf16 v[24:27], a[228:231], v[44:47], v[24:27]
  ds_read_b128 v[40:43], v16 offset:34560
  v_mfma_f32_16x16x32_bf16 v[28:31], a[100:103], v[48:51], v[28:31]
  v_mfma_f32_16x16x32_bf16 v[32:35], a[228:231], v[48:51], v[32:35]
  s_waitcnt lgkmcnt(4)
  v_mfma_f32_16x16x32_bf16 v[20:23], a[104:107], v[52:55], v[20:23]
  ds_read_b128 v[44:47], v17 offset:1792
  v_mfma_f32_16x16x32_bf16 v[24:27], a[232:235], v[52:55], v[24:27]
  ds_read_b128 v[48:51], v17 offset:34560
  v_mfma_f32_16x16x32_bf16 v[28:31], a[104:107], v[56:59], v[28:31]
  v_mfma_f32_16x16x32_bf16 v[32:35], a[232:235], v[56:59], v[32:35]
  s_waitcnt lgkmcnt(4)
  v_mfma_f32_16x16x32_bf16 v[20:23], a[108:111], v[60:63], v[20:23]
  ds_read_b128 v[52:55], v18 offset:1792
  v_mfma_f32_16x16x32_bf16 v[24:27], a[236:239], v[60:63], v[24:27]
  ds_read_b128 v[56:59], v18 offset:34560
  v_mfma_f32_16x16x32_bf16 v[28:31], a[108:111], v[64:67], v[28:31]
  v_mfma_f32_16x16x32_bf16 v[32:35], a[236:239], v[64:67], v[32:35]
  s_waitcnt lgkmcnt(4)
  v_mfma_f32_16x16x32_bf16 v[20:23], a[112:115], v[36:39], v[20:23]
  ds_read_b128 v[60:63], v19 offset:1792
  v_mfma_f32_16x16x32_bf16 v[24:27], a[240:243], v[36:39], v[24:27]
  ds_read_b128 v[64:67], v19 offset:34560
  v_mfma_f32_16x16x32_bf16 v[28:31], a[112:115], v[40:43], v[28:31]
  v_mfma_f32_16x16x32_bf16 v[32:35], a[240:243], v[40:43], v[32:35]
  s_waitcnt lgkmcnt(4)
  v_mfma_f32_16x16x32_bf16 v[20:23], a[116:119], v[44:47], v[20:23]
  v_xor_b32 v16, 0x10000, v16
  v_mfma_f32_16x16x32_bf16 v[24:27], a[244:247], v[44:47], v[24:27]
  v_mfma_f32_16x16x32_bf16 v[28:31], a[116:119], v[48:51], v[28:31]
  v_mfma_f32_16x16x32_bf16 v[32:35], a[244:247], v[48:51], v[32:35]
  s_waitcnt lgkmcnt(2)
  v_mfma_f32_16x16x32_bf16 v[20:23], a[120:123], v[52:55], v[20:23]
  v_xor_b32 v17, 0x10000, v17
  v_mfma_f32_16x16x32_bf16 v[24:27], a[248:251], v[52:55], v[24:27]
  v_mfma_f32_16x16x32_bf16 v[28:31], a[120:123], v[56:59], v[28:31]
  v_mfma_f32_16x16x32_bf16 v[32:35], a[248:251], v[56:59], v[32:35]
  s_waitcnt lgkmcnt(0)
  v_mfma_f32_16x16x32_bf16 v[20:23], a[124:127], v[60:63], v[20:23]
  v_xor_b32 v18, 0x10000, v18
  v_mfma_f32_16x16x32_bf16 v[24:27], a[252:255], v[60:63], v[24:27]
  v_xor_b32 v19, 0x10000, v19
  v_mfma_f32_16x16x32_bf16 v[28:31], a[124:127], v[64:67], v[28:31]
  v_mfma_f32_16x16x32_bf16 v[32:35], a[252:255], v[64:67], v[32:35]
  v_mov_b32 v0, v0
  v_mov_b32 v0, v0
  v_mov_b32 v0, v0
  v_mul_f32 v68, s66, v20
  v_mul_f32 v69, s66, v21
  v_mul_f32 v70, s66, v22
  v_mul_f32 v71, s66, v23
  v_mul_f32 v72, s66, v24
  v_mul_f32 v73, s66, v25
  v_mul_f32 v74, s66, v26
  v_mul_f32 v75, s66, v27
  v_mul_f32 v76, s66, v28
  v_mul_f32 v77, s66, v29
  v_mul_f32 v78, s66, v30
  v_mul_f32 v79, s66, v31
  v_mul_f32 v80, s66, v32
  v_mul_f32 v81, s66, v33
  v_mul_f32 v82, s66, v34
  v_mul_f32 v83, s66, v35
  v_exp_f32 v68, v68
  v_exp_f32 v69, v69
  v_exp_f32 v70, v70
  v_exp_f32 v71, v71
  v_exp_f32 v72, v72
  v_exp_f32 v73, v73
  v_exp_f32 v74, v74
  v_exp_f32 v75, v75
  v_exp_f32 v76, v76
  v_exp_f32 v77, v77
  v_exp_f32 v78, v78
  v_exp_f32 v79, v79
  v_exp_f32 v80, v80
  v_exp_f32 v81, v81
  v_exp_f32 v82, v82
  v_exp_f32 v83, v83
  v_cmp_lt_f32 vcc, 0, v20
  v_add_f32 v20, 1.0, v20
  s_nop 0
  v_cndmask_b32 v20, v68, v20, vcc
  v_add_f32 v20, s68, v20
  v_cmp_lt_f32 vcc, 0, v21
  v_add_f32 v21, 1.0, v21
  s_nop 0
  v_cndmask_b32 v21, v69, v21, vcc
  v_add_f32 v21, s68, v21
  v_cmp_lt_f32 vcc, 0, v22
  v_add_f32 v22, 1.0, v22
  s_nop 0
  v_cndmask_b32 v22, v70, v22, vcc
  v_add_f32 v22, s68, v22
  v_cmp_lt_f32 vcc, 0, v23
  v_add_f32 v23, 1.0, v23
  s_nop 0
  v_cndmask_b32 v23, v71, v23, vcc
  v_add_f32 v23, s68, v23
  v_cmp_lt_f32 vcc, 0, v24
  v_add_f32 v24, 1.0, v24
  s_nop 0
  v_cndmask_b32 v24, v72, v24, vcc
  v_add_f32 v24, s68, v24
  v_cmp_lt_f32 vcc, 0, v25
  v_add_f32 v25, 1.0, v25
  s_nop 0
  v_cndmask_b32 v25, v73, v25, vcc
  v_add_f32 v25, s68, v25
  v_cmp_lt_f32 vcc, 0, v26
  v_add_f32 v26, 1.0, v26
  s_nop 0
  v_cndmask_b32 v26, v74, v26, vcc
  v_add_f32 v26, s68, v26
  v_cmp_lt_f32 vcc, 0, v27
  v_add_f32 v27, 1.0, v27
  s_nop 0
  v_cndmask_b32 v27, v75, v27, vcc
  v_add_f32 v27, s68, v27
  v_cmp_lt_f32 vcc, 0, v28
  v_add_f32 v28, 1.0, v28
  s_nop 0
  v_cndmask_b32 v28, v76, v28, vcc
  v_add_f32 v28, s68, v28
  v_cmp_lt_f32 vcc, 0, v29
  v_add_f32 v29, 1.0, v29
  s_nop 0
  v_cndmask_b32 v29, v77, v29, vcc
  v_add_f32 v29, s68, v29
  v_cmp_lt_f32 vcc, 0, v30
  v_add_f32 v30, 1.0, v30
  s_nop 0
  v_cndmask_b32 v30, v78, v30, vcc
  v_add_f32 v30, s68, v30
  v_cmp_lt_f32 vcc, 0, v31
  v_add_f32 v31, 1.0, v31
  s_nop 0
  v_cndmask_b32 v31, v79, v31, vcc
  v_add_f32 v31, s68, v31
  v_cmp_lt_f32 vcc, 0, v32
  v_add_f32 v32, 1.0, v32
  s_nop 0
  v_cndmask_b32 v32, v80, v32, vcc
  v_add_f32 v32, s68, v32
  v_cmp_lt_f32 vcc, 0, v33
  v_add_f32 v33, 1.0, v33
  s_nop 0
  v_cndmask_b32 v33, v81, v33, vcc
  v_add_f32 v33, s68, v33
  v_cmp_lt_f32 vcc, 0, v34
  v_add_f32 v34, 1.0, v34
  s_nop 0
  v_cndmask_b32 v34, v82, v34, vcc
  v_add_f32 v34, s68, v34
  v_cmp_lt_f32 vcc, 0, v35
  v_add_f32 v35, 1.0, v35
  s_nop 0
  v_cndmask_b32 v35, v83, v35, vcc
  v_add_f32 v35, s68, v35
  v_cvt_pk_bf16_f32 v140, v20, v21
  v_cvt_pk_bf16_f32 v141, v22, v23
  v_cvt_pk_bf16_f32 v142, v24, v25
  v_cvt_pk_bf16_f32 v143, v26, v27
  v_cvt_pk_bf16_f32 v144, v28, v29
  v_cvt_pk_bf16_f32 v145, v30, v31
  v_cvt_pk_bf16_f32 v146, v32, v33
  v_cvt_pk_bf16_f32 v147, v34, v35
  v_mfma_f32_16x16x32_bf16 v[160:163], v[128:131], v[140:143], 0
  v_mfma_f32_16x16x32_bf16 v[164:167], v[132:135], v[140:143], 0
  v_mfma_f32_16x16x32_bf16 v[168:171], v[136:139], v[140:143], 0
  v_mfma_f32_16x16x32_bf16 v[172:175], v[128:131], v[144:147], 0
  v_mfma_f32_16x16x32_bf16 v[176:179], v[132:135], v[144:147], 0
  v_mfma_f32_16x16x32_bf16 v[180:183], v[136:139], v[144:147], 0
  s_lshl_b32 s71, s61, 6
  s_add_u32 s71, s71, s60
  s_lshl_b32 s71, s71, 10
  s_add_u32 s71, s71, 0x6800000
  v_mov_b32 v7, v1
  v_add_f32 v168, s68, v168
  v_rcp_f32 v168, v168
  s_nop 0
  v_mul_f32 v160, v160, v168
  v_mul_f32 v161, v161, v168
  v_mul_f32 v162, v162, v168
  v_mul_f32 v163, v163, v168
  v_mul_f32 v164, v164, v168
  v_mul_f32 v165, v165, v168
  v_mul_f32 v166, v166, v168
  v_mul_f32 v167, v167, v168
  v_cvt_pk_bf16_f32 v68, v160, v161
  v_cvt_pk_bf16_f32 v69, v162, v163
  v_cvt_pk_bf16_f32 v70, v164, v165
  v_cvt_pk_bf16_f32 v71, v166, v167
  v_add_f32 v180, s68, v180
  v_rcp_f32 v180, v180
  s_nop 0
  v_mul_f32 v172, v172, v180
  v_mul_f32 v173, v173, v180
  v_mul_f32 v174, v174, v180
  v_mul_f32 v175, v175, v180
  v_mul_f32 v176, v176, v180
  v_mul_f32 v177, v177, v180
  v_mul_f32 v178, v178, v180
  v_mul_f32 v179, v179, v180
  v_cvt_pk_bf16_f32 v72, v172, v173
  v_cvt_pk_bf16_f32 v73, v174, v175
  v_cvt_pk_bf16_f32 v74, v176, v177
  v_cvt_pk_bf16_f32 v75, v178, v179
  s_add_u32 s61, s61, 1
  s_cmp_lt_u32 s61, s62
  s_cbranch_scc1 L_b2
  buffer_store_dwordx4 v[68:71], v7, s[4:7], s71 offen sc1
  s_add_u32 s71, s71, 32768
  buffer_store_dwordx4 v[72:75], v7, s[4:7], s71 offen sc1
  s_waitcnt vmcnt(0)
  s_barrier
  s_cmp_lg_u32 s50, 0
  s_cbranch_scc1 Lsg_248
  v_mov_b32 v126, 2
  s_lshl_b32 s59, s2, 7
  s_mov_b64 exec, 1
  buffer_store_dword v126, off, s[4:7], s59 sc1
  s_mov_b64 exec, -1
Lsg_248:
  s_mov_b32 s8, s42
  s_mov_b32 s9, s43
  s_mov_b32 s10, 0x200000
  s_mov_b32 s11, 0x20000
  v_lshrrev_b32 v126, 3, v0
  v_lshlrev_b32 v2, 11, v126
  v_and_b32 v126, 2, v126
  v_xor_b32 v126, v126, v0
  v_and_b32 v126, 7, v126
  v_lshlrev_b32 v126, 4, v126
  v_xor_b32 v3, 64, v126
  v_add_u32 v3, v3, v2
  v_add_u32 v2, v126, v2
  v_lshrrev_b32 v126, 2, v0
  v_bfe_u32 v127, v0, 3, 1
  v_lshlrev_b32 v126, 7, v126
  s_and_b32 s56, s50, 1
  s_lshl_b32 s56, s56, 1
  v_xor_b32 v127, s56, v127
  v_bfe_u32 v4, v0, 1, 1
  v_xor_b32 v127, v127, v4
  v_and_b32 v4, 1, v0
  v_lshl_add_u32 v126, v4, 4, v126
  v_lshl_add_u32 v126, v127, 5, v126
  v_xor_b32 v68, 0, v126
  v_add_u32 v72, 0x10000, v68
  v_xor_b32 v69, 32, v126
  v_add_u32 v73, 0x10000, v69
  v_xor_b32 v70, 64, v126
  v_add_u32 v74, 0x10000, v70
  v_xor_b32 v71, 96, v126
  v_add_u32 v75, 0x10000, v71
  s_and_b32 s60, s52, 7
  s_lshl_b32 s60, s60, 8
  s_mul_i32 s56, s50, 524288
  s_add_u32 s60, s60, s56
  s_lshl_b32 s56, s50, 15
  s_add_u32 s56, s56, 0
  s_sub_u32 s57, s60, 16384
  s_mov_b32 s58, 4
Ldma_249:
  s_mov_b32 m0, s56
  s_add_u32 s57, s57, 16384
  buffer_load_dwordx4 v2, s[8:11], s57 offen nt lds
  s_add_u32 s56, s56, 1024
  s_mov_b32 m0, s56
  s_add_u32 s57, s57, 16384
  buffer_load_dwordx4 v2, s[8:11], s57 offen nt lds
  s_add_u32 s56, s56, 1024
  s_mov_b32 m0, s56
  s_add_u32 s57, s57, 16384
  buffer_load_dwordx4 v3, s[8:11], s57 offen nt lds
  s_add_u32 s56, s56, 1024
  s_mov_b32 m0, s56
  s_add_u32 s57, s57, 16384
  buffer_load_dwordx4 v3, s[8:11], s57 offen nt lds
  s_add_u32 s56, s56, 1024
  s_sub_u32 s58, s58, 1
  s_cmp_lg_u32 s58, 0
  s_cbranch_scc1 Ldma_249
  s_and_b32 s60, s52, 7
  s_lshl_b32 s60, s60, 8
  s_mul_i32 s56, s50, 524288
  s_add_u32 s60, s60, s56
  s_add_u32 s60, s60, 262144
  s_lshl_b32 s56, s50, 15
  s_add_u32 s56, s56, 16384
  s_sub_u32 s57, s60, 16384
  s_mov_b32 s58, 4
Ldma_250:
  s_mov_b32 m0, s56
  s_add_u32 s57, s57, 16384
  buffer_load_dwordx4 v2, s[8:11], s57 offen nt lds
  s_add_u32 s56, s56, 1024
  s_mov_b32 m0, s56
  s_add_u32 s57, s57, 16384
  buffer_load_dwordx4 v2, s[8:11], s57 offen nt lds
  s_add_u32 s56, s56, 1024
  s_mov_b32 m0, s56
  s_add_u32 s57, s57, 16384
  buffer_load_dwordx4 v3, s[8:11], s57 offen nt lds
  s_add_u32 s56, s56, 1024
  s_mov_b32 m0, s56
  s_add_u32 s57, s57, 16384
  buffer_load_dwordx4 v3, s[8:11], s57 offen nt lds
  s_add_u32 s56, s56, 1024
  s_sub_u32 s58, s58, 1
  s_cmp_lg_u32 s58, 0
  s_cbranch_scc1 Ldma_250
  s_waitcnt vmcnt(16)
  s_barrier
  s_lshr_b32 s56, s50, 1
  s_cmp_lg_u32 s56, 0
  s_cbranch_scc1 Lro_251
  ds_read_b64_tr_b16 a[0:1], v68 offset:0
  ds_read_b64_tr_b16 a[2:3], v70 offset:2048
  ds_read_b64_tr_b16 a[4:5], v68 offset:4096
  ds_read_b64_tr_b16 a[6:7], v70 offset:6144
  ds_read_b64_tr_b16 a[8:9], v68 offset:8192
  ds_read_b64_tr_b16 a[10:11], v70 offset:10240
  ds_read_b64_tr_b16 a[12:13], v68 offset:12288
  ds_read_b64_tr_b16 a[14:15], v70 offset:14336
  ds_read_b64_tr_b16 a[32:33], v68 offset:32768
  ds_read_b64_tr_b16 a[34:35], v70 offset:34816
  ds_read_b64_tr_b16 a[36:37], v68 offset:36864
  ds_read_b64_tr_b16 a[38:39], v70 offset:38912
  ds_read_b64_tr_b16 a[40:41], v68 offset:40960
  ds_read_b64_tr_b16 a[42:43], v70 offset:43008
  ds_read_b64_tr_b16 a[44:45], v68 offset:45056
  ds_read_b64_tr_b16 a[46:47], v70 offset:47104
  ds_read_b64_tr_b16 a[64:65], v72 offset:0
  ds_read_b64_tr_b16 a[66:67], v74 offset:2048
  ds_read_b64_tr_b16 a[68:69], v72 offset:4096
  ds_read_b64_tr_b16 a[70:71], v74 offset:6144
  ds_read_b64_tr_b16 a[72:73], v72 offset:8192
  ds_read_b64_tr_b16 a[74:75], v74 offset:10240
  ds_read_b64_tr_b16 a[76:77], v72 offset:12288
  ds_read_b64_tr_b16 a[78:79], v74 offset:14336
  ds_read_b64_tr_b16 a[96:97], v72 offset:32768
  ds_read_b64_tr_b16 a[98:99], v74 offset:34816
  ds_read_b64_tr_b16 a[100:101], v72 offset:36864
  ds_read_b64_tr_b16 a[102:103], v74 offset:38912
  ds_read_b64_tr_b16 a[104:105], v72 offset:40960
  ds_read_b64_tr_b16 a[106:107], v74 offset:43008
  ds_read_b64_tr_b16 a[108:109], v72 offset:45056
  ds_read_b64_tr_b16 a[110:111], v74 offset:47104
  ds_read_b64_tr_b16 a[128:129], v68 offset:8
  ds_read_b64_tr_b16 a[130:131], v70 offset:2056
  ds_read_b64_tr_b16 a[132:133], v68 offset:4104
  ds_read_b64_tr_b16 a[134:135], v70 offset:6152
  ds_read_b64_tr_b16 a[136:137], v68 offset:8200
  ds_read_b64_tr_b16 a[138:139], v70 offset:10248
  ds_read_b64_tr_b16 a[140:141], v68 offset:12296
  ds_read_b64_tr_b16 a[142:143], v70 offset:14344
  ds_read_b64_tr_b16 a[160:161], v68 offset:32776
  ds_read_b64_tr_b16 a[162:163], v70 offset:34824
  ds_read_b64_tr_b16 a[164:165], v68 offset:36872
  ds_read_b64_tr_b16 a[166:167], v70 offset:38920
  ds_read_b64_tr_b16 a[168:169], v68 offset:40968
  ds_read_b64_tr_b16 a[170:171], v70 offset:43016
  ds_read_b64_tr_b16 a[172:173], v68 offset:45064
  ds_read_b64_tr_b16 a[174:175], v70 offset:47112
  ds_read_b64_tr_b16 a[192:193], v72 offset:8
  ds_read_b64_tr_b16 a[194:195], v74 offset:2056
  ds_read_b64_tr_b16 a[196:197], v72 offset:4104
  ds_read_b64_tr_b16 a[198:199], v74 offset:6152
  ds_read_b64_tr_b16 a[200:201], v72 offset:8200
  ds_read_b64_tr_b16 a[202:203], v74 offset:10248
  ds_read_b64_tr_b16 a[204:205], v72 offset:12296
  ds_read_b64_tr_b16 a[206:207], v74 offset:14344
  ds_read_b64_tr_b16 a[224:225], v72 offset:32776
  ds_read_b64_tr_b16 a[226:227], v74 offset:34824
  ds_read_b64_tr_b16 a[228:229], v72 offset:36872
  ds_read_b64_tr_b16 a[230:231], v74 offset:38920
  ds_read_b64_tr_b16 a[232:233], v72 offset:40968
  ds_read_b64_tr_b16 a[234:235], v74 offset:43016
  ds_read_b64_tr_b16 a[236:237], v72 offset:45064
  ds_read_b64_tr_b16 a[238:239], v74 offset:47112
Lro_251:
  s_waitcnt lgkmcnt(0)
  s_barrier
  s_and_b32 s60, s52, 7
  s_lshl_b32 s60, s60, 8
  s_add_u32 s60, s60, 128
  s_mul_i32 s56, s50, 524288
  s_add_u32 s60, s60, s56
  s_lshl_b32 s56, s50, 15
  s_add_u32 s56, s56, 0
  s_sub_u32 s57, s60, 16384
  s_mov_b32 s58, 4
Ldma_252:
  s_mov_b32 m0, s56
  s_add_u32 s57, s57, 16384
  buffer_load_dwordx4 v2, s[8:11], s57 offen nt lds
  s_add_u32 s56, s56, 1024
  s_mov_b32 m0, s56
  s_add_u32 s57, s57, 16384
  buffer_load_dwordx4 v2, s[8:11], s57 offen nt lds
  s_add_u32 s56, s56, 1024
  s_mov_b32 m0, s56
  s_add_u32 s57, s57, 16384
  buffer_load_dwordx4 v3, s[8:11], s57 offen nt lds
  s_add_u32 s56, s56, 1024
  s_mov_b32 m0, s56
  s_add_u32 s57, s57, 16384
  buffer_load_dwordx4 v3, s[8:11], s57 offen nt lds
  s_add_u32 s56, s56, 1024
  s_sub_u32 s58, s58, 1
  s_cmp_lg_u32 s58, 0
  s_cbranch_scc1 Ldma_252
  s_waitcnt vmcnt(16)
  s_barrier
  s_lshr_b32 s56, s50, 1
  s_cmp_lg_u32 s56, 0
  s_cbranch_scc1 Lro_253
  ds_read_b64_tr_b16 a[16:17], v68 offset:16384
  ds_read_b64_tr_b16 a[18:19], v70 offset:18432
  ds_read_b64_tr_b16 a[20:21], v68 offset:20480
  ds_read_b64_tr_b16 a[22:23], v70 offset:22528
  ds_read_b64_tr_b16 a[24:25], v68 offset:24576
  ds_read_b64_tr_b16 a[26:27], v70 offset:26624
  ds_read_b64_tr_b16 a[28:29], v68 offset:28672
  ds_read_b64_tr_b16 a[30:31], v70 offset:30720
  ds_read_b64_tr_b16 a[48:49], v68 offset:49152
  ds_read_b64_tr_b16 a[50:51], v70 offset:51200
  ds_read_b64_tr_b16 a[52:53], v68 offset:53248
  ds_read_b64_tr_b16 a[54:55], v70 offset:55296
  ds_read_b64_tr_b16 a[56:57], v68 offset:57344
  ds_read_b64_tr_b16 a[58:59], v70 offset:59392
  ds_read_b64_tr_b16 a[60:61], v68 offset:61440
  ds_read_b64_tr_b16 a[62:63], v70 offset:63488
  ds_read_b64_tr_b16 a[80:81], v72 offset:16384
  ds_read_b64_tr_b16 a[82:83], v74 offset:18432
  ds_read_b64_tr_b16 a[84:85], v72 offset:20480
  ds_read_b64_tr_b16 a[86:87], v74 offset:22528
  ds_read_b64_tr_b16 a[88:89], v72 offset:24576
  ds_read_b64_tr_b16 a[90:91], v74 offset:26624
  ds_read_b64_tr_b16 a[92:93], v72 offset:28672
  ds_read_b64_tr_b16 a[94:95], v74 offset:30720
  ds_read_b64_tr_b16 a[112:113], v72 offset:49152
  ds_read_b64_tr_b16 a[114:115], v74 offset:51200
  ds_read_b64_tr_b16 a[116:117], v72 offset:53248
  ds_read_b64_tr_b16 a[118:119], v74 offset:55296
  ds_read_b64_tr_b16 a[120:121], v72 offset:57344
  ds_read_b64_tr_b16 a[122:123], v74 offset:59392
  ds_read_b64_tr_b16 a[124:125], v72 offset:61440
  ds_read_b64_tr_b16 a[126:127], v74 offset:63488
  ds_read_b64_tr_b16 a[144:145], v68 offset:16392
  ds_read_b64_tr_b16 a[146:147], v70 offset:18440
  ds_read_b64_tr_b16 a[148:149], v68 offset:20488
  ds_read_b64_tr_b16 a[150:151], v70 offset:22536
  ds_read_b64_tr_b16 a[152:153], v68 offset:24584
  ds_read_b64_tr_b16 a[154:155], v70 offset:26632
  ds_read_b64_tr_b16 a[156:157], v68 offset:28680
  ds_read_b64_tr_b16 a[158:159], v70 offset:30728
  ds_read_b64_tr_b16 a[176:177], v68 offset:49160
  ds_read_b64_tr_b16 a[178:179], v70 offset:51208
  ds_read_b64_tr_b16 a[180:181], v68 offset:53256
  ds_read_b64_tr_b16 a[182:183], v70 offset:55304
  ds_read_b64_tr_b16 a[184:185], v68 offset:57352
  ds_read_b64_tr_b16 a[186:187], v70 offset:59400
  ds_read_b64_tr_b16 a[188:189], v68 offset:61448
  ds_read_b64_tr_b16 a[190:191], v70 offset:63496
  ds_read_b64_tr_b16 a[208:209], v72 offset:16392
  ds_read_b64_tr_b16 a[210:211], v74 offset:18440
  ds_read_b64_tr_b16 a[212:213], v72 offset:20488
  ds_read_b64_tr_b16 a[214:215], v74 offset:22536
  ds_read_b64_tr_b16 a[216:217], v72 offset:24584
  ds_read_b64_tr_b16 a[218:219], v74 offset:26632
  ds_read_b64_tr_b16 a[220:221], v72 offset:28680
  ds_read_b64_tr_b16 a[222:223], v74 offset:30728
  ds_read_b64_tr_b16 a[240:241], v72 offset:49160
  ds_read_b64_tr_b16 a[242:243], v74 offset:51208
  ds_read_b64_tr_b16 a[244:245], v72 offset:53256
  ds_read_b64_tr_b16 a[246:247], v74 offset:55304
  ds_read_b64_tr_b16 a[248:249], v72 offset:57352
  ds_read_b64_tr_b16 a[250:251], v74 offset:59400
  ds_read_b64_tr_b16 a[252:253], v72 offset:61448
  ds_read_b64_tr_b16 a[254:255], v74 offset:63496
Lro_253:
  s_waitcnt lgkmcnt(0)
  s_barrier
  s_and_b32 s60, s52, 7
  s_lshl_b32 s60, s60, 8
  s_add_u32 s60, s60, 128
  s_mul_i32 s56, s50, 524288
  s_add_u32 s60, s60, s56
  s_add_u32 s60, s60, 262144
  s_lshl_b32 s56, s50, 15
  s_add_u32 s56, s56, 16384
  s_sub_u32 s57, s60, 16384
  s_mov_b32 s58, 4
Ldma_254:
  s_mov_b32 m0, s56
  s_add_u32 s57, s57, 16384
  buffer_load_dwordx4 v2, s[8:11], s57 offen nt lds
  s_add_u32 s56, s56, 1024
  s_mov_b32 m0, s56
  s_add_u32 s57, s57, 16384
  buffer_load_dwordx4 v2, s[8:11], s57 offen nt lds
  s_add_u32 s56, s56, 1024
  s_mov_b32 m0, s56
  s_add_u32 s57, s57, 16384
  buffer_load_dwordx4 v3, s[8:11], s57 offen nt lds
  s_add_u32 s56, s56, 1024
  s_mov_b32 m0, s56
  s_add_u32 s57, s57, 16384
  buffer_load_dwordx4 v3, s[8:11], s57 offen nt lds
  s_add_u32 s56, s56, 1024
  s_sub_u32 s58, s58, 1
  s_cmp_lg_u32 s58, 0
  s_cbranch_scc1 Ldma_254
  s_waitcnt vmcnt(16)
  s_barrier
  s_lshr_b32 s56, s50, 1
  s_cmp_lg_u32 s56, 1
  s_cbranch_scc1 Lro_255
  ds_read_b64_tr_b16 a[0:1], v68 offset:0
  ds_read_b64_tr_b16 a[2:3], v70 offset:2048
  ds_read_b64_tr_b16 a[4:5], v68 offset:4096
  ds_read_b64_tr_b16 a[6:7], v70 offset:6144
  ds_read_b64_tr_b16 a[8:9], v68 offset:8192
  ds_read_b64_tr_b16 a[10:11], v70 offset:10240
  ds_read_b64_tr_b16 a[12:13], v68 offset:12288
  ds_read_b64_tr_b16 a[14:15], v70 offset:14336
  ds_read_b64_tr_b16 a[32:33], v68 offset:32768
  ds_read_b64_tr_b16 a[34:35], v70 offset:34816
  ds_read_b64_tr_b16 a[36:37], v68 offset:36864
  ds_read_b64_tr_b16 a[38:39], v70 offset:38912
  ds_read_b64_tr_b16 a[40:41], v68 offset:40960
  ds_read_b64_tr_b16 a[42:43], v70 offset:43008
  ds_read_b64_tr_b16 a[44:45], v68 offset:45056
  ds_read_b64_tr_b16 a[46:47], v70 offset:47104
  ds_read_b64_tr_b16 a[64:65], v72 offset:0
  ds_read_b64_tr_b16 a[66:67], v74 offset:2048
  ds_read_b64_tr_b16 a[68:69], v72 offset:4096
  ds_read_b64_tr_b16 a[70:71], v74 offset:6144
  ds_read_b64_tr_b16 a[72:73], v72 offset:8192
  ds_read_b64_tr_b16 a[74:75], v74 offset:10240
  ds_read_b64_tr_b16 a[76:77], v72 offset:12288
  ds_read_b64_tr_b16 a[78:79], v74 offset:14336
  ds_read_b64_tr_b16 a[96:97], v72 offset:32768
  ds_read_b64_tr_b16 a[98:99], v74 offset:34816
  ds_read_b64_tr_b16 a[100:101], v72 offset:36864
  ds_read_b64_tr_b16 a[102:103], v74 offset:38912
  ds_read_b64_tr_b16 a[104:105], v72 offset:40960
  ds_read_b64_tr_b16 a[106:107], v74 offset:43008
  ds_read_b64_tr_b16 a[108:109], v72 offset:45056
  ds_read_b64_tr_b16 a[110:111], v74 offset:47104
  ds_read_b64_tr_b16 a[128:129], v68 offset:8
  ds_read_b64_tr_b16 a[130:131], v70 offset:2056
  ds_read_b64_tr_b16 a[132:133], v68 offset:4104
  ds_read_b64_tr_b16 a[134:135], v70 offset:6152
  ds_read_b64_tr_b16 a[136:137], v68 offset:8200
  ds_read_b64_tr_b16 a[138:139], v70 offset:10248
  ds_read_b64_tr_b16 a[140:141], v68 offset:12296
  ds_read_b64_tr_b16 a[142:143], v70 offset:14344
  ds_read_b64_tr_b16 a[160:161], v68 offset:32776
  ds_read_b64_tr_b16 a[162:163], v70 offset:34824
  ds_read_b64_tr_b16 a[164:165], v68 offset:36872
  ds_read_b64_tr_b16 a[166:167], v70 offset:38920
  ds_read_b64_tr_b16 a[168:169], v68 offset:40968
  ds_read_b64_tr_b16 a[170:171], v70 offset:43016
  ds_read_b64_tr_b16 a[172:173], v68 offset:45064
  ds_read_b64_tr_b16 a[174:175], v70 offset:47112
  ds_read_b64_tr_b16 a[192:193], v72 offset:8
  ds_read_b64_tr_b16 a[194:195], v74 offset:2056
  ds_read_b64_tr_b16 a[196:197], v72 offset:4104
  ds_read_b64_tr_b16 a[198:199], v74 offset:6152
  ds_read_b64_tr_b16 a[200:201], v72 offset:8200
  ds_read_b64_tr_b16 a[202:203], v74 offset:10248
  ds_read_b64_tr_b16 a[204:205], v72 offset:12296
  ds_read_b64_tr_b16 a[206:207], v74 offset:14344
  ds_read_b64_tr_b16 a[224:225], v72 offset:32776
  ds_read_b64_tr_b16 a[226:227], v74 offset:34824
  ds_read_b64_tr_b16 a[228:229], v72 offset:36872
  ds_read_b64_tr_b16 a[230:231], v74 offset:38920
  ds_read_b64_tr_b16 a[232:233], v72 offset:40968
  ds_read_b64_tr_b16 a[234:235], v74 offset:43016
  ds_read_b64_tr_b16 a[236:237], v72 offset:45064
  ds_read_b64_tr_b16 a[238:239], v74 offset:47112
Lro_255:
  s_waitcnt lgkmcnt(0)
  s_barrier
  s_waitcnt vmcnt(0)
  s_barrier
  s_lshr_b32 s56, s50, 1
  s_cmp_lg_u32 s56, 1
  s_cbranch_scc1 Lro_256
  ds_read_b64_tr_b16 a[16:17], v68 offset:16384
  ds_read_b64_tr_b16 a[18:19], v70 offset:18432
  ds_read_b64_tr_b16 a[20:21], v68 offset:20480
  ds_read_b64_tr_b16 a[22:23], v70 offset:22528
  ds_read_b64_tr_b16 a[24:25], v68 offset:24576
  ds_read_b64_tr_b16 a[26:27], v70 offset:26624
  ds_read_b64_tr_b16 a[28:29], v68 offset:28672
  ds_read_b64_tr_b16 a[30:31], v70 offset:30720
  ds_read_b64_tr_b16 a[48:49], v68 offset:49152
  ds_read_b64_tr_b16 a[50:51], v70 offset:51200
  ds_read_b64_tr_b16 a[52:53], v68 offset:53248
  ds_read_b64_tr_b16 a[54:55], v70 offset:55296
  ds_read_b64_tr_b16 a[56:57], v68 offset:57344
  ds_read_b64_tr_b16 a[58:59], v70 offset:59392
  ds_read_b64_tr_b16 a[60:61], v68 offset:61440
  ds_read_b64_tr_b16 a[62:63], v70 offset:63488
  ds_read_b64_tr_b16 a[80:81], v72 offset:16384
  ds_read_b64_tr_b16 a[82:83], v74 offset:18432
  ds_read_b64_tr_b16 a[84:85], v72 offset:20480
  ds_read_b64_tr_b16 a[86:87], v74 offset:22528
  ds_read_b64_tr_b16 a[88:89], v72 offset:24576
  ds_read_b64_tr_b16 a[90:91], v74 offset:26624
  ds_read_b64_tr_b16 a[92:93], v72 offset:28672
  ds_read_b64_tr_b16 a[94:95], v74 offset:30720
  ds_read_b64_tr_b16 a[112:113], v72 offset:49152
  ds_read_b64_tr_b16 a[114:115], v74 offset:51200
  ds_read_b64_tr_b16 a[116:117], v72 offset:53248
  ds_read_b64_tr_b16 a[118:119], v74 offset:55296
  ds_read_b64_tr_b16 a[120:121], v72 offset:57344
  ds_read_b64_tr_b16 a[122:123], v74 offset:59392
  ds_read_b64_tr_b16 a[124:125], v72 offset:61440
  ds_read_b64_tr_b16 a[126:127], v74 offset:63488
  ds_read_b64_tr_b16 a[144:145], v68 offset:16392
  ds_read_b64_tr_b16 a[146:147], v70 offset:18440
  ds_read_b64_tr_b16 a[148:149], v68 offset:20488
  ds_read_b64_tr_b16 a[150:151], v70 offset:22536
  ds_read_b64_tr_b16 a[152:153], v68 offset:24584
  ds_read_b64_tr_b16 a[154:155], v70 offset:26632
  ds_read_b64_tr_b16 a[156:157], v68 offset:28680
  ds_read_b64_tr_b16 a[158:159], v70 offset:30728
  ds_read_b64_tr_b16 a[176:177], v68 offset:49160
  ds_read_b64_tr_b16 a[178:179], v70 offset:51208
  ds_read_b64_tr_b16 a[180:181], v68 offset:53256
  ds_read_b64_tr_b16 a[182:183], v70 offset:55304
  ds_read_b64_tr_b16 a[184:185], v68 offset:57352
  ds_read_b64_tr_b16 a[186:187], v70 offset:59400
  ds_read_b64_tr_b16 a[188:189], v68 offset:61448
  ds_read_b64_tr_b16 a[190:191], v70 offset:63496
  ds_read_b64_tr_b16 a[208:209], v72 offset:16392
  ds_read_b64_tr_b16 a[210:211], v74 offset:18440
  ds_read_b64_tr_b16 a[212:213], v72 offset:20488
  ds_read_b64_tr_b16 a[214:215], v74 offset:22536
  ds_read_b64_tr_b16 a[216:217], v72 offset:24584
  ds_read_b64_tr_b16 a[218:219], v74 offset:26632
  ds_read_b64_tr_b16 a[220:221], v72 offset:28680
  ds_read_b64_tr_b16 a[222:223], v74 offset:30728
  ds_read_b64_tr_b16 a[240:241], v72 offset:49160
  ds_read_b64_tr_b16 a[242:243], v74 offset:51208
  ds_read_b64_tr_b16 a[244:245], v72 offset:53256
  ds_read_b64_tr_b16 a[246:247], v74 offset:55304
  ds_read_b64_tr_b16 a[248:249], v72 offset:57352
  ds_read_b64_tr_b16 a[250:251], v74 offset:59400
  ds_read_b64_tr_b16 a[252:253], v72 offset:61448
  ds_read_b64_tr_b16 a[254:255], v74 offset:63496
Lro_256:
  s_waitcnt lgkmcnt(0)
  s_barrier
  s_and_b32 s56, s52, 24
  s_lshl_b32 s56, s56, 10
  s_add_u32 s56, s56, 640
  v_and_b32 v126, 7, v0
  v_lshl_add_u32 v158, v126, 10, s56
  s_and_b32 s56, s52, 7
  s_lshl_b32 s56, s56, 2
  s_add_u32 s56, s56, s50
  s_lshl_b32 s56, s56, 6
  s_add_u32 s56, s56, 2048
  v_and_b32 v126, 15, v0
  v_lshlrev_b32 v126, 12, v126
  v_and_b32 v127, 48, v0
  v_add3_u32 v159, v126, v127, s56
Lwf_257:
  buffer_load_dword v126, v158, s[4:7], 0 offen sc1
  s_waitcnt vmcnt(0)
  v_cmp_gt_u32 vcc, 2, v126
  s_cbranch_vccz Lwf_258
  s_sleep 2
  s_add_u32 s55, s55, 1
  s_bitcmp1_b32 s55, 21
  s_cbranch_scc1 L_abort
  s_branch Lwf_257
Lwf_258:
  s_lshr_b32 s61, s52, 3
  s_lshl_b32 s61, s61, 4
  s_add_u32 s62, s61, 16
  s_mov_b32 s71, 0
  s_lshl_b32 s56, s50, 3
  s_add_u32 s56, s56, 0
  s_lshl_b32 s56, s56, 11
  v_add_u32 v8, s56, v1
  s_lshl_b32 s56, s50, 3
  s_add_u32 s56, s56, 1
  s_lshl_b32 s56, s56, 11
  v_add_u32 v9, s56, v1
  s_lshl_b32 s56, s50, 3
  s_add_u32 s56, s56, 2
  s_lshl_b32 s56, s56, 11
  v_add_u32 v10, s56, v1
  s_lshl_b32 s56, s50, 3
  s_add_u32 s56, s56, 3
  s_lshl_b32 s56, s56, 11
  v_add_u32 v11, s56, v1
  s_lshl_b32 s56, s50, 3
  s_add_u32 s56, s56, 4
  s_lshl_b32 s56, s56, 11
  v_add_u32 v12, s56, v1
  s_lshl_b32 s56, s50, 3
  s_add_u32 s56, s56, 5
  s_lshl_b32 s56, s56, 11
  v_add_u32 v13, s56, v1
  s_lshl_b32 s56, s50, 3
  s_add_u32 s56, s56, 6
  s_lshl_b32 s56, s56, 11
  v_add_u32 v14, s56, v1
  s_lshl_b32 s56, s50, 3
  s_add_u32 s56, s56, 7
  s_lshl_b32 s56, s56, 11
  v_add_u32 v15, s56, v1
  v_mov_b32 v16, v1
  v_mov_b32 v17, v1
  v_mov_b32 v18, v1
  v_mov_b32 v19, v1
  s_and_b32 s56, s52, 7
  s_lshl_b32 s56, s56, 2
  s_add_u32 s56, s56, s50
  s_mul_i32 s56, s56, 2048
  v_lshl_add_u32 v5, v0, 6, s56
  v_cmp_gt_u32 vcc, 32, v0
  v_mov_b32 v7, 0x80000000
  s_nop 0
  v_cndmask_b32 v5, v7, v5, vcc
  s_add_u32 s70, s61, 0
  s_sub_u32 s56, s62, 1
  s_min_u32 s70, s70, s56
  s_lshl_b32 s70, s70, 16
  s_add_u32 s70, s70, 0x6800000
  buffer_load_dword v6, v5, s[4:7], s70 offen sc1
  s_add_u32 s70, s61, 1
  s_sub_u32 s56, s62, 1
  s_min_u32 s70, s70, s56
  s_lshl_b32 s70, s70, 16
  s_add_u32 s70, s70, 0x6800000
  buffer_load_dword v6, v5, s[4:7], s70 offen sc1
  s_add_u32 s70, s61, 2
  s_sub_u32 s56, s62, 1
  s_min_u32 s70, s70, s56
  s_lshl_b32 s70, s70, 16
  s_add_u32 s70, s70, 0x6800000
  buffer_load_dword v6, v5, s[4:7], s70 offen sc1
  s_lshl_b32 s65, s50, 14
  s_add_u32 s63, s61, 0
  s_sub_u32 s56, s62, 1
  s_min_u32 s63, s63, s56
  s_lshl_b32 s63, s63, 16
  s_add_u32 s63, s63, 0x6800000
  s_add_u32 m0, s65, 0
  s_nop 0
  buffer_load_dwordx4 v8, s[4:7], s63 offen sc1 lds
  buffer_load_dwordx4 v8, s[4:7], s63 offen offset:1024 sc1 lds
  s_add_u32 m0, s65, 2048
  s_nop 0
  buffer_load_dwordx4 v9, s[4:7], s63 offen sc1 lds
  buffer_load_dwordx4 v9, s[4:7], s63 offen offset:1024 sc1 lds
  s_add_u32 m0, s65, 4096
  s_nop 0
  buffer_load_dwordx4 v10, s[4:7], s63 offen sc1 lds
  buffer_load_dwordx4 v10, s[4:7], s63 offen offset:1024 sc1 lds
  s_add_u32 m0, s65, 6144
  s_nop 0
  buffer_load_dwordx4 v11, s[4:7], s63 offen sc1 lds
  buffer_load_dwordx4 v11, s[4:7], s63 offen offset:1024 sc1 lds
  s_add_u32 m0, s65, 8192
  s_nop 0
  buffer_load_dwordx4 v12, s[4:7], s63 offen sc1 lds
  buffer_load_dwordx4 v12, s[4:7], s63 offen offset:1024 sc1 lds
  s_add_u32 m0, s65, 10240
  s_nop 0
  buffer_load_dwordx4 v13, s[4:7], s63 offen sc1 lds
  buffer_load_dwordx4 v13, s[4:7], s63 offen offset:1024 sc1 lds
  s_add_u32 m0, s65, 12288
  s_nop 0
  buffer_load_dwordx4 v14, s[4:7], s63 offen sc1 lds
  buffer_load_dwordx4 v14, s[4:7], s63 offen offset:1024 sc1 lds
  s_add_u32 m0, s65, 14336
  s_nop 0
  buffer_load_dwordx4 v15, s[4:7], s63 offen sc1 lds
  buffer_load_dwordx4 v15, s[4:7], s63 offen offset:1024 sc1 lds
  s_waitcnt vmcnt(0)
L_b3:
  s_waitcnt vmcnt(3)
  s_barrier
  ds_read_b128 v[36:39], v16 offset:0
  ds_read_b128 v[40:43], v16 offset:32768
  ds_read_b128 v[44:47], v17 offset:1024
  ds_read_b128 v[48:51], v17 offset:33792
  ds_read_b128 v[52:55], v18 offset:2048
  ds_read_b128 v[56:59], v18 offset:34816
  s_xor_b32 s65, s65, 0x10000
  s_add_u32 s63, s61, 1
  s_sub_u32 s56, s62, 1
  s_min_u32 s63, s63, s56
  s_lshl_b32 s63, s63, 16
  s_add_u32 s63, s63, 0x6800000
  s_add_u32 s70, s61, 3
  s_sub_u32 s56, s62, 1
  s_min_u32 s70, s70, s56
  s_lshl_b32 s70, s70, 16
  s_add_u32 s70, s70, 0x6800000
  s_waitcnt lgkmcnt(4)
  v_mfma_f32_16x16x32_bf16 v[20:23], a[0:3], v[36:39], 0
  ds_read_b128 v[60:63], v19 offset:3072
  v_mfma_f32_16x16x32_bf16 v[24:27], a[128:131], v[36:39], 0
  ds_read_b128 v[64:67], v19 offset:35840
  s_add_u32 m0, s65, 0
  v_mfma_f32_16x16x32_bf16 v[28:31], a[0:3], v[40:43], 0
  buffer_load_dwordx4 v8, s[4:7], s63 offen sc1 lds
  v_mfma_f32_16x16x32_bf16 v[32:35], a[128:131], v[40:43], 0
  s_waitcnt lgkmcnt(4)
  v_mfma_f32_16x16x32_bf16 v[20:23], a[4:7], v[44:47], v[20:23]
  ds_read_b128 v[36:39], v16 offset:4096
  v_mfma_f32_16x16x32_bf16 v[24:27], a[132:135], v[44:47], v[24:27]
  ds_read_b128 v[40:43], v16 offset:36864
  v_mfma_f32_16x16x32_bf16 v[28:31], a[4:7], v[48:51], v[28:31]
  buffer_load_dwordx4 v8, s[4:7], s63 offen offset:1024 sc1 lds
  v_mfma_f32_16x16x32_bf16 v[32:35], a[132:135], v[48:51], v[32:35]
  s_waitcnt lgkmcnt(4)
  v_mfma_f32_16x16x32_bf16 v[20:23], a[8:11], v[52:55], v[20:23]
  ds_read_b128 v[44:47], v17 offset:5120
  v_mfma_f32_16x16x32_bf16 v[24:27], a[136:139], v[52:55], v[24:27]
  ds_read_b128 v[48:51], v17 offset:37888
  s_add_u32 m0, s65, 2048
  v_mfma_f32_16x16x32_bf16 v[28:31], a[8:11], v[56:59], v[28:31]
  buffer_load_dwordx4 v9, s[4:7], s63 offen sc1 lds
  v_mfma_f32_16x16x32_bf16 v[32:35], a[136:139], v[56:59], v[32:35]
  s_waitcnt lgkmcnt(4)
  v_mfma_f32_16x16x32_bf16 v[20:23], a[12:15], v[60:63], v[20:23]
  ds_read_b128 v[52:55], v18 offset:6144
  v_mfma_f32_16x16x32_bf16 v[24:27], a[140:143], v[60:63], v[24:27]
  ds_read_b128 v[56:59], v18 offset:38912
  v_mfma_f32_16x16x32_bf16 v[28:31], a[12:15], v[64:67], v[28:31]
  buffer_load_dwordx4 v9, s[4:7], s63 offen offset:1024 sc1 lds
  v_mfma_f32_16x16x32_bf16 v[32:35], a[140:143], v[64:67], v[32:35]
  s_waitcnt lgkmcnt(4)
  v_mfma_f32_16x16x32_bf16 v[20:23], a[16:19], v[36:39], v[20:23]
  ds_read_b128 v[60:63], v19 offset:7168
  v_mfma_f32_16x16x32_bf16 v[24:27], a[144:147], v[36:39], v[24:27]
  ds_read_b128 v[64:67], v19 offset:39936
  s_add_u32 m0, s65, 4096
  v_mfma_f32_16x16x32_bf16 v[28:31], a[16:19], v[40:43], v[28:31]
  buffer_load_dwordx4 v10, s[4:7], s63 offen sc1 lds
  v_mfma_f32_16x16x32_bf16 v[32:35], a[144:147], v[40:43], v[32:35]
  s_waitcnt lgkmcnt(4)
  v_mfma_f32_16x16x32_bf16 v[20:23], a[20:23], v[44:47], v[20:23]
  ds_read_b128 v[36:39], v16 offset:8192
  v_mfma_f32_16x16x32_bf16 v[24:27], a[148:151], v[44:47], v[24:27]
  ds_read_b128 v[40:43], v16 offset:40960
  v_mfma_f32_16x16x32_bf16 v[28:31], a[20:23], v[48:51], v[28:31]
  buffer_load_dwordx4 v10, s[4:7], s63 offen offset:1024 sc1 lds
  v_mfma_f32_16x16x32_bf16 v[32:35], a[148:151], v[48:51], v[32:35]
  s_waitcnt lgkmcnt(4)
  v_mfma_f32_16x16x32_bf16 v[20:23], a[24:27], v[52:55], v[20:23]
  ds_read_b128 v[44:47], v17 offset:9216
  v_mfma_f32_16x16x32_bf16 v[24:27], a[152:155], v[52:55], v[24:27]
  ds_read_b128 v[48:51], v17 offset:41984
  s_add_u32 m0, s65, 6144
  v_mfma_f32_16x16x32_bf16 v[28:31], a[24:27], v[56:59], v[28:31]
  buffer_load_dwordx4 v11, s[4:7], s63 offen sc1 lds
  v_mfma_f32_16x16x32_bf16 v[32:35], a[152:155], v[56:59], v[32:35]
  s_waitcnt lgkmcnt(4)
  v_mfma_f32_16x16x32_bf16 v[20:23], a[28:31], v[60:63], v[20:23]
  ds_read_b128 v[52:55], v18 offset:10240
  v_mfma_f32_16x16x32_bf16 v[24:27], a[156:159], v[60:63], v[24:27]
  ds_read_b128 v[56:59], v18 offset:43008
  v_mfma_f32_16x16x32_bf16 v[28:31], a[28:31], v[64:67], v[28:31]
  buffer_load_dwordx4 v11, s[4:7], s63 offen offset:1024 sc1 lds
  v_mfma_f32_16x16x32_bf16 v[32:35], a[156:159], v[64:67], v[32:35]
  s_waitcnt lgkmcnt(4)
  v_mfma_f32_16x16x32_bf16 v[20:23], a[32:35], v[36:39], v[20:23]
  ds_read_b128 v[60:63], v19 offset:11264
  v_mfma_f32_16x16x32_bf16 v[24:27], a[160:163], v[36:39], v[24:27]
  ds_read_b128 v[64:67], v19 offset:44032
  s_add_u32 m0, s65, 8192
  v_mfma_f32_16x16x32_bf16 v[28:31], a[32:35], v[40:43], v[28:31]
  buffer_load_dwordx4 v12, s[4:7], s63 offen sc1 lds
  v_mfma_f32_16x16x32_bf16 v[32:35], a[160:163], v[40:43], v[32:35]
  s_waitcnt lgkmcnt(4)
  v_mfma_f32_16x16x32_bf16 v[20:23], a[36:39], v[44:47], v[20:23]
  ds_read_b128 v[36:39], v16 offset:12288
  v_mfma_f32_16x16x32_bf16 v[24:27], a[164:167], v[44:47], v[24:27]
  ds_read_b128 v[40:43], v16 offset:45056
  v_mfma_f32_16x16x32_bf16 v[28:31], a[36:39], v[48:51], v[28:31]
  buffer_load_dwordx4 v12, s[4:7], s63 offen offset:1024 sc1 lds
  v_mfma_f32_16x16x32_bf16 v[32:35], a[164:167], v[48:51], v[32:35]
  s_waitcnt lgkmcnt(4)
  v_mfma_f32_16x16x32_bf16 v[20:23], a[40:43], v[52:55], v[20:23]
  ds_read_b128 v[44:47], v17 offset:13312
  v_mfma_f32_16x16x32_bf16 v[24:27], a[168:171], v[52:55], v[24:27]
  ds_read_b128 v[48:51], v17 offset:46080
  s_add_u32 m0, s65, 10240
  v_mfma_f32_16x16x32_bf16 v[28:31], a[40:43], v[56:59], v[28:31]
  buffer_load_dwordx4 v13, s[4:7], s63 offen sc1 lds
  v_mfma_f32_16x16x32_bf16 v[32:35], a[168:171], v[56:59], v[32:35]
  s_waitcnt lgkmcnt(4)
  v_mfma_f32_16x16x32_bf16 v[20:23], a[44:47], v[60:63], v[20:23]
  ds_read_b128 v[52:55], v18 offset:14336
  v_mfma_f32_16x16x32_bf16 v[24:27], a[172:175], v[60:63], v[24:27]
  ds_read_b128 v[56:59], v18 offset:47104
  v_mfma_f32_16x16x32_bf16 v[28:31], a[44:47], v[64:67], v[28:31]
  buffer_load_dwordx4 v13, s[4:7], s63 offen offset:1024 sc1 lds
  v_mfma_f32_16x16x32_bf16 v[32:35], a[172:175], v[64:67], v[32:35]
  s_waitcnt lgkmcnt(4)
  v_mfma_f32_16x16x32_bf16 v[20:23], a[48:51], v[36:39], v[20:23]
  ds_read_b128 v[60:63], v19 offset:15360
  v_mfma_f32_16x16x32_bf16 v[24:27], a[176:179], v[36:39], v[24:27]
  ds_read_b128 v[64:67], v19 offset:48128
  s_add_u32 m0, s65, 12288
  v_mfma_f32_16x16x32_bf16 v[28:31], a[48:51], v[40:43], v[28:31]
  buffer_load_dwordx4 v14, s[4:7], s63 offen sc1 lds
  v_mfma_f32_16x16x32_bf16 v[32:35], a[176:179], v[40:43], v[32:35]
  s_waitcnt lgkmcnt(4)
  v_mfma_f32_16x16x32_bf16 v[20:23], a[52:55], v[44:47], v[20:23]
  ds_read_b128 v[36:39], v16 offset:16384
  v_mfma_f32_16x16x32_bf16 v[24:27], a[180:183], v[44:47], v[24:27]
  ds_read_b128 v[40:43], v16 offset:49152
  v_mfma_f32_16x16x32_bf16 v[28:31], a[52:55], v[48:51], v[28:31]
  buffer_load_dwordx4 v14, s[4:7], s63 offen offset:1024 sc1 lds
  v_mfma_f32_16x16x32_bf16 v[32:35], a[180:183], v[48:51], v[32:35]
  s_waitcnt lgkmcnt(4)
  v_mfma_f32_16x16x32_bf16 v[20:23], a[56:59], v[52:55], v[20:23]
  ds_read_b128 v[44:47], v17 offset:17408
  v_mfma_f32_16x16x32_bf16 v[24:27], a[184:187], v[52:55], v[24:27]
  ds_read_b128 v[48:51], v17 offset:50176
  s_add_u32 m0, s65, 14336
  v_mfma_f32_16x16x32_bf16 v[28:31], a[56:59], v[56:59], v[28:31]
  buffer_load_dwordx4 v15, s[4:7], s63 offen sc1 lds
  v_mfma_f32_16x16x32_bf16 v[32:35], a[184:187], v[56:59], v[32:35]
  s_waitcnt lgkmcnt(4)
  v_mfma_f32_16x16x32_bf16 v[20:23], a[60:63], v[60:63], v[20:23]
  ds_read_b128 v[52:55], v18 offset:18432
  v_mfma_f32_16x16x32_bf16 v[24:27], a[188:191], v[60:63], v[24:27]
  ds_read_b128 v[56:59], v18 offset:51200
  v_mfma_f32_16x16x32_bf16 v[28:31], a[60:63], v[64:67], v[28:31]
  buffer_load_dwordx4 v15, s[4:7], s63 offen offset:1024 sc1 lds
  v_mfma_f32_16x16x32_bf16 v[32:35], a[188:191], v[64:67], v[32:35]
  s_waitcnt lgkmcnt(4)
  v_mfma_f32_16x16x32_bf16 v[20:23], a[64:67], v[36:39], v[20:23]
  ds_read_b128 v[60:63], v19 offset:19456
  v_mfma_f32_16x16x32_bf16 v[24:27], a[192:195], v[36:39], v[24:27]
  ds_read_b128 v[64:67], v19 offset:52224
  v_mfma_f32_16x16x32_bf16 v[28:31], a[64:67], v[40:43], v[28:31]
  buffer_load_dword v6, v5, s[4:7], s70 offen sc1
  v_mfma_f32_16x16x32_bf16 v[32:35], a[192:195], v[40:43], v[32:35]
  s_waitcnt lgkmcnt(4)
  v_mfma_f32_16x16x32_bf16 v[20:23], a[68:71], v[44:47], v[20:23]
  ds_read_b128 v[36:39], v16 offset:20480
  v_mfma_f32_16x16x32_bf16 v[24:27], a[196:199], v[44:47], v[24:27]
  ds_read_b128 v[40:43], v16 offset:53248
  v_mfma_f32_16x16x32_bf16 v[28:31], a[68:71], v[48:51], v[28:31]
  buffer_store_dwordx4 v[68:71], v7, s[16:19], s71 offen
  s_add_u32 s71, s71, 65536
  v_mfma_f32_16x16x32_bf16 v[32:35], a[196:199], v[48:51], v[32:35]
  s_waitcnt lgkmcnt(4)
  v_mfma_f32_16x16x32_bf16 v[20:23], a[72:75], v[52:55], v[20:23]
  ds_read_b128 v[44:47], v17 offset:21504
  v_mfma_f32_16x16x32_bf16 v[24:27], a[200:203], v[52:55], v[24:27]
  ds_read_b128 v[48:51], v17 offset:54272
  v_mfma_f32_16x16x32_bf16 v[28:31], a[72:75], v[56:59], v[28:31]
  buffer_store_dwordx4 v[72:75], v7, s[16:19], s71 offen
  v_mfma_f32_16x16x32_bf16 v[32:35], a[200:203], v[56:59], v[32:35]
  s_waitcnt lgkmcnt(4)
  v_mfma_f32_16x16x32_bf16 v[20:23], a[76:79], v[60:63], v[20:23]
  ds_read_b128 v[52:55], v18 offset:22528
  v_mfma_f32_16x16x32_bf16 v[24:27], a[204:207], v[60:63], v[24:27]
  ds_read_b128 v[56:59], v18 offset:55296
  v_mfma_f32_16x16x32_bf16 v[28:31], a[76:79], v[64:67], v[28:31]
  v_mfma_f32_16x16x32_bf16 v[32:35], a[204:207], v[64:67], v[32:35]
  s_waitcnt lgkmcnt(4)
  v_mfma_f32_16x16x32_bf16 v[20:23], a[80:83], v[36:39], v[20:23]
  ds_read_b128 v[60:63], v19 offset:23552
  v_mfma_f32_16x16x32_bf16 v[24:27], a[208:211], v[36:39], v[24:27]
  ds_read_b128 v[64:67], v19 offset:56320
  v_mfma_f32_16x16x32_bf16 v[28:31], a[80:83], v[40:43], v[28:31]
  v_mfma_f32_16x16x32_bf16 v[32:35], a[208:211], v[40:43], v[32:35]
  s_waitcnt lgkmcnt(4)
  v_mfma_f32_16x16x32_bf16 v[20:23], a[84:87], v[44:47], v[20:23]
  ds_read_b128 v[36:39], v16 offset:24576
  v_mfma_f32_16x16x32_bf16 v[24:27], a[212:215], v[44:47], v[24:27]
  ds_read_b128 v[40:43], v16 offset:57344
  v_mfma_f32_16x16x32_bf16 v[28:31], a[84:87], v[48:51], v[28:31]
  v_mfma_f32_16x16x32_bf16 v[32:35], a[212:215], v[48:51], v[32:35]
  s_waitcnt lgkmcnt(4)
  v_mfma_f32_16x16x32_bf16 v[20:23], a[88:91], v[52:55], v[20:23]
  ds_read_b128 v[44:47], v17 offset:25600
  v_mfma_f32_16x16x32_bf16 v[24:27], a[216:219], v[52:55], v[24:27]
  ds_read_b128 v[48:51], v17 offset:58368
  v_mfma_f32_16x16x32_bf16 v[28:31], a[88:91], v[56:59], v[28:31]
  v_mfma_f32_16x16x32_bf16 v[32:35], a[216:219], v[56:59], v[32:35]
  s_waitcnt lgkmcnt(4)
  v_mfma_f32_16x16x32_bf16 v[20:23], a[92:95], v[60:63], v[20:23]
  ds_read_b128 v[52:55], v18 offset:26624
  v_mfma_f32_16x16x32_bf16 v[24:27], a[220:223], v[60:63], v[24:27]
  ds_read_b128 v[56:59], v18 offset:59392
  v_mfma_f32_16x16x32_bf16 v[28:31], a[92:95], v[64:67], v[28:31]
  v_mfma_f32_16x16x32_bf16 v[32:35], a[220:223], v[64:67], v[32:35]
  s_waitcnt lgkmcnt(4)
  v_mfma_f32_16x16x32_bf16 v[20:23], a[96:99], v[36:39], v[20:23]
  ds_read_b128 v[60:63], v19 offset:27648
  v_mfma_f32_16x16x32_bf16 v[24:27], a[224:227], v[36:39], v[24:27]
  ds_read_b128 v[64:67], v19 offset:60416
  v_mfma_f32_16x16x32_bf16 v[28:31], a[96:99], v[40:43], v[28:31]
  v_mfma_f32_16x16x32_bf16 v[32:35], a[224:227], v[40:43], v[32:35]
  s_waitcnt lgkmcnt(4)
  v_mfma_f32_16x16x32_bf16 v[20:23], a[100:103], v[44:47], v[20:23]
  ds_read_b128 v[36:39], v16 offset:28672
  v_mfma_f32_16x16x32_bf16 v[24:27], a[228:231], v[44:47], v[24:27]
  ds_read_b128 v[40:43], v16 offset:61440
  v_mfma_f32_16x16x32_bf16 v[28:31], a[100:103], v[48:51], v[28:31]
  v_mfma_f32_16x16x32_bf16 v[32:35], a[228:231], v[48:51], v[32:35]
  s_waitcnt lgkmcnt(4)
  v_mfma_f32_16x16x32_bf16 v[20:23], a[104:107], v[52:55], v[20:23]
  ds_read_b128 v[44:47], v17 offset:29696
  v_mfma_f32_16x16x32_bf16 v[24:27], a[232:235], v[52:55], v[24:27]
  ds_read_b128 v[48:51], v17 offset:62464
  v_mfma_f32_16x16x32_bf16 v[28:31], a[104:107], v[56:59], v[28:31]
  v_mfma_f32_16x16x32_bf16 v[32:35], a[232:235], v[56:59], v[32:35]
  s_waitcnt lgkmcnt(4)
  v_mfma_f32_16x16x32_bf16 v[20:23], a[108:111], v[60:63], v[20:23]
  ds_read_b128 v[52:55], v18 offset:30720
  v_mfma_f32_16x16x32_bf16 v[24:27], a[236:239], v[60:63], v[24:27]
  ds_read_b128 v[56:59], v18 offset:63488
  v_mfma_f32_16x16x32_bf16 v[28:31], a[108:111], v[64:67], v[28:31]
  v_mfma_f32_16x16x32_bf16 v[32:35], a[236:239], v[64:67], v[32:35]
  s_waitcnt lgkmcnt(4)
  v_mfma_f32_16x16x32_bf16 v[20:23], a[112:115], v[36:39], v[20:23]
  ds_read_b128 v[60:63], v19 offset:31744
  v_mfma_f32_16x16x32_bf16 v[24:27], a[240:243], v[36:39], v[24:27]
  ds_read_b128 v[64:67], v19 offset:64512
  v_mfma_f32_16x16x32_bf16 v[28:31], a[112:115], v[40:43], v[28:31]
  v_mfma_f32_16x16x32_bf16 v[32:35], a[240:243], v[40:43], v[32:35]
  s_waitcnt lgkmcnt(4)
  v_mfma_f32_16x16x32_bf16 v[20:23], a[116:119], v[44:47], v[20:23]
  v_xor_b32 v16, 0x10000, v16
  v_mfma_f32_16x16x32_bf16 v[24:27], a[244:247], v[44:47], v[24:27]
  v_mfma_f32_16x16x32_bf16 v[28:31], a[116:119], v[48:51], v[28:31]
  v_mfma_f32_16x16x32_bf16 v[32:35], a[244:247], v[48:51], v[32:35]
  s_waitcnt lgkmcnt(2)
  v_mfma_f32_16x16x32_bf16 v[20:23], a[120:123], v[52:55], v[20:23]
  v_xor_b32 v17, 0x10000, v17
  v_mfma_f32_16x16x32_bf16 v[24:27], a[248:251], v[52:55], v[24:27]
  v_mfma_f32_16x16x32_bf16 v[28:31], a[120:123], v[56:59], v[28:31]
  v_mfma_f32_16x16x32_bf16 v[32:35], a[248:251], v[56:59], v[32:35]
  s_waitcnt lgkmcnt(0)
  v_mfma_f32_16x16x32_bf16 v[20:23], a[124:127], v[60:63], v[20:23]
  v_xor_b32 v18, 0x10000, v18
  v_mfma_f32_16x16x32_bf16 v[24:27], a[252:255], v[60:63], v[24:27]
  v_xor_b32 v19, 0x10000, v19
  v_mfma_f32_16x16x32_bf16 v[28:31], a[124:127], v[64:67], v[28:31]
  v_mfma_f32_16x16x32_bf16 v[32:35], a[252:255], v[64:67], v[32:35]
  s_lshl_b32 s71, s61, 17
  v_mov_b32 v7, v159
  s_nop 0
  v_cvt_pk_bf16_f32 v68, v20, v21
  v_cvt_pk_bf16_f32 v69, v22, v23
  v_cvt_pk_bf16_f32 v70, v24, v25
  v_cvt_pk_bf16_f32 v71, v26, v27
  v_cvt_pk_bf16_f32 v72, v28, v29
  v_cvt_pk_bf16_f32 v73, v30, v31
  v_cvt_pk_bf16_f32 v74, v32, v33
  v_cvt_pk_bf16_f32 v75, v34, v35
  s_add_u32 s61, s61, 1
  s_cmp_lt_u32 s61, s62
  s_cbranch_scc1 L_b3
  buffer_store_dwordx4 v[68:71], v7, s[16:19], s71 offen
  s_add_u32 s71, s71, 65536
  buffer_store_dwordx4 v[72:75], v7, s[16:19], s71 offen
  s_branch L_end
L_g3:
  v_lshlrev_b32 v1, 4, v0
  s_mul_i32 s67, s52, 0x202000
  s_cmp_lg_u32 s51, 2
  s_cbranch_scc1 Lcal_259
  s_cmp_eq_u32 s100, 0
  s_cbranch_scc1 Lcal_259
  s_cmp_lg_u32 s50, 0
  s_cbranch_scc1 Lcal_259
  s_lshl_b32 s63, s52, 8
  s_add_u32 s63, s63, 0x2b0000
  s_add_u32 s64, s63, 8192
  s_mov_b32 s74, -1
  s_mov_b32 s75, -1
  s_mov_b32 s58, 0
  s_mov_b64 exec, 1
Lcal_260:
  s_waitcnt vmcnt(0)
  s_memtime s[70:71]
  s_waitcnt lgkmcnt(0)
  buffer_store_dword v0, off, s[4:7], s63 sc1
  s_waitcnt vmcnt(0)
  s_memtime s[72:73]
  s_waitcnt lgkmcnt(0)
  s_sub_u32 s56, s72, s70
  s_min_u32 s74, s74, s56
  s_waitcnt vmcnt(0)
  s_memtime s[70:71]
  s_waitcnt lgkmcnt(0)
  buffer_store_dword v0, off, s[4:7], s64 sc1
  s_waitcnt vmcnt(0)
  s_memtime s[72:73]
  s_waitcnt lgkmcnt(0)
  s_sub_u32 s56, s72, s70
  s_min_u32 s75, s75, s56
  s_add_u32 s58, s58, 1
  s_cmp_lt_u32 s58, 5
  s_cbranch_scc1 Lcal_260
  s_cmp_lt_u32 s75, s74
  s_cselect_b32 s56, 0x101, 1
  v_mov_b32 v126, s56
  buffer_atomic_add v126, off, s[20:23], 0 offset:4 sc1
  s_mov_b64 exec, -1
Lcal_259:
  s_barrier
  s_cmp_eq_u32 s50, 0
  s_cselect_b32 s8, s34, s8
  s_cselect_b32 s9, s35, s9
  s_cmp_eq_u32 s50, 1
  s_cselect_b32 s8, s28, s8
  s_cselect_b32 s9, s29, s9
  s_cmp_eq_u32 s50, 2
  s_cselect_b32 s8, s30, s8
  s_cselect_b32 s9, s31, s9
  s_cmp_eq_u32 s50, 3
  s_cselect_b32 s8, s32, s8
  s_cselect_b32 s9, s33, s9
  s_sub_u32 s56, s51, 2
  s_lshl_b32 s56, s56, 5
  s_add_u32 s56, s56, s52
  s_lshl_b32 s56, s56, 16
  v_lshlrev_b32 v127, 10, v0
  buffer_load_dword v6, v127, s[8:11], s56 offen offset:384
  s_sub_u32 s56, s51, 2
  s_lshl_b32 s56, s56, 5
  s_add_u32 s56, s56, s52
  s_lshl_b32 s56, s56, 2
  s_add_u32 s56, s56, s50
  s_lshl_b32 s56, s56, 10
  v_lshl_add_u32 v68, v0, 4, s56
  v_mov_b32 v69, 0x80000000
  v_mov_b32 v72, 0
  v_mov_b32 v73, 0
  v_mov_b32 v74, 0
  v_mov_b32 v75, 0
  v_cmp_gt_u32 vcc, 0x9000, v68
  s_mov_b32 s56, 0x0
  s_nop 0
  v_cndmask_b32 v70, v69, v68, vcc
  buffer_store_dwordx4 v[72:75], v70, s[4:7], s56 offen sc1
  s_nop 1
  v_mov_b32 v72, -1
  v_mov_b32 v73, -1
  v_mov_b32 v74, -1
  v_mov_b32 v75, -1
  v_cmp_gt_u32 vcc, 0x90000, v68
  s_mov_b32 s56, 0x90000
  s_nop 0
  v_cndmask_b32 v70, v69, v68, vcc
  buffer_store_dwordx4 v[72:75], v70, s[4:7], s56 offen sc1
  v_cmp_gt_u32 vcc, 0x10000, v68
  s_mov_b32 s56, 0x110000
  s_nop 0
  v_cndmask_b32 v70, v69, v68, vcc
  buffer_store_dwordx4 v[72:75], v70, s[4:7], s56 offen sc1
  s_nop 1
  v_mov_b32 v72, -1
  v_mov_b32 v73, -1
  v_mov_b32 v74, -1
  v_mov_b32 v75, -1
  v_cmp_gt_u32 vcc, 0xa0000, v68
  s_mov_b32 s56, 0x200000
  s_nop 0
  v_cndmask_b32 v70, v69, v68, vcc
  buffer_store_dwordx4 v[72:75], v70, s[4:7], s56 offen sc1
  v_cmp_gt_u32 vcc, 0x20000, v68
  s_mov_b32 s56, 0x280000
  s_nop 0
  v_cndmask_b32 v70, v69, v68, vcc
  buffer_store_dwordx4 v[72:75], v70, s[4:7], s56 offen sc1
  s_waitcnt vmcnt(0)
  s_barrier
  s_cmp_lg_u32 s50, 0
  s_cbranch_scc1 Lar_261
  s_cmp_eq_u32 s100, 0
  s_cselect_b32 s56, 0, 128
  v_mov_b32 v68, 1
  s_mov_b64 exec, 1
  buffer_atomic_add v68, off, s[20:23], s56 sc1
  s_mov_b64 exec, -1
Lar_261:
  s_branch Lwa_265
Lwa_262:
  v_lshlrev_b32 v69, 2, v0
  buffer_load_dword v68, v69, s[20:23], 0 offen sc1
  s_waitcnt vmcnt(0)
Lwa_266:
  s_cmp_eq_u32 s100, 0
  s_cbranch_scc1 Lwa_264
  s_mov_b32 s56, 0
  v_readlane_b32 s57, v68, 8
  s_add_u32 s56, s56, s57
  v_readlane_b32 s57, v68, 9
  s_add_u32 s56, s56, s57
  v_readlane_b32 s57, v68, 10
  s_add_u32 s56, s56, s57
  v_readlane_b32 s57, v68, 11
  s_add_u32 s56, s56, s57
  v_readlane_b32 s57, v68, 12
  s_add_u32 s56, s56, s57
  v_readlane_b32 s57, v68, 13
  s_add_u32 s56, s56, s57
  v_readlane_b32 s57, v68, 14
  s_add_u32 s56, s56, s57
  v_readlane_b32 s57, v68, 15
  s_add_u32 s56, s56, s57
  v_readlane_b32 s57, v68, 16
  s_add_u32 s56, s56, s57
  v_readlane_b32 s57, v68, 40
  s_add_u32 s56, s56, s57
  v_readlane_b32 s57, v68, 41
  s_add_u32 s56, s56, s57
  v_readlane_b32 s57, v68, 42
  s_add_u32 s56, s56, s57
  v_readlane_b32 s57, v68, 43
  s_add_u32 s56, s56, s57
  v_readlane_b32 s57, v68, 44
  s_add_u32 s56, s56, s57
  v_readlane_b32 s57, v68, 45
  s_add_u32 s56, s56, s57
  v_readlane_b32 s57, v68, 46
  s_add_u32 s56, s56, s57
  v_readlane_b32 s57, v68, 47
  s_add_u32 s56, s56, s57
  v_readlane_b32 s57, v68, 48
  s_add_u32 s56, s56, s57
  s_cmp_lt_u32 s56, 256
  s_cbranch_scc1 Lwa_265
  s_lshr_b32 s58, s100, 2
  v_readlane_b32 s56, v68, s58
  s_add_u32 s58, s58, 32
  v_readlane_b32 s57, v68, s58
  s_add_u32 s56, s56, s57
  s_cmp_eq_u32 s58, 48
  s_cselect_b32 s56, 0, s56
  s_cmp_lt_u32 s56, 256
  s_cbranch_scc1 L_restart
  v_readlane_b32 s56, v68, 32
  s_cmp_ge_u32 s56, 128
  s_cbranch_scc1 Lwa_263
  s_branch Lwa_265
Lwa_264:
  v_readlane_b32 s56, v68, 0
  s_cmp_ge_u32 s56, 256
  s_cbranch_scc1 Lwa_263
Lwa_265:
  s_sleep 127
  s_add_u32 s55, s55, 1
  s_bitcmp1_b32 s55, 21
  s_cbranch_scc1 L_abort
  s_branch Lwa_262
Lwa_263:
  s_lshl_b32 s56, s52, 10
  s_add_u32 s56, s56, 768
  v_mov_b32 v127, s56
Lwf_268:
  buffer_load_dword v126, v127, s[4:7], 0 offen sc1
  s_waitcnt vmcnt(0)
  v_cmp_gt_u32 vcc, 3, v126
  s_cbranch_vccz Lwf_269
  s_sleep 8
  s_add_u32 s55, s55, 1
  s_bitcmp1_b32 s55, 21
  s_cbranch_scc1 L_abort
  s_branch Lwf_268
Lwf_269:
L_g3_help:
  s_mov_b32 s8, s34
  s_mov_b32 s9, s35
  s_mov_b32 s10, 0x800000
  s_mov_b32 s11, 0x20000
  v_lshrrev_b32 v126, 2, v0
  v_and_b32 v127, 3, v0
  v_lshlrev_b32 v2, 11, v126
  v_lshl_add_u32 v2, v127, 4, v2
  v_lshlrev_b32 v4, 6, v126
  v_lshl_add_u32 v4, v127, 3, v4
  s_lshl_b32 s56, s50, 15
  v_add_u32 v4, s56, v4
  s_lshl_b32 s60, s50, 21
  s_lshl_b32 s56, s52, 6
  s_add_u32 s60, s60, s56
  s_add_u32 s60, s60, 0
  s_lshl_b32 s56, s50, 15
  s_add_u32 s56, s56, 0
  s_mov_b32 s58, 0
Ldn_270:
  s_and_b32 s59, s52, 1
  s_lshl_b32 s59, s59, 3
  s_xor_b32 s59, s59, s58
  s_lshl_b32 s57, s59, 10
  s_add_u32 m0, s56, s57
  s_lshl_b32 s57, s59, 15
  s_add_u32 s57, s57, s60
  buffer_load_dwordx4 v2, s[8:11], s57 offen lds
  s_waitcnt vmcnt(0)
  s_add_u32 s58, s58, 1
  s_cmp_lg_u32 s58, 16
  s_cbranch_scc1 Ldn_270
  s_lshl_b32 s60, s50, 21
  s_lshl_b32 s56, s52, 6
  s_add_u32 s60, s60, s56
  s_add_u32 s60, s60, 524288
  s_lshl_b32 s56, s50, 15
  s_add_u32 s56, s56, 16384
  s_mov_b32 s58, 0
Ldn_271:
  s_and_b32 s59, s52, 1
  s_lshl_b32 s59, s59, 3
  s_xor_b32 s59, s59, s58
  s_lshl_b32 s57, s59, 10
  s_add_u32 m0, s56, s57
  s_lshl_b32 s57, s59, 15
  s_add_u32 s57, s57, s60
  buffer_load_dwordx4 v2, s[8:11], s57 offen lds
  s_waitcnt vmcnt(0)
  s_add_u32 s58, s58, 1
  s_cmp_lg_u32 s58, 16
  s_cbranch_scc1 Ldn_271
  s_waitcnt vmcnt(16)
  s_barrier
  ds_read_b64_tr_b16 a[0:1], v4 offset:0
  ds_read_b64_tr_b16 a[2:3], v4 offset:1024
  ds_read_b64_tr_b16 a[128:129], v4 offset:32
  ds_read_b64_tr_b16 a[130:131], v4 offset:1056
  ds_read_b64_tr_b16 a[4:5], v4 offset:2048
  ds_read_b64_tr_b16 a[6:7], v4 offset:3072
  ds_read_b64_tr_b16 a[132:133], v4 offset:2080
  ds_read_b64_tr_b16 a[134:135], v4 offset:3104
  ds_read_b64_tr_b16 a[8:9], v4 offset:4096
  ds_read_b64_tr_b16 a[10:11], v4 offset:5120
  ds_read_b64_tr_b16 a[136:137], v4 offset:4128
  ds_read_b64_tr_b16 a[138:139], v4 offset:5152
  ds_read_b64_tr_b16 a[12:13], v4 offset:6144
  ds_read_b64_tr_b16 a[14:15], v4 offset:7168
  ds_read_b64_tr_b16 a[140:141], v4 offset:6176
  ds_read_b64_tr_b16 a[142:143], v4 offset:7200
  ds_read_b64_tr_b16 a[16:17], v4 offset:8192
  ds_read_b64_tr_b16 a[18:19], v4 offset:9216
  ds_read_b64_tr_b16 a[144:145], v4 offset:8224
  ds_read_b64_tr_b16 a[146:147], v4 offset:9248
  ds_read_b64_tr_b16 a[20:21], v4 offset:10240
  ds_read_b64_tr_b16 a[22:23], v4 offset:11264
  ds_read_b64_tr_b16 a[148:149], v4 offset:10272
  ds_read_b64_tr_b16 a[150:151], v4 offset:11296
  ds_read_b64_tr_b16 a[24:25], v4 offset:12288
  ds_read_b64_tr_b16 a[26:27], v4 offset:13312
  ds_read_b64_tr_b16 a[152:153], v4 offset:12320
  ds_read_b64_tr_b16 a[154:155], v4 offset:13344
  ds_read_b64_tr_b16 a[28:29], v4 offset:14336
  ds_read_b64_tr_b16 a[30:31], v4 offset:15360
  ds_read_b64_tr_b16 a[156:157], v4 offset:14368
  ds_read_b64_tr_b16 a[158:159], v4 offset:15392
  s_waitcnt lgkmcnt(0)
  s_barrier
  s_lshl_b32 s60, s50, 21
  s_lshl_b32 s56, s52, 6
  s_add_u32 s60, s60, s56
  s_add_u32 s60, s60, 1048576
  s_lshl_b32 s56, s50, 15
  s_add_u32 s56, s56, 0
  s_mov_b32 s58, 0
Ldn_272:
  s_and_b32 s59, s52, 1
  s_lshl_b32 s59, s59, 3
  s_xor_b32 s59, s59, s58
  s_lshl_b32 s57, s59, 10
  s_add_u32 m0, s56, s57
  s_lshl_b32 s57, s59, 15
  s_add_u32 s57, s57, s60
  buffer_load_dwordx4 v2, s[8:11], s57 offen lds
  s_waitcnt vmcnt(0)
  s_add_u32 s58, s58, 1
  s_cmp_lg_u32 s58, 16
  s_cbranch_scc1 Ldn_272
  s_waitcnt vmcnt(16)
  s_barrier
  ds_read_b64_tr_b16 a[32:33], v4 offset:16384
  ds_read_b64_tr_b16 a[34:35], v4 offset:17408
  ds_read_b64_tr_b16 a[160:161], v4 offset:16416
  ds_read_b64_tr_b16 a[162:163], v4 offset:17440
  ds_read_b64_tr_b16 a[36:37], v4 offset:18432
  ds_read_b64_tr_b16 a[38:39], v4 offset:19456
  ds_read_b64_tr_b16 a[164:165], v4 offset:18464
  ds_read_b64_tr_b16 a[166:167], v4 offset:19488
  ds_read_b64_tr_b16 a[40:41], v4 offset:20480
  ds_read_b64_tr_b16 a[42:43], v4 offset:21504
  ds_read_b64_tr_b16 a[168:169], v4 offset:20512
  ds_read_b64_tr_b16 a[170:171], v4 offset:21536
  ds_read_b64_tr_b16 a[44:45], v4 offset:22528
  ds_read_b64_tr_b16 a[46:47], v4 offset:23552
  ds_read_b64_tr_b16 a[172:173], v4 offset:22560
  ds_read_b64_tr_b16 a[174:175], v4 offset:23584
  ds_read_b64_tr_b16 a[48:49], v4 offset:24576
  ds_read_b64_tr_b16 a[50:51], v4 offset:25600
  ds_read_b64_tr_b16 a[176:177], v4 offset:24608
  ds_read_b64_tr_b16 a[178:179], v4 offset:25632
  ds_read_b64_tr_b16 a[52:53], v4 offset:26624
  ds_read_b64_tr_b16 a[54:55], v4 offset:27648
  ds_read_b64_tr_b16 a[180:181], v4 offset:26656
  ds_read_b64_tr_b16 a[182:183], v4 offset:27680
  ds_read_b64_tr_b16 a[56:57], v4 offset:28672
  ds_read_b64_tr_b16 a[58:59], v4 offset:29696
  ds_read_b64_tr_b16 a[184:185], v4 offset:28704
  ds_read_b64_tr_b16 a[186:187], v4 offset:29728
  ds_read_b64_tr_b16 a[60:61], v4 offset:30720
  ds_read_b64_tr_b16 a[62:63], v4 offset:31744
  ds_read_b64_tr_b16 a[188:189], v4 offset:30752
  ds_read_b64_tr_b16 a[190:191], v4 offset:31776
  s_waitcnt lgkmcnt(0)
  s_barrier
  s_lshl_b32 s60, s50, 21
  s_lshl_b32 s56, s52, 6
  s_add_u32 s60, s60, s56
  s_add_u32 s60, s60, 1572864
  s_lshl_b32 s56, s50, 15
  s_add_u32 s56, s56, 16384
  s_mov_b32 s58, 0
Ldn_273:
  s_and_b32 s59, s52, 1
  s_lshl_b32 s59, s59, 3
  s_xor_b32 s59, s59, s58
  s_lshl_b32 s57, s59, 10
  s_add_u32 m0, s56, s57
  s_lshl_b32 s57, s59, 15
  s_add_u32 s57, s57, s60
  buffer_load_dwordx4 v2, s[8:11], s57 offen lds
  s_waitcnt vmcnt(0)
  s_add_u32 s58, s58, 1
  s_cmp_lg_u32 s58, 16
  s_cbranch_scc1 Ldn_273
  s_waitcnt vmcnt(16)
  s_barrier
  ds_read_b64_tr_b16 a[64:65], v4 offset:0
  ds_read_b64_tr_b16 a[66:67], v4 offset:1024
  ds_read_b64_tr_b16 a[192:193], v4 offset:32
  ds_read_b64_tr_b16 a[194:195], v4 offset:1056
  ds_read_b64_tr_b16 a[68:69], v4 offset:2048
  ds_read_b64_tr_b16 a[70:71], v4 offset:3072
  ds_read_b64_tr_b16 a[196:197], v4 offset:2080
  ds_read_b64_tr_b16 a[198:199], v4 offset:3104
  ds_read_b64_tr_b16 a[72:73], v4 offset:4096
  ds_read_b64_tr_b16 a[74:75], v4 offset:5120
  ds_read_b64_tr_b16 a[200:201], v4 offset:4128
  ds_read_b64_tr_b16 a[202:203], v4 offset:5152
  ds_read_b64_tr_b16 a[76:77], v4 offset:6144
  ds_read_b64_tr_b16 a[78:79], v4 offset:7168
  ds_read_b64_tr_b16 a[204:205], v4 offset:6176
  ds_read_b64_tr_b16 a[206:207], v4 offset:7200
  ds_read_b64_tr_b16 a[80:81], v4 offset:8192
  ds_read_b64_tr_b16 a[82:83], v4 offset:9216
  ds_read_b64_tr_b16 a[208:209], v4 offset:8224
  ds_read_b64_tr_b16 a[210:211], v4 offset:9248
  ds_read_b64_tr_b16 a[84:85], v4 offset:10240
  ds_read_b64_tr_b16 a[86:87], v4 offset:11264
  ds_read_b64_tr_b16 a[212:213], v4 offset:10272
  ds_read_b64_tr_b16 a[214:215], v4 offset:11296
  ds_read_b64_tr_b16 a[88:89], v4 offset:12288
  ds_read_b64_tr_b16 a[90:91], v4 offset:13312
  ds_read_b64_tr_b16 a[216:217], v4 offset:12320
  ds_read_b64_tr_b16 a[218:219], v4 offset:13344
  ds_read_b64_tr_b16 a[92:93], v4 offset:14336
  ds_read_b64_tr_b16 a[94:95], v4 offset:15360
  ds_read_b64_tr_b16 a[220:221], v4 offset:14368
  ds_read_b64_tr_b16 a[222:223], v4 offset:15392
  s_waitcnt lgkmcnt(0)
  s_barrier
  s_waitcnt vmcnt(0)
  s_barrier
  ds_read_b64_tr_b16 a[96:97], v4 offset:16384
  ds_read_b64_tr_b16 a[98:99], v4 offset:17408
  ds_read_b64_tr_b16 a[224:225], v4 offset:16416
  ds_read_b64_tr_b16 a[226:227], v4 offset:17440
  ds_read_b64_tr_b16 a[100:101], v4 offset:18432
  ds_read_b64_tr_b16 a[102:103], v4 offset:19456
  ds_read_b64_tr_b16 a[228:229], v4 offset:18464
  ds_read_b64_tr_b16 a[230:231], v4 offset:19488
  ds_read_b64_tr_b16 a[104:105], v4 offset:20480
  ds_read_b64_tr_b16 a[106:107], v4 offset:21504
  ds_read_b64_tr_b16 a[232:233], v4 offset:20512
  ds_read_b64_tr_b16 a[234:235], v4 offset:21536
  ds_read_b64_tr_b16 a[108:109], v4 offset:22528
  ds_read_b64_tr_b16 a[110:111], v4 offset:23552
  ds_read_b64_tr_b16 a[236:237], v4 offset:22560
  ds_read_b64_tr_b16 a[238:239], v4 offset:23584
  ds_read_b64_tr_b16 a[112:113], v4 offset:24576
  ds_read_b64_tr_b16 a[114:115], v4 offset:25600
  ds_read_b64_tr_b16 a[240:241], v4 offset:24608
  ds_read_b64_tr_b16 a[242:243], v4 offset:25632
  ds_read_b64_tr_b16 a[116:117], v4 offset:26624
  ds_read_b64_tr_b16 a[118:119], v4 offset:27648
  ds_read_b64_tr_b16 a[244:245], v4 offset:26656
  ds_read_b64_tr_b16 a[246:247], v4 offset:27680
  ds_read_b64_tr_b16 a[120:121], v4 offset:28672
  ds_read_b64_tr_b16 a[122:123], v4 offset:29696
  ds_read_b64_tr_b16 a[248:249], v4 offset:28704
  ds_read_b64_tr_b16 a[250:251], v4 offset:29728
  ds_read_b64_tr_b16 a[124:125], v4 offset:30720
  ds_read_b64_tr_b16 a[126:127], v4 offset:31744
  ds_read_b64_tr_b16 a[252:253], v4 offset:30752
  ds_read_b64_tr_b16 a[254:255], v4 offset:31776
  s_waitcnt lgkmcnt(0)
  s_barrier
  v_and_b32 v126, 7, v0
  s_lshl_b32 s56, s50, 13
  s_add_u32 s56, s56, 512
  v_lshl_add_u32 v8, v126, 10, s56
  v_and_b32 v126, 15, v0
  v_lshrrev_b32 v127, 4, v0
  v_mul_u32_u24 v9, 144, v126
  v_lshl_add_u32 v9, v127, 4, v9
  s_mul_i32 s56, s50, 2304
  v_add_u32 v9, s56, v9
  s_lshl_b32 s56, s50, 2
  v_add_u32 v127, s56, v127
  v_mul_u32_u24 v10, 144, v127
  v_lshl_add_u32 v10, v126, 3, v10
  v_lshlrev_b32 v11, 12, v127
  v_lshl_add_u32 v11, v126, 2, v11
  s_lshl_b32 s56, s52, 10
  v_lshl_add_u32 v5, v126, 6, s56
  s_and_b32 s66, s51, 1
  s_cmp_ge_u32 s51, 6
  s_cselect_b32 s61, 57, 0
Lwa_274:
  v_lshlrev_b32 v69, 2, v0
  buffer_load_dword v68, v69, s[20:23], 0 offen sc1
  s_waitcnt vmcnt(0)
Lwa_278:
  s_cmp_eq_u32 s100, 0
  s_cbranch_scc1 Lwa_276
  s_mov_b32 s56, 0
  v_readlane_b32 s57, v68, 8
  s_add_u32 s56, s56, s57
  v_readlane_b32 s57, v68, 9
  s_add_u32 s56, s56, s57
  v_readlane_b32 s57, v68, 10
  s_add_u32 s56, s56, s57
  v_readlane_b32 s57, v68, 11
  s_add_u32 s56, s56, s57
  v_readlane_b32 s57, v68, 12
  s_add_u32 s56, s56, s57
  v_readlane_b32 s57, v68, 13
  s_add_u32 s56, s56, s57
  v_readlane_b32 s57, v68, 14
  s_add_u32 s56, s56, s57
  v_readlane_b32 s57, v68, 15
  s_add_u32 s56, s56, s57
  v_readlane_b32 s57, v68, 16
  s_add_u32 s56, s56, s57
  v_readlane_b32 s57, v68, 40
  s_add_u32 s56, s56, s57
  v_readlane_b32 s57, v68, 41
  s_add_u32 s56, s56, s57
  v_readlane_b32 s57, v68, 42
  s_add_u32 s56, s56, s57
  v_readlane_b32 s57, v68, 43
  s_add_u32 s56, s56, s57
  v_readlane_b32 s57, v68, 44
  s_add_u32 s56, s56, s57
  v_readlane_b32 s57, v68, 45
  s_add_u32 s56, s56, s57
  v_readlane_b32 s57, v68, 46
  s_add_u32 s56, s56, s57
  v_readlane_b32 s57, v68, 47
  s_add_u32 s56, s56, s57
  v_readlane_b32 s57, v68, 48
  s_add_u32 s56, s56, s57
  s_cmp_lt_u32 s56, 256
  s_cbranch_scc1 Lwa_277
  s_lshr_b32 s58, s100, 2
  v_readlane_b32 s56, v68, s58
  s_add_u32 s58, s58, 32
  v_readlane_b32 s57, v68, s58
  s_add_u32 s56, s56, s57
  s_cmp_eq_u32 s58, 48
  s_cselect_b32 s56, 0, s56
  s_cmp_lt_u32 s56, 256
  s_cbranch_scc1 L_restart
  v_readlane_b32 s56, v68, 32
  s_cmp_ge_u32 s56, 128
  s_cbranch_scc1 Lwa_275
  s_branch Lwa_277
Lwa_276:
  v_readlane_b32 s56, v68, 0
  s_cmp_ge_u32 s56, 256
  s_cbranch_scc1 Lwa_275
Lwa_277:
  s_sleep 8
  s_add_u32 s55, s55, 1
  s_bitcmp1_b32 s55, 21
  s_cbranch_scc1 L_abort
  s_branch Lwa_274
Lwa_275:
L_g3_loop:
  s_add_u32 s64, s61, 1
Lwf_280:
  buffer_load_dword v126, v8, s[4:7], 0 offen sc1
  s_waitcnt vmcnt(0)
  v_cmp_gt_u32 vcc, s64, v126
  s_cbranch_vccz Lwf_281
  s_sleep 1
  s_add_u32 s55, s55, 1
  s_bitcmp1_b32 s55, 21
  s_cbranch_scc1 L_abort
  s_branch Lwf_280
Lwf_281:
  s_lshl_b32 s63, s61, 1
  s_add_u32 s63, s63, s66
  s_lshl_b32 s64, s63, 16
  s_lshl_b32 s63, s63, 2
  s_add_u32 s63, s63, s50
  s_lshl_b32 s63, s63, 15
  s_add_u32 s63, s63, 0x5400000
  s_lshl_b32 s56, s52, 6
  s_add_u32 s64, s64, s56
  buffer_load_dword v6, v5, s[4:7], s63 offen sc1
  buffer_load_dwordx4 v[128:131], v1, s[4:7], s63 offen offset:0 sc1
  buffer_load_dwordx4 v[132:135], v1, s[4:7], s63 offen offset:1024 sc1
  buffer_load_dwordx4 v[136:139], v1, s[4:7], s63 offen offset:2048 sc1
  buffer_load_dwordx4 v[140:143], v1, s[4:7], s63 offen offset:3072 sc1
  s_add_u32 s63, s63, 4096
  buffer_load_dwordx4 v[144:147], v1, s[4:7], s63 offen offset:0 sc1
  buffer_load_dwordx4 v[148:151], v1, s[4:7], s63 offen offset:1024 sc1
  buffer_load_dwordx4 v[152:155], v1, s[4:7], s63 offen offset:2048 sc1
  buffer_load_dwordx4 v[156:159], v1, s[4:7], s63 offen offset:3072 sc1
  s_add_u32 s63, s63, 4096
  buffer_load_dwordx4 v[160:163], v1, s[4:7], s63 offen offset:0 sc1
  buffer_load_dwordx4 v[164:167], v1, s[4:7], s63 offen offset:1024 sc1
  buffer_load_dwordx4 v[168:171], v1, s[4:7], s63 offen offset:2048 sc1
  buffer_load_dwordx4 v[172:175], v1, s[4:7], s63 offen offset:3072 sc1
  s_add_u32 s63, s63, 4096
  buffer_load_dwordx4 v[176:179], v1, s[4:7], s63 offen offset:0 sc1
  buffer_load_dwordx4 v[180:183], v1, s[4:7], s63 offen offset:1024 sc1
  buffer_load_dwordx4 v[184:187], v1, s[4:7], s63 offen offset:2048 sc1
  buffer_load_dwordx4 v[188:191], v1, s[4:7], s63 offen offset:3072 sc1
  s_add_u32 s63, s63, 4096
  buffer_load_dwordx4 v[192:195], v1, s[4:7], s63 offen offset:0 sc1
  buffer_load_dwordx4 v[196:199], v1, s[4:7], s63 offen offset:1024 sc1
  buffer_load_dwordx4 v[200:203], v1, s[4:7], s63 offen offset:2048 sc1
  buffer_load_dwordx4 v[204:207], v1, s[4:7], s63 offen offset:3072 sc1
  s_add_u32 s63, s63, 4096
  buffer_load_dwordx4 v[208:211], v1, s[4:7], s63 offen offset:0 sc1
  buffer_load_dwordx4 v[212:215], v1, s[4:7], s63 offen offset:1024 sc1
  buffer_load_dwordx4 v[216:219], v1, s[4:7], s63 offen offset:2048 sc1
  buffer_load_dwordx4 v[220:223], v1, s[4:7], s63 offen offset:3072 sc1
  s_add_u32 s63, s63, 4096
  buffer_load_dwordx4 v[224:227], v1, s[4:7], s63 offen offset:0 sc1
  buffer_load_dwordx4 v[228:231], v1, s[4:7], s63 offen offset:1024 sc1
  buffer_load_dwordx4 v[232:235], v1, s[4:7], s63 offen offset:2048 sc1
  buffer_load_dwordx4 v[236:239], v1, s[4:7], s63 offen offset:3072 sc1
  s_add_u32 s63, s63, 4096
  buffer_load_dwordx4 v[240:243], v1, s[4:7], s63 offen offset:0 sc1
  buffer_load_dwordx4 v[244:247], v1, s[4:7], s63 offen offset:1024 sc1
  buffer_load_dwordx4 v[248:251], v1, s[4:7], s63 offen offset:2048 sc1
  buffer_load_dwordx4 v[252:255], v1, s[4:7], s63 offen offset:3072 sc1
  s_waitcnt vmcnt(31)
  v_mfma_f32_16x16x32_bf16 v[20:23], a[0:3], v[128:131], 0
  v_mfma_f32_16x16x32_bf16 v[24:27], a[128:131], v[128:131], 0
  s_waitcnt vmcnt(30)
  v_mfma_f32_16x16x32_bf16 v[20:23], a[4:7], v[132:135], v[20:23]
  v_mfma_f32_16x16x32_bf16 v[24:27], a[132:135], v[132:135], v[24:27]
  s_waitcnt vmcnt(29)
  v_mfma_f32_16x16x32_bf16 v[20:23], a[8:11], v[136:139], v[20:23]
  v_mfma_f32_16x16x32_bf16 v[24:27], a[136:139], v[136:139], v[24:27]
  s_waitcnt vmcnt(28)
  v_mfma_f32_16x16x32_bf16 v[20:23], a[12:15], v[140:143], v[20:23]
  v_mfma_f32_16x16x32_bf16 v[24:27], a[140:143], v[140:143], v[24:27]
  s_waitcnt vmcnt(27)
  v_mfma_f32_16x16x32_bf16 v[20:23], a[16:19], v[144:147], v[20:23]
  v_mfma_f32_16x16x32_bf16 v[24:27], a[144:147], v[144:147], v[24:27]
  s_waitcnt vmcnt(26)
  v_mfma_f32_16x16x32_bf16 v[20:23], a[20:23], v[148:151], v[20:23]
  v_mfma_f32_16x16x32_bf16 v[24:27], a[148:151], v[148:151], v[24:27]
  s_waitcnt vmcnt(25)
  v_mfma_f32_16x16x32_bf16 v[20:23], a[24:27], v[152:155], v[20:23]
  v_mfma_f32_16x16x32_bf16 v[24:27], a[152:155], v[152:155], v[24:27]
  s_waitcnt vmcnt(24)
  v_mfma_f32_16x16x32_bf16 v[20:23], a[28:31], v[156:159], v[20:23]
  v_mfma_f32_16x16x32_bf16 v[24:27], a[156:159], v[156:159], v[24:27]
  s_waitcnt vmcnt(23)
  v_mfma_f32_16x16x32_bf16 v[20:23], a[32:35], v[160:163], v[20:23]
  v_mfma_f32_16x16x32_bf16 v[24:27], a[160:163], v[160:163], v[24:27]
  s_waitcnt vmcnt(22)
  v_mfma_f32_16x16x32_bf16 v[20:23], a[36:39], v[164:167], v[20:23]
  v_mfma_f32_16x16x32_bf16 v[24:27], a[164:167], v[164:167], v[24:27]
  s_waitcnt vmcnt(21)
  v_mfma_f32_16x16x32_bf16 v[20:23], a[40:43], v[168:171], v[20:23]
  v_mfma_f32_16x16x32_bf16 v[24:27], a[168:171], v[168:171], v[24:27]
  s_waitcnt vmcnt(20)
  v_mfma_f32_16x16x32_bf16 v[20:23], a[44:47], v[172:175], v[20:23]
  v_mfma_f32_16x16x32_bf16 v[24:27], a[172:175], v[172:175], v[24:27]
  s_waitcnt vmcnt(19)
  v_mfma_f32_16x16x32_bf16 v[20:23], a[48:51], v[176:179], v[20:23]
  v_mfma_f32_16x16x32_bf16 v[24:27], a[176:179], v[176:179], v[24:27]
  s_waitcnt vmcnt(18)
  v_mfma_f32_16x16x32_bf16 v[20:23], a[52:55], v[180:183], v[20:23]
  v_mfma_f32_16x16x32_bf16 v[24:27], a[180:183], v[180:183], v[24:27]
  s_waitcnt vmcnt(17)
  v_mfma_f32_16x16x32_bf16 v[20:23], a[56:59], v[184:187], v[20:23]
  v_mfma_f32_16x16x32_bf16 v[24:27], a[184:187], v[184:187], v[24:27]
  s_waitcnt vmcnt(16)
  v_mfma_f32_16x16x32_bf16 v[20:23], a[60:63], v[188:191], v[20:23]
  v_mfma_f32_16x16x32_bf16 v[24:27], a[188:191], v[188:191], v[24:27]
  s_waitcnt vmcnt(15)
  v_mfma_f32_16x16x32_bf16 v[20:23], a[64:67], v[192:195], v[20:23]
  v_mfma_f32_16x16x32_bf16 v[24:27], a[192:195], v[192:195], v[24:27]
  s_waitcnt vmcnt(14)
  v_mfma_f32_16x16x32_bf16 v[20:23], a[68:71], v[196:199], v[20:23]
  v_mfma_f32_16x16x32_bf16 v[24:27], a[196:199], v[196:199], v[24:27]
  s_waitcnt vmcnt(13)
  v_mfma_f32_16x16x32_bf16 v[20:23], a[72:75], v[200:203], v[20:23]
  v_mfma_f32_16x16x32_bf16 v[24:27], a[200:203], v[200:203], v[24:27]
  s_waitcnt vmcnt(12)
  v_mfma_f32_16x16x32_bf16 v[20:23], a[76:79], v[204:207], v[20:23]
  v_mfma_f32_16x16x32_bf16 v[24:27], a[204:207], v[204:207], v[24:27]
  s_waitcnt vmcnt(11)
  v_mfma_f32_16x16x32_bf16 v[20:23], a[80:83], v[208:211], v[20:23]
  v_mfma_f32_16x16x32_bf16 v[24:27], a[208:211], v[208:211], v[24:27]
  s_waitcnt vmcnt(10)
  v_mfma_f32_16x16x32_bf16 v[20:23], a[84:87], v[212:215], v[20:23]
  v_mfma_f32_16x16x32_bf16 v[24:27], a[212:215], v[212:215], v[24:27]
  s_waitcnt vmcnt(9)
  v_mfma_f32_16x16x32_bf16 v[20:23], a[88:91], v[216:219], v[20:23]
  v_mfma_f32_16x16x32_bf16 v[24:27], a[216:219], v[216:219], v[24:27]
  s_waitcnt vmcnt(8)
  v_mfma_f32_16x16x32_bf16 v[20:23], a[92:95], v[220:223], v[20:23]
  v_mfma_f32_16x16x32_bf16 v[24:27], a[220:223], v[220:223], v[24:27]
  s_waitcnt vmcnt(7)
  v_mfma_f32_16x16x32_bf16 v[20:23], a[96:99], v[224:227], v[20:23]
  v_mfma_f32_16x16x32_bf16 v[24:27], a[224:227], v[224:227], v[24:27]
  s_waitcnt vmcnt(6)
  v_mfma_f32_16x16x32_bf16 v[20:23], a[100:103], v[228:231], v[20:23]
  v_mfma_f32_16x16x32_bf16 v[24:27], a[228:231], v[228:231], v[24:27]
  s_waitcnt vmcnt(5)
  v_mfma_f32_16x16x32_bf16 v[20:23], a[104:107], v[232:235], v[20:23]
  v_mfma_f32_16x16x32_bf16 v[24:27], a[232:235], v[232:235], v[24:27]
  s_waitcnt vmcnt(4)
  v_mfma_f32_16x16x32_bf16 v[20:23], a[108:111], v[236:239], v[20:23]
  v_mfma_f32_16x16x32_bf16 v[24:27], a[236:239], v[236:239], v[24:27]
  s_waitcnt vmcnt(3)
  v_mfma_f32_16x16x32_bf16 v[20:23], a[112:115], v[240:243], v[20:23]
  v_mfma_f32_16x16x32_bf16 v[24:27], a[240:243], v[240:243], v[24:27]
  s_waitcnt vmcnt(2)
  v_mfma_f32_16x16x32_bf16 v[20:23], a[116:119], v[244:247], v[20:23]
  v_mfma_f32_16x16x32_bf16 v[24:27], a[244:247], v[244:247], v[24:27]
  s_waitcnt vmcnt(1)
  v_mfma_f32_16x16x32_bf16 v[20:23], a[120:123], v[248:251], v[20:23]
  v_mfma_f32_16x16x32_bf16 v[24:27], a[248:251], v[248:251], v[24:27]
  s_waitcnt vmcnt(0)
  v_mfma_f32_16x16x32_bf16 v[20:23], a[124:127], v[252:255], v[20:23]
  v_mfma_f32_16x16x32_bf16 v[24:27], a[252:255], v[252:255], v[24:27]
  v_mov_b32 v0, v0
  v_mov_b32 v0, v0
  v_mov_b32 v0, v0
  v_mov_b32 v0, v0
  v_mov_b32 v0, v0
  v_mov_b32 v0, v0
  v_mov_b32 v0, v0
  ds_write_b128 v9, v[20:23]
  ds_write_b128 v9, v[24:27] offset:64
  s_waitcnt lgkmcnt(0)
  s_barrier
  ds_read_b64 v[28:29], v10 offset:0
  ds_read_b64 v[30:31], v10 offset:2304
  ds_read_b64 v[32:33], v10 offset:4608
  ds_read_b64 v[34:35], v10 offset:6912
  v_xor_b32 v9, 0x4000, v9
  v_xor_b32 v10, 0x4000, v10
  s_waitcnt lgkmcnt(0)
  v_pk_add_f32 v[28:29], v[28:29], v[30:31]
  v_pk_add_f32 v[32:33], v[32:33], v[34:35]
  v_pk_add_f32 v[28:29], v[28:29], v[32:33]
  v_cvt_pk_bf16_f32 v28, v28, v29
  buffer_store_dword v28, v11, s[16:19], s64 offen
  s_cmp_ge_u32 s61, 56
  s_addc_u32 s61, s61, 1
  s_cmp_lt_u32 s61, 64
  s_cbranch_scc1 L_g3_loop
  s_branch L_end
L_abort:
  s_mov_b64 exec, 1
  s_lshl_b32 s56, s2, 8
  s_or_b32 s56, s56, s54
  s_or_b32 s56, s56, 0x40000000
  v_mov_b32 v2, s56
  buffer_store_dword v2, off, s[20:23], 0 offset:16 sc1
L_end:
  s_endpgm
.section .rodata,"a"
.p2align 6
.amdhsa_kernel concat_heads__memory_aug_recurrent_mem_tr__linear_attn_block__prompt_kernel
  .amdhsa_next_free_vgpr 512
  .amdhsa_next_free_sgpr 102
  .amdhsa_accum_offset 256
  .amdhsa_group_segment_fixed_size 0
  .amdhsa_kernarg_size 104
  .amdhsa_user_sgpr_count 2
  .amdhsa_user_sgpr_kernarg_segment_ptr 1
  .amdhsa_system_sgpr_workgroup_id_x 1
  .amdhsa_float_denorm_mode_32 3
.end_amdhsa_kernel
```
